```python
import torch

def _softmax(x, axis=-1):
    return torch.softmax(x, dim=axis)

def _gelu(x):
    return torch.nn.functional.gelu(x, approximate='tanh')

def _silu(x):
    return torch.nn.functional.silu(x)

def _sigmoid(x):
    return torch.sigmoid(x)

def _layernorm(x, axis=-1, eps=1e-05):
    m = x.mean(dim=axis, keepdim=True)
    v = x.var(dim=axis, keepdim=True, unbiased=False)
    return (x - m) / torch.sqrt(v + eps)

def _scatter_add(tgt, idx, src, axis=0):
    return tgt.clone().index_add_(axis, idx, src)

def _segment_sum(src, seg, n):
    out = torch.zeros((n,) + src.shape[1:], dtype=src.dtype)
    return out.index_add_(0, seg, src)

def _pad(x, pw):
    flat = tuple((v for pair in reversed(pw) for v in pair))
    return torch.nn.functional.pad(x, flat)
kernel_name = 'gated_mix__linear_attn_block__mixer_gmlp__prompt'

def setup_inputs():

    _w = lambda a: (lambda t: t.to(torch.bfloat16) if t.is_floating_point() else t)(torch.as_tensor(a))

    def _A_setup():
        B, S, D = (1, 2048, 512)
        return {'x': _w((lambda *s: torch.randn(*s, dtype=torch.bfloat16) * 0.05)(B, S, D)), 'wqkv': _w((lambda *s: torch.randn(*s, dtype=torch.bfloat16) * 1.6)(D, 3 * D)), 'wo': _w((lambda *s: torch.randn(*s, dtype=torch.bfloat16) * 0.2)(D, D))}
    _A_in = _A_setup()

    def _B_setup():
        B, S, D, F = (1, 2048, 512, 1792)
        Fh = F // 2
        return {'x': _w((lambda *s: torch.randn(*s, dtype=torch.bfloat16) * 0.05)(B, S, D)), 'w_in': _w((lambda *s: torch.randn(*s, dtype=torch.bfloat16) * 0.4)(D, 2 * Fh)), 'w_sp': _w(0.01 * (lambda *s: torch.randn(*s, dtype=torch.bfloat16) * 0.4)(S, S)), 'b_sp': _w(1.0 + 0.01 * (lambda *s: torch.randn(*s, dtype=torch.bfloat16) * 0.05)(S)), 'w_out': _w((lambda *s: torch.randn(*s, dtype=torch.bfloat16) * 0.05)(Fh, D))}
    _B_in = _B_setup()
    return {'A_x': _A_in['x'], 'A_wqkv': _A_in['wqkv'], 'A_wo': _A_in['wo'], 'B_x': _B_in['x'], 'B_w_in': _B_in['w_in'], 'B_w_sp': _B_in['w_sp'], 'B_b_sp': _B_in['b_sp'], 'B_w_out': _B_in['w_out'], 'gate_w': _w((lambda *s: torch.randn(*s, dtype=torch.bfloat16) * 0.05)(512) * 16.0)}

def reference(A_x, A_wqkv, A_wo, B_x, B_w_in, B_w_sp, B_b_sp, B_w_out, gate_w):

    def _A_ref(x, wqkv, wo):
        B, S, D = x.shape
        H = 32
        Dh = D // H
        qkv = (lambda x, *d: x.permute(*d))((x @ wqkv).reshape(B, S, 3, H, Dh), 2, 0, 3, 1, 4)
        q, k, v = (qkv[0], qkv[1], qkv[2])
        phi = lambda t: torch.where(t > 0, t + 1, torch.exp(t)) + 1e-06
        pq, pk = (phi(q), phi(k))
        kv = torch.einsum('bhsd,bhse->bhde', pk, v)
        z = torch.einsum('bhsd->bhd', pk)
        num = torch.einsum('bhqd,bhde->bhqe', pq, kv)
        den = torch.einsum('bhqd,bhd->bhq', pq, z)[..., None] + 1e-06
        o = num / den
        return (lambda x, *d: x.permute(*d))(o, 0, 2, 1, 3).reshape(B, S, D) @ wo

    def _B_ref(x, w_in, w_sp, b_sp, w_out):
        B, S, D = x.shape
        F = w_in.shape[-1]
        Fh = F // 2
        z = _gelu(torch.einsum('bsd,df->bsf', x, w_in))
        z1 = z[..., :Fh].clone()
        z2 = _layernorm(z[..., Fh:], axis=-1)
        g = torch.einsum('ts,bsf->btf', w_sp, z2) + b_sp[None, :, None]
        return torch.einsum('bsf,fd->bsd', z1 * g, w_out)
    x = A_x
    g = _sigmoid((x * gate_w).sum(-1, keepdims=True))
    a = _A_ref(x, A_wqkv, A_wo)
    b = _B_ref(x, B_w_in, B_w_sp, B_b_sp, B_w_out)
    return g * a + (1 - g) * b
```

```asm
; @launch grid=(256,1,1) block=(512,1,1) lds=163840
.amdgcn_target "amdgcn-amd-amdhsa--gfx950"
.text
.globl gated_mix__linear_attn_block__mixer_gmlp__prompt_kernel
.p2align 8
.type gated_mix__linear_attn_block__mixer_gmlp__prompt_kernel,@function
gated_mix__linear_attn_block__mixer_gmlp__prompt_kernel:
    s_cmp_ge_u32 s2, 256
    s_cbranch_scc1 L_end
    s_load_dwordx16 s[36:51], s[0:1], 0
    s_load_dwordx8 s[52:59], s[0:1], 64
    v_and_b32 v1, 63, v0
    v_lshrrev_b32 v2, 6, v0
    s_nop 0
    v_readfirstlane_b32 s16, v2
    v_and_b32 v6, 255, v0
    s_lshr_b32 s29, s2, 3
    s_and_b32 s30, s2, 1
    s_bfe_u32 s19, s2, 0x20001
    s_lshl_b32 s19, s19, 2
    s_and_b32 s23, s29, 3
    s_add_u32 s19, s19, s23
    s_lshr_b32 s31, s29, 2
    s_lshl_b32 s21, s23, 1
    s_add_u32 s21, s21, s31
    s_and_b32 s21, s21, 6
    s_lshl_b32 s23, s30, 2
    s_xor_b32 s20, s31, s23
    s_xor_b32 s63, s20, 4
    s_and_b32 s17, s16, 3
    s_lshr_b32 s18, s16, 2
    s_lshl_b32 s27, s17, 10
    s_mov_b32 s33, 0
    s_mov_b32 s7, 0x20000
    s_mov_b32 s11, 0x20000
    s_mov_b32 s99, 0x20000
    s_lshl_b32 s32, s19, 2
    s_lshl_b32 s22, s30, 1
    s_add_u32 s32, s32, s22
    s_add_u32 s32, s32, s18
    s_lshl_b32 s22, s30, 3
    s_add_u32 s62, s22, s20
    s_add_u32 s22, s22, s31
    s_cmp_eq_u32 s22, 11
    s_cbranch_scc1 L_misc
    s_cmp_lt_u32 s16, 4
    s_cbranch_scc1 L_p1_comp
    s_setprio 3
    v_lshrrev_b32 v4, 3, v6
    v_lshlrev_b32 v2, 10, v4
    v_lshrrev_b32 v4, 4, v6
    v_xor_b32 v4, v4, v6
    v_and_b32 v4, 7, v4
    v_lshl_add_u32 v2, v4, 4, v2
    s_movk_i32 s23, 3584
    v_lshrrev_b32 v4, 3, v6
    v_mul_lo_u32 v3, v4, s23
    v_bfe_u32 v4, v6, 4, 1
    v_lshlrev_b32 v4, 2, v4
    v_and_b32 v5, 7, v6
    v_xor_b32 v4, v4, v5
    v_lshl_add_u32 v3, v4, 4, v3
    s_movk_i32 s23, 3072
    v_lshrrev_b32 v4, 3, v6
    v_mul_lo_u32 v7, v4, s23
    v_bfe_u32 v4, v6, 4, 1
    v_lshlrev_b32 v4, 2, v4
    v_and_b32 v5, 7, v6
    v_xor_b32 v4, v4, v5
    v_lshl_add_u32 v7, v4, 4, v7
    s_and_b32 s23, s17, 1
    s_lshl_b32 s23, s23, 5
    v_xor_b32 v3, s23, v3
    v_xor_b32 v7, s23, v7
    s_lshl_b32 s24, s19, 17
    s_lshl_b32 s25, s20, 8
    s_lshl_b32 s26, s63, 7
    s_waitcnt lgkmcnt(0)
    s_mov_b32 s4, s36
    s_mov_b32 s5, s37
    s_mov_b32 s6, 0x200000
    s_mov_b32 s8, s44
    s_mov_b32 s9, s45
    s_mov_b32 s10, 0x1c0000
    s_mov_b32 s96, s38
    s_mov_b32 s97, s39
    s_mov_b32 s98, 0x180000
    s_cmp_ge_u32 s31, 4
    s_cbranch_scc1 L_hq
    s_add_u32 s23, s21, 0
    s_and_b32 s23, s23, 7
    s_lshl_b32 s34, s23, 7
    s_add_u32 s34, s34, s24
    s_add_u32 m0, s27, 0
    s_nop 0
    buffer_load_dwordx4 v2, s[4:7], s34 offen lds
    s_add_u32 s34, s34, 32768
    s_add_u32 m0, s27, 4096
    s_nop 0
    buffer_load_dwordx4 v2, s[4:7], s34 offen lds
    s_add_u32 s34, s34, 32768
    s_add_u32 m0, s27, 8192
    s_nop 0
    buffer_load_dwordx4 v2, s[4:7], s34 offen lds
    s_add_u32 s34, s34, 32768
    s_add_u32 m0, s27, 12288
    s_nop 0
    buffer_load_dwordx4 v2, s[4:7], s34 offen lds
    s_mul_i32 s34, s23, 229376
    s_add_u32 s34, s34, s25
    s_add_u32 s34, s34, 1792
    s_add_u32 m0, s27, 16384
    s_nop 0
    buffer_load_dwordx4 v3, s[8:11], s34 offen lds
    s_add_u32 s34, s34, 114688
    s_add_u32 m0, s27, 20480
    s_nop 0
    buffer_load_dwordx4 v3, s[8:11], s34 offen lds
    s_mul_i32 s34, s23, 229376
    s_add_u32 s34, s34, s25
    s_add_u32 s34, s34, 1920
    s_add_u32 m0, s27, 24576
    s_nop 0
    buffer_load_dwordx4 v3, s[8:11], s34 offen lds
    s_add_u32 s34, s34, 114688
    s_add_u32 m0, s27, 28672
    s_nop 0
    buffer_load_dwordx4 v3, s[8:11], s34 offen lds
    s_add_u32 s23, s21, 1
    s_and_b32 s23, s23, 7
    s_lshl_b32 s34, s23, 7
    s_add_u32 s34, s34, s24
    s_add_u32 m0, s27, 32768
    s_nop 0
    buffer_load_dwordx4 v2, s[4:7], s34 offen lds
    s_add_u32 s34, s34, 32768
    s_add_u32 m0, s27, 36864
    s_nop 0
    buffer_load_dwordx4 v2, s[4:7], s34 offen lds
    s_add_u32 s34, s34, 32768
    s_add_u32 m0, s27, 40960
    s_nop 0
    buffer_load_dwordx4 v2, s[4:7], s34 offen lds
    s_add_u32 s34, s34, 32768
    s_add_u32 m0, s27, 45056
    s_nop 0
    buffer_load_dwordx4 v2, s[4:7], s34 offen lds
    s_mul_i32 s34, s23, 229376
    s_add_u32 s34, s34, s25
    s_add_u32 s34, s34, 1792
    s_add_u32 m0, s27, 49152
    s_nop 0
    buffer_load_dwordx4 v3, s[8:11], s34 offen lds
    s_add_u32 s34, s34, 114688
    s_add_u32 m0, s27, 53248
    s_nop 0
    buffer_load_dwordx4 v3, s[8:11], s34 offen lds
    s_mul_i32 s34, s23, 229376
    s_add_u32 s34, s34, s25
    s_add_u32 s34, s34, 1920
    s_add_u32 m0, s27, 57344
    s_nop 0
    buffer_load_dwordx4 v3, s[8:11], s34 offen lds
    s_add_u32 s34, s34, 114688
    s_add_u32 m0, s27, 61440
    s_nop 0
    buffer_load_dwordx4 v3, s[8:11], s34 offen lds
    s_mov_b32 s12, s58
    s_mov_b32 s13, s59
    s_mov_b32 s14, 0x1800000
    s_mov_b32 s15, 0x20000
    s_add_u32 s60, s58, 0x16f0000
    s_addc_u32 s61, s59, 0
    s_load_dword s28, s[60:61], 0
    s_waitcnt vmcnt(8)
    s_barrier
    s_add_u32 s23, s21, 2
    s_and_b32 s23, s23, 7
    s_lshl_b32 s34, s23, 7
    s_add_u32 s34, s34, s24
    s_add_u32 m0, s27, 65536
    s_nop 0
    buffer_load_dwordx4 v2, s[4:7], s34 offen lds
    s_add_u32 s34, s34, 32768
    s_add_u32 m0, s27, 69632
    s_nop 0
    buffer_load_dwordx4 v2, s[4:7], s34 offen lds
    s_add_u32 s34, s34, 32768
    s_add_u32 m0, s27, 73728
    s_nop 0
    buffer_load_dwordx4 v2, s[4:7], s34 offen lds
    s_add_u32 s34, s34, 32768
    s_add_u32 m0, s27, 77824
    s_nop 0
    buffer_load_dwordx4 v2, s[4:7], s34 offen lds
    s_mul_i32 s34, s23, 229376
    s_add_u32 s34, s34, s25
    s_add_u32 s34, s34, 1792
    s_add_u32 m0, s27, 81920
    s_nop 0
    buffer_load_dwordx4 v3, s[8:11], s34 offen lds
    s_add_u32 s34, s34, 114688
    s_add_u32 m0, s27, 86016
    s_nop 0
    buffer_load_dwordx4 v3, s[8:11], s34 offen lds
    s_mul_i32 s34, s23, 229376
    s_add_u32 s34, s34, s25
    s_add_u32 s34, s34, 1920
    s_add_u32 m0, s27, 90112
    s_nop 0
    buffer_load_dwordx4 v3, s[8:11], s34 offen lds
    s_add_u32 s34, s34, 114688
    s_add_u32 m0, s27, 94208
    s_nop 0
    buffer_load_dwordx4 v3, s[8:11], s34 offen lds
    s_add_u32 s23, s21, 3
    s_and_b32 s23, s23, 7
    s_lshl_b32 s34, s23, 7
    s_add_u32 s34, s34, s24
    s_add_u32 m0, s27, 98304
    s_nop 0
    buffer_load_dwordx4 v2, s[4:7], s34 offen lds
    s_add_u32 s34, s34, 32768
    s_add_u32 m0, s27, 102400
    s_nop 0
    buffer_load_dwordx4 v2, s[4:7], s34 offen lds
    s_add_u32 s34, s34, 32768
    s_add_u32 m0, s27, 106496
    s_nop 0
    buffer_load_dwordx4 v2, s[4:7], s34 offen lds
    s_add_u32 s34, s34, 32768
    s_add_u32 m0, s27, 110592
    s_nop 0
    buffer_load_dwordx4 v2, s[4:7], s34 offen lds
    s_mul_i32 s34, s23, 229376
    s_add_u32 s34, s34, s25
    s_add_u32 s34, s34, 1792
    s_add_u32 m0, s27, 114688
    s_nop 0
    buffer_load_dwordx4 v3, s[8:11], s34 offen lds
    s_add_u32 s34, s34, 114688
    s_add_u32 m0, s27, 118784
    s_nop 0
    buffer_load_dwordx4 v3, s[8:11], s34 offen lds
    s_mul_i32 s34, s23, 229376
    s_add_u32 s34, s34, s25
    s_add_u32 s34, s34, 1920
    s_add_u32 m0, s27, 122880
    s_nop 0
    buffer_load_dwordx4 v3, s[8:11], s34 offen lds
    s_add_u32 s34, s34, 114688
    s_add_u32 m0, s27, 126976
    s_nop 0
    buffer_load_dwordx4 v3, s[8:11], s34 offen lds
    s_waitcnt vmcnt(16)
    s_barrier
    s_add_u32 s23, s21, 4
    s_and_b32 s23, s23, 7
    s_lshl_b32 s34, s23, 7
    s_add_u32 s34, s34, s24
    s_add_u32 m0, s27, 131072
    s_nop 0
    buffer_load_dwordx4 v2, s[4:7], s34 offen lds
    s_add_u32 s34, s34, 32768
    s_add_u32 m0, s27, 135168
    s_nop 0
    buffer_load_dwordx4 v2, s[4:7], s34 offen lds
    s_add_u32 s34, s34, 32768
    s_add_u32 m0, s27, 139264
    s_nop 0
    buffer_load_dwordx4 v2, s[4:7], s34 offen lds
    s_add_u32 s34, s34, 32768
    s_add_u32 m0, s27, 143360
    s_nop 0
    buffer_load_dwordx4 v2, s[4:7], s34 offen lds
    s_mul_i32 s34, s23, 229376
    s_add_u32 s34, s34, s25
    s_add_u32 s34, s34, 1792
    s_add_u32 m0, s27, 147456
    s_nop 0
    buffer_load_dwordx4 v3, s[8:11], s34 offen lds
    s_add_u32 s34, s34, 114688
    s_add_u32 m0, s27, 151552
    s_nop 0
    buffer_load_dwordx4 v3, s[8:11], s34 offen lds
    s_mul_i32 s34, s23, 229376
    s_add_u32 s34, s34, s25
    s_add_u32 s34, s34, 1920
    s_add_u32 m0, s27, 155648
    s_nop 0
    buffer_load_dwordx4 v3, s[8:11], s34 offen lds
    s_add_u32 s34, s34, 114688
    s_add_u32 m0, s27, 159744
    s_nop 0
    buffer_load_dwordx4 v3, s[8:11], s34 offen lds
    s_waitcnt vmcnt(16)
    s_barrier
    s_add_u32 s23, s21, 5
    s_and_b32 s23, s23, 7
    s_lshl_b32 s34, s23, 7
    s_add_u32 s34, s34, s24
    s_add_u32 m0, s27, 0
    s_nop 0
    buffer_load_dwordx4 v2, s[4:7], s34 offen lds
    s_add_u32 s34, s34, 32768
    s_add_u32 m0, s27, 4096
    s_nop 0
    buffer_load_dwordx4 v2, s[4:7], s34 offen lds
    s_add_u32 s34, s34, 32768
    s_add_u32 m0, s27, 8192
    s_nop 0
    buffer_load_dwordx4 v2, s[4:7], s34 offen lds
    s_add_u32 s34, s34, 32768
    s_add_u32 m0, s27, 12288
    s_nop 0
    buffer_load_dwordx4 v2, s[4:7], s34 offen lds
    s_mul_i32 s34, s23, 229376
    s_add_u32 s34, s34, s25
    s_add_u32 s34, s34, 1792
    s_add_u32 m0, s27, 16384
    s_nop 0
    buffer_load_dwordx4 v3, s[8:11], s34 offen lds
    s_add_u32 s34, s34, 114688
    s_add_u32 m0, s27, 20480
    s_nop 0
    buffer_load_dwordx4 v3, s[8:11], s34 offen lds
    s_mul_i32 s34, s23, 229376
    s_add_u32 s34, s34, s25
    s_add_u32 s34, s34, 1920
    s_add_u32 m0, s27, 24576
    s_nop 0
    buffer_load_dwordx4 v3, s[8:11], s34 offen lds
    s_add_u32 s34, s34, 114688
    s_add_u32 m0, s27, 28672
    s_nop 0
    buffer_load_dwordx4 v3, s[8:11], s34 offen lds
    s_waitcnt vmcnt(16)
    s_barrier
    s_add_u32 s23, s21, 6
    s_and_b32 s23, s23, 7
    s_lshl_b32 s34, s23, 7
    s_add_u32 s34, s34, s24
    s_add_u32 m0, s27, 32768
    s_nop 0
    buffer_load_dwordx4 v2, s[4:7], s34 offen lds
    s_add_u32 s34, s34, 32768
    s_add_u32 m0, s27, 36864
    s_nop 0
    buffer_load_dwordx4 v2, s[4:7], s34 offen lds
    s_add_u32 s34, s34, 32768
    s_add_u32 m0, s27, 40960
    s_nop 0
    buffer_load_dwordx4 v2, s[4:7], s34 offen lds
    s_add_u32 s34, s34, 32768
    s_add_u32 m0, s27, 45056
    s_nop 0
    buffer_load_dwordx4 v2, s[4:7], s34 offen lds
    s_mul_i32 s34, s23, 229376
    s_add_u32 s34, s34, s25
    s_add_u32 s34, s34, 1792
    s_add_u32 m0, s27, 49152
    s_nop 0
    buffer_load_dwordx4 v3, s[8:11], s34 offen lds
    s_add_u32 s34, s34, 114688
    s_add_u32 m0, s27, 53248
    s_nop 0
    buffer_load_dwordx4 v3, s[8:11], s34 offen lds
    s_mul_i32 s34, s23, 229376
    s_add_u32 s34, s34, s25
    s_add_u32 s34, s34, 1920
    s_add_u32 m0, s27, 57344
    s_nop 0
    buffer_load_dwordx4 v3, s[8:11], s34 offen lds
    s_add_u32 s34, s34, 114688
    s_add_u32 m0, s27, 61440
    s_nop 0
    buffer_load_dwordx4 v3, s[8:11], s34 offen lds
    s_waitcnt vmcnt(16)
    s_barrier
    s_add_u32 s23, s21, 7
    s_and_b32 s23, s23, 7
    s_lshl_b32 s34, s23, 7
    s_add_u32 s34, s34, s24
    s_add_u32 m0, s27, 65536
    s_nop 0
    buffer_load_dwordx4 v2, s[4:7], s34 offen lds
    s_add_u32 s34, s34, 32768
    s_add_u32 m0, s27, 69632
    s_nop 0
    buffer_load_dwordx4 v2, s[4:7], s34 offen lds
    s_add_u32 s34, s34, 32768
    s_add_u32 m0, s27, 73728
    s_nop 0
    buffer_load_dwordx4 v2, s[4:7], s34 offen lds
    s_add_u32 s34, s34, 32768
    s_add_u32 m0, s27, 77824
    s_nop 0
    buffer_load_dwordx4 v2, s[4:7], s34 offen lds
    s_mul_i32 s34, s23, 229376
    s_add_u32 s34, s34, s25
    s_add_u32 s34, s34, 1792
    s_add_u32 m0, s27, 81920
    s_nop 0
    buffer_load_dwordx4 v3, s[8:11], s34 offen lds
    s_add_u32 s34, s34, 114688
    s_add_u32 m0, s27, 86016
    s_nop 0
    buffer_load_dwordx4 v3, s[8:11], s34 offen lds
    s_mul_i32 s34, s23, 229376
    s_add_u32 s34, s34, s25
    s_add_u32 s34, s34, 1920
    s_add_u32 m0, s27, 90112
    s_nop 0
    buffer_load_dwordx4 v3, s[8:11], s34 offen lds
    s_add_u32 s34, s34, 114688
    s_add_u32 m0, s27, 94208
    s_nop 0
    buffer_load_dwordx4 v3, s[8:11], s34 offen lds
    v_lshrrev_b32 v19, 3, v6
    v_lshlrev_b32 v19, 12, v19
    v_and_b32 v9, 7, v6
    v_lshl_add_u32 v19, v9, 7, v19
    s_lshl_b32 s23, s19, 2
    s_and_b32 s34, s31, 3
    s_add_u32 s23, s23, s34
    s_lshl_b32 s23, s23, 17
    s_lshl_b32 s34, s30, 11
    s_add_u32 s23, s23, s34
    v_add_u32 v19, s23, v19
    global_load_dword v10, v19, s[46:47] offset:0
    s_mul_i32 s23, s2, 3584
    s_mul_i32 s34, s17, 896
    s_add_u32 s23, s23, s34
    v_lshlrev_b32 v9, 7, v1
    v_add_u32 v9, s23, v9
    s_mov_b64 exec, 0x7f
    global_load_dword v13, v9, s[50:51]
    s_lshl_b32 s23, s2, 11
    s_lshl_b32 s34, s17, 9
    s_add_u32 s23, s23, s34
    v_lshlrev_b32 v9, 7, v1
    v_add_u32 v9, s23, v9
    s_mov_b64 exec, 15
    global_load_dword v12, v9, s[40:41]
    s_mov_b64 exec, -1
    s_waitcnt vmcnt(19)
    s_barrier
    s_waitcnt vmcnt(11)
    s_barrier
    s_waitcnt vmcnt(3)
    s_barrier
    s_add_u32 s23, s21, 3
    s_and_b32 s23, s23, 7
    s_mul_i32 s34, s23, 229376
    s_add_u32 s34, s34, s25
    s_add_u32 m0, s27, 114688
    s_nop 0
    buffer_load_dwordx4 v3, s[8:11], s34 offen lds
    s_add_u32 s34, s34, 114688
    s_add_u32 m0, s27, 118784
    s_nop 0
    buffer_load_dwordx4 v3, s[8:11], s34 offen lds
    s_add_u32 s23, s21, 8
    s_and_b32 s23, s23, 7
    s_mul_i32 s34, s23, 229376
    s_add_u32 s34, s34, s25
    s_add_u32 m0, s27, 122880
    s_nop 0
    buffer_load_dwordx4 v3, s[8:11], s34 offen lds
    s_add_u32 s34, s34, 114688
    s_add_u32 m0, s27, 126976
    s_nop 0
    buffer_load_dwordx4 v3, s[8:11], s34 offen lds
    s_add_u32 s23, s21, 4
    s_and_b32 s23, s23, 7
    s_mul_i32 s34, s23, 229376
    s_add_u32 s34, s34, s25
    s_add_u32 m0, s27, 147456
    s_nop 0
    buffer_load_dwordx4 v3, s[8:11], s34 offen lds
    s_add_u32 s34, s34, 114688
    s_add_u32 m0, s27, 151552
    s_nop 0
    buffer_load_dwordx4 v3, s[8:11], s34 offen lds
    s_add_u32 s23, s21, 9
    s_and_b32 s23, s23, 7
    s_mul_i32 s34, s23, 229376
    s_add_u32 s34, s34, s25
    s_add_u32 m0, s27, 155648
    s_nop 0
    buffer_load_dwordx4 v3, s[8:11], s34 offen lds
    s_add_u32 s34, s34, 114688
    s_add_u32 m0, s27, 159744
    s_nop 0
    buffer_load_dwordx4 v3, s[8:11], s34 offen lds
    s_add_u32 s23, s21, 5
    s_and_b32 s23, s23, 7
    s_mul_i32 s34, s23, 229376
    s_add_u32 s34, s34, s25
    s_add_u32 m0, s27, 16384
    s_nop 0
    buffer_load_dwordx4 v3, s[8:11], s34 offen lds
    s_add_u32 s34, s34, 114688
    s_add_u32 m0, s27, 20480
    s_nop 0
    buffer_load_dwordx4 v3, s[8:11], s34 offen lds
    s_add_u32 s23, s21, 10
    s_and_b32 s23, s23, 7
    s_mul_i32 s34, s23, 229376
    s_add_u32 s34, s34, s25
    s_add_u32 m0, s27, 24576
    s_nop 0
    buffer_load_dwordx4 v3, s[8:11], s34 offen lds
    s_add_u32 s34, s34, 114688
    s_add_u32 m0, s27, 28672
    s_nop 0
    buffer_load_dwordx4 v3, s[8:11], s34 offen lds
    s_barrier
    s_add_u32 s23, s21, 6
    s_and_b32 s23, s23, 7
    s_mul_i32 s34, s23, 229376
    s_add_u32 s34, s34, s25
    s_add_u32 m0, s27, 49152
    s_nop 0
    buffer_load_dwordx4 v3, s[8:11], s34 offen lds
    s_add_u32 s34, s34, 114688
    s_add_u32 m0, s27, 53248
    s_nop 0
    buffer_load_dwordx4 v3, s[8:11], s34 offen lds
    s_add_u32 s23, s21, 7
    s_and_b32 s23, s23, 7
    s_mul_i32 s34, s23, 229376
    s_add_u32 s34, s34, s25
    s_add_u32 m0, s27, 81920
    s_nop 0
    buffer_load_dwordx4 v3, s[8:11], s34 offen lds
    s_add_u32 s34, s34, 114688
    s_add_u32 m0, s27, 86016
    s_nop 0
    buffer_load_dwordx4 v3, s[8:11], s34 offen lds
    s_waitcnt lgkmcnt(0)
    s_add_u32 s28, s28, 0x9e3779b9
    s_lshl_b32 s23, s19, 7
    s_add_u32 s23, s23, 0x1683800
    v_mov_b32 v8, 0
L_poll1:
    buffer_load_dword v9, v8, s[12:15], s23 offen sc1
    s_add_u32 s33, s33, 1
    s_waitcnt vmcnt(0)
    v_cmp_ne_u32 vcc, s28, v9
    s_cmp_gt_u32 s33, 262144
    s_cbranch_scc1 L_poll1_d
    s_cbranch_vccnz L_poll1
L_poll1_d:
    v_lshrrev_b32 v4, 3, v6
    v_lshlrev_b32 v2, 12, v4
    v_lshrrev_b32 v4, 4, v6
    v_xor_b32 v4, v4, v6
    v_and_b32 v4, 7, v4
    v_lshl_add_u32 v2, v4, 4, v2
    s_lshl_b32 s24, s19, 19
    s_lshl_b32 s23, s30, 11
    s_add_u32 s24, s24, s23
    s_mov_b32 s4, s46
    s_mov_b32 s5, s47
    s_mov_b32 s6, 0x800000
    s_mov_b32 s96, s40
    s_mov_b32 s97, s41
    s_mov_b32 s98, 0x80000
    v_lshrrev_b32 v4, 3, v1
    v_lshlrev_b32 v7, 10, v4
    v_bfe_u32 v4, v1, 4, 1
    v_lshlrev_b32 v4, 2, v4
    v_and_b32 v5, 7, v1
    v_xor_b32 v4, v4, v5
    v_lshl_add_u32 v7, v4, 4, v7
    s_lshl_b32 s23, s17, 15
    v_add_u32 v7, s23, v7
    v_mov_b32 v3, v7
    s_mov_b32 s8, s50
    s_mov_b32 s9, s51
    s_mov_b32 s10, 0xe0000
    s_lshl_b32 s23, s19, 8
    v_lshlrev_b32 v22, 2, v1
    v_add_u32 v70, s23, v22
    global_load_dword v70, v70, s[48:49]
    v_lshlrev_b32 v17, 4, v1
    v_add_u32 v14, s27, v17
    v_add_u32 v15, 65536, v14
    v_add_u32 v16, 131072, v14
    s_mul_i32 s34, s17, 98304
    s_lshl_b32 s23, s31, 7
    s_add_u32 s34, s34, s23
    s_lshl_b32 s23, s17, 12
    buffer_load_dwordx4 v[144:147], v7, s[96:99], s34 offen
    s_add_u32 s34, s34, 8192
    buffer_load_dwordx4 v[148:151], v7, s[96:99], s34 offen
    s_add_u32 s34, s34, 8192
    buffer_load_dwordx4 v[152:155], v7, s[96:99], s34 offen
    s_add_u32 s34, s34, 8192
    buffer_load_dwordx4 v[156:159], v7, s[96:99], s34 offen
    s_mul_i32 s34, s17, 98304
    s_lshl_b32 s23, s31, 7
    s_add_u32 s34, s34, s23
    s_add_u32 s34, s34, 32768
    s_lshl_b32 s23, s17, 12
    buffer_load_dwordx4 v[160:163], v7, s[96:99], s34 offen
    s_add_u32 s34, s34, 8192
    buffer_load_dwordx4 v[164:167], v7, s[96:99], s34 offen
    s_add_u32 s34, s34, 8192
    buffer_load_dwordx4 v[168:171], v7, s[96:99], s34 offen
    s_add_u32 s34, s34, 8192
    buffer_load_dwordx4 v[172:175], v7, s[96:99], s34 offen
    s_add_u32 s34, s24, 0
    buffer_load_dwordx4 v[80:83], v2, s[4:7], s34 offen
    s_add_u32 s34, s34, 131072
    buffer_load_dwordx4 v[84:87], v2, s[4:7], s34 offen
    s_add_u32 s34, s34, 131072
    buffer_load_dwordx4 v[88:91], v2, s[4:7], s34 offen
    s_add_u32 s34, s34, 131072
    buffer_load_dwordx4 v[92:95], v2, s[4:7], s34 offen
    s_add_u32 s34, s24, 128
    buffer_load_dwordx4 v[96:99], v2, s[4:7], s34 offen
    s_add_u32 s34, s34, 131072
    buffer_load_dwordx4 v[100:103], v2, s[4:7], s34 offen
    s_add_u32 s34, s34, 131072
    buffer_load_dwordx4 v[104:107], v2, s[4:7], s34 offen
    s_add_u32 s34, s34, 131072
    buffer_load_dwordx4 v[108:111], v2, s[4:7], s34 offen
    s_barrier
    s_mul_i32 s34, s17, 98304
    s_lshl_b32 s23, s31, 7
    s_add_u32 s34, s34, s23
    s_add_u32 s34, s34, 65536
    s_lshl_b32 s23, s17, 12
    buffer_load_dwordx4 v[176:179], v7, s[96:99], s34 offen
    s_add_u32 s34, s34, 8192
    buffer_load_dwordx4 v[180:183], v7, s[96:99], s34 offen
    s_add_u32 s34, s34, 8192
    buffer_load_dwordx4 v[184:187], v7, s[96:99], s34 offen
    s_add_u32 s34, s34, 8192
    buffer_load_dwordx4 v[188:191], v7, s[96:99], s34 offen
    s_mul_i32 s34, s17, 98304
    s_lshl_b32 s23, s31, 7
    s_add_u32 s34, s34, s23
    s_add_u32 s34, s34, 98304
    s_lshl_b32 s23, s17, 12
    buffer_load_dwordx4 v[192:195], v7, s[96:99], s34 offen
    s_add_u32 s34, s34, 8192
    buffer_load_dwordx4 v[196:199], v7, s[96:99], s34 offen
    s_add_u32 s34, s34, 8192
    buffer_load_dwordx4 v[200:203], v7, s[96:99], s34 offen
    s_add_u32 s34, s34, 8192
    buffer_load_dwordx4 v[204:207], v7, s[96:99], s34 offen
    s_add_u32 s34, s24, 256
    buffer_load_dwordx4 v[112:115], v2, s[4:7], s34 offen
    s_add_u32 s34, s34, 131072
    s_waitcnt vmcnt(6)
    buffer_load_dwordx4 v[116:119], v2, s[4:7], s34 offen
    s_add_u32 s34, s34, 131072
    s_waitcnt vmcnt(6)
    buffer_load_dwordx4 v[120:123], v2, s[4:7], s34 offen
    s_add_u32 s34, s34, 131072
    s_waitcnt vmcnt(6)
    buffer_load_dwordx4 v[124:127], v2, s[4:7], s34 offen
    s_waitcnt vmcnt(6)
    s_add_u32 s34, s24, 384
    buffer_load_dwordx4 v[128:131], v2, s[4:7], s34 offen
    s_add_u32 s34, s34, 131072
    s_waitcnt vmcnt(6)
    buffer_load_dwordx4 v[132:135], v2, s[4:7], s34 offen
    s_add_u32 s34, s34, 131072
    s_waitcnt vmcnt(6)
    buffer_load_dwordx4 v[136:139], v2, s[4:7], s34 offen
    s_add_u32 s34, s34, 131072
    s_waitcnt vmcnt(6)
    buffer_load_dwordx4 v[140:143], v2, s[4:7], s34 offen
    s_waitcnt vmcnt(6)
    s_add_u32 s34, s24, 512
    buffer_load_dwordx4 v[240:243], v2, s[4:7], s34 offen
    s_add_u32 s34, s34, 131072
    s_waitcnt vmcnt(6)
    buffer_load_dwordx4 v[244:247], v2, s[4:7], s34 offen
    s_add_u32 s34, s34, 131072
    s_waitcnt vmcnt(6)
    buffer_load_dwordx4 v[248:251], v2, s[4:7], s34 offen
    s_add_u32 s34, s34, 131072
    s_waitcnt vmcnt(6)
    buffer_load_dwordx4 v[252:255], v2, s[4:7], s34 offen
    s_waitcnt vmcnt(6)
    s_waitcnt vmcnt(0)
    s_lshl_b32 s23, s30, 3
    v_and_b32 v8, 7, v1
    v_add_u32 v8, s23, v8
    s_xor_b32 s23, s23, 15
    v_mov_b32 v9, s23
    v_cmp_gt_u32 vcc, 8, v1
    s_nop 1
    v_cndmask_b32 v8, v9, v8, vcc
    v_lshlrev_b32 v8, 7, v8
    s_lshl_b32 s25, s20, 11
    s_add_u32 s25, s25, 0x1680000
    v_lshrrev_b32 v19, 3, v1
    v_lshlrev_b32 v19, 12, v19
    v_and_b32 v9, 7, v1
    v_lshl_add_u32 v19, v9, 7, v19
    s_lshl_b32 s26, s20, 2
    s_add_u32 s26, s26, s17
    s_lshl_b32 s26, s26, 1
    s_add_u32 s26, s26, s30
    s_lshl_b32 s26, s26, 16
    s_and_b32 s23, s19, 3
    s_lshl_b32 s23, s23, 10
    s_add_u32 s26, s26, s23
    v_lshlrev_b32 v22, 2, v1
    v_add_u32 v22, 135168, v22
    s_barrier
    s_barrier
    ds_write_b32 v22, v70
    ds_write_b128 v14, v[80:83] offset:0
    ds_write_b128 v14, v[84:87] offset:4096
    ds_write_b128 v14, v[88:91] offset:8192
    ds_write_b128 v14, v[92:95] offset:12288
    ds_write_b128 v14, v[96:99] offset:16384
    ds_write_b128 v14, v[100:103] offset:20480
    ds_write_b128 v14, v[104:107] offset:24576
    ds_write_b128 v14, v[108:111] offset:28672
    s_cmp_lg_u32 s16, 4
    s_cbranch_scc1 L_zp2
L_poll3:
    buffer_load_dword v9, v8, s[12:15], s25 offen sc1
    s_add_u32 s33, s33, 1
    s_waitcnt vmcnt(0)
    v_cmp_ne_u32 vcc, s28, v9
    s_cmp_gt_u32 s33, 262144
    s_cbranch_scc1 L_poll3_d
    s_cbranch_vccz L_poll3_d
    s_sleep 4
    s_branch L_poll3
L_poll3_d:
L_zp2:
    s_waitcnt lgkmcnt(8)
    s_barrier
    ds_write_b128 v14, v[112:115] offset:32768
    ds_write_b128 v14, v[116:119] offset:36864
    ds_write_b128 v14, v[120:123] offset:40960
    ds_write_b128 v14, v[124:127] offset:45056
    ds_write_b128 v14, v[128:131] offset:49152
    ds_write_b128 v14, v[132:135] offset:53248
    ds_write_b128 v14, v[136:139] offset:57344
    ds_write_b128 v14, v[140:143] offset:61440
    ds_write_b128 v15, v[240:243] offset:0
    ds_write_b128 v15, v[244:247] offset:4096
    ds_write_b128 v15, v[248:251] offset:8192
    ds_write_b128 v15, v[252:255] offset:12288
    s_add_u32 s34, s24, 640
    s_add_u32 m0, s27, 81920
    s_nop 0
    buffer_load_dwordx4 v2, s[4:7], s34 offen lds
    s_add_u32 s34, s34, 131072
    s_add_u32 m0, s27, 86016
    s_nop 0
    buffer_load_dwordx4 v2, s[4:7], s34 offen lds
    s_add_u32 s34, s34, 131072
    s_add_u32 m0, s27, 90112
    s_nop 0
    buffer_load_dwordx4 v2, s[4:7], s34 offen lds
    s_add_u32 s34, s34, 131072
    s_add_u32 m0, s27, 94208
    s_nop 0
    buffer_load_dwordx4 v2, s[4:7], s34 offen lds
    s_add_u32 s34, s24, 768
    s_add_u32 m0, s27, 98304
    s_nop 0
    buffer_load_dwordx4 v2, s[4:7], s34 offen lds
    s_add_u32 s34, s34, 131072
    s_add_u32 m0, s27, 102400
    s_nop 0
    buffer_load_dwordx4 v2, s[4:7], s34 offen lds
    s_add_u32 s34, s34, 131072
    s_add_u32 m0, s27, 106496
    s_nop 0
    buffer_load_dwordx4 v2, s[4:7], s34 offen lds
    s_add_u32 s34, s34, 131072
    s_add_u32 m0, s27, 110592
    s_nop 0
    buffer_load_dwordx4 v2, s[4:7], s34 offen lds
    s_add_u32 s34, s24, 896
    s_add_u32 m0, s27, 114688
    s_nop 0
    buffer_load_dwordx4 v2, s[4:7], s34 offen lds
    s_add_u32 s34, s34, 131072
    s_add_u32 m0, s27, 118784
    s_nop 0
    buffer_load_dwordx4 v2, s[4:7], s34 offen lds
    s_add_u32 s34, s34, 131072
    s_add_u32 m0, s27, 122880
    s_nop 0
    buffer_load_dwordx4 v2, s[4:7], s34 offen lds
    s_add_u32 s34, s34, 131072
    s_add_u32 m0, s27, 126976
    s_nop 0
    buffer_load_dwordx4 v2, s[4:7], s34 offen lds
    s_branch L_sp_help
L_hq:
    s_add_u32 s23, s21, 0
    s_and_b32 s23, s23, 7
    s_lshl_b32 s34, s23, 7
    s_add_u32 s34, s34, s24
    s_add_u32 m0, s27, 0
    s_nop 0
    buffer_load_dwordx4 v2, s[4:7], s34 offen lds
    s_add_u32 s34, s34, 32768
    s_add_u32 m0, s27, 4096
    s_nop 0
    buffer_load_dwordx4 v2, s[4:7], s34 offen lds
    s_add_u32 s34, s34, 32768
    s_add_u32 m0, s27, 8192
    s_nop 0
    buffer_load_dwordx4 v2, s[4:7], s34 offen lds
    s_add_u32 s34, s34, 32768
    s_add_u32 m0, s27, 12288
    s_nop 0
    buffer_load_dwordx4 v2, s[4:7], s34 offen lds
    s_mul_i32 s34, s23, 196608
    s_add_u32 s34, s34, s26
    s_add_u32 s34, s34, 1024
    s_add_u32 m0, s27, 16384
    s_nop 0
    buffer_load_dwordx4 v7, s[96:99], s34 offen lds
    s_add_u32 s34, s34, 98304
    s_add_u32 m0, s27, 20480
    s_nop 0
    buffer_load_dwordx4 v7, s[96:99], s34 offen lds
    s_mul_i32 s34, s23, 196608
    s_add_u32 s34, s34, s26
    s_add_u32 s34, s34, 2048
    s_add_u32 m0, s27, 24576
    s_nop 0
    buffer_load_dwordx4 v7, s[96:99], s34 offen lds
    s_add_u32 s34, s34, 98304
    s_add_u32 m0, s27, 28672
    s_nop 0
    buffer_load_dwordx4 v7, s[96:99], s34 offen lds
    s_mul_i32 s34, s23, 196608
    s_add_u32 s34, s34, s26
    s_add_u32 m0, s27, 32768
    s_nop 0
    buffer_load_dwordx4 v7, s[96:99], s34 offen lds
    s_add_u32 s34, s34, 98304
    s_add_u32 m0, s27, 36864
    s_nop 0
    buffer_load_dwordx4 v7, s[96:99], s34 offen lds
    s_add_u32 s23, s21, 1
    s_and_b32 s23, s23, 7
    s_lshl_b32 s34, s23, 7
    s_add_u32 s34, s34, s24
    s_add_u32 m0, s27, 40960
    s_nop 0
    buffer_load_dwordx4 v2, s[4:7], s34 offen lds
    s_add_u32 s34, s34, 32768
    s_add_u32 m0, s27, 45056
    s_nop 0
    buffer_load_dwordx4 v2, s[4:7], s34 offen lds
    s_add_u32 s34, s34, 32768
    s_add_u32 m0, s27, 49152
    s_nop 0
    buffer_load_dwordx4 v2, s[4:7], s34 offen lds
    s_add_u32 s34, s34, 32768
    s_add_u32 m0, s27, 53248
    s_nop 0
    buffer_load_dwordx4 v2, s[4:7], s34 offen lds
    s_mul_i32 s34, s23, 196608
    s_add_u32 s34, s34, s26
    s_add_u32 s34, s34, 1024
    s_add_u32 m0, s27, 57344
    s_nop 0
    buffer_load_dwordx4 v7, s[96:99], s34 offen lds
    s_add_u32 s34, s34, 98304
    s_add_u32 m0, s27, 61440
    s_nop 0
    buffer_load_dwordx4 v7, s[96:99], s34 offen lds
    s_mul_i32 s34, s23, 196608
    s_add_u32 s34, s34, s26
    s_add_u32 s34, s34, 2048
    s_add_u32 m0, s27, 65536
    s_nop 0
    buffer_load_dwordx4 v7, s[96:99], s34 offen lds
    s_add_u32 s34, s34, 98304
    s_add_u32 m0, s27, 69632
    s_nop 0
    buffer_load_dwordx4 v7, s[96:99], s34 offen lds
    s_mul_i32 s34, s23, 196608
    s_add_u32 s34, s34, s26
    s_add_u32 m0, s27, 73728
    s_nop 0
    buffer_load_dwordx4 v7, s[96:99], s34 offen lds
    s_add_u32 s34, s34, 98304
    s_add_u32 m0, s27, 77824
    s_nop 0
    buffer_load_dwordx4 v7, s[96:99], s34 offen lds
    s_mov_b32 s12, s58
    s_mov_b32 s13, s59
    s_mov_b32 s14, 0x1800000
    s_mov_b32 s15, 0x20000
    s_add_u32 s60, s58, 0x16f0000
    s_addc_u32 s61, s59, 0
    s_load_dword s28, s[60:61], 0
    s_waitcnt vmcnt(10)
    s_barrier
    s_add_u32 s23, s21, 2
    s_and_b32 s23, s23, 7
    s_lshl_b32 s34, s23, 7
    s_add_u32 s34, s34, s24
    s_add_u32 m0, s27, 81920
    s_nop 0
    buffer_load_dwordx4 v2, s[4:7], s34 offen lds
    s_add_u32 s34, s34, 32768
    s_add_u32 m0, s27, 86016
    s_nop 0
    buffer_load_dwordx4 v2, s[4:7], s34 offen lds
    s_add_u32 s34, s34, 32768
    s_add_u32 m0, s27, 90112
    s_nop 0
    buffer_load_dwordx4 v2, s[4:7], s34 offen lds
    s_add_u32 s34, s34, 32768
    s_add_u32 m0, s27, 94208
    s_nop 0
    buffer_load_dwordx4 v2, s[4:7], s34 offen lds
    s_mul_i32 s34, s23, 196608
    s_add_u32 s34, s34, s26
    s_add_u32 s34, s34, 1024
    s_add_u32 m0, s27, 98304
    s_nop 0
    buffer_load_dwordx4 v7, s[96:99], s34 offen lds
    s_add_u32 s34, s34, 98304
    s_add_u32 m0, s27, 102400
    s_nop 0
    buffer_load_dwordx4 v7, s[96:99], s34 offen lds
    s_mul_i32 s34, s23, 196608
    s_add_u32 s34, s34, s26
    s_add_u32 s34, s34, 2048
    s_add_u32 m0, s27, 106496
    s_nop 0
    buffer_load_dwordx4 v7, s[96:99], s34 offen lds
    s_add_u32 s34, s34, 98304
    s_add_u32 m0, s27, 110592
    s_nop 0
    buffer_load_dwordx4 v7, s[96:99], s34 offen lds
    s_mul_i32 s34, s23, 196608
    s_add_u32 s34, s34, s26
    s_add_u32 m0, s27, 114688
    s_nop 0
    buffer_load_dwordx4 v7, s[96:99], s34 offen lds
    s_add_u32 s34, s34, 98304
    s_add_u32 m0, s27, 118784
    s_nop 0
    buffer_load_dwordx4 v7, s[96:99], s34 offen lds
    s_waitcnt vmcnt(10)
    s_barrier
    s_add_u32 s23, s21, 3
    s_and_b32 s23, s23, 7
    s_lshl_b32 s34, s23, 7
    s_add_u32 s34, s34, s24
    s_add_u32 m0, s27, 122880
    s_nop 0
    buffer_load_dwordx4 v2, s[4:7], s34 offen lds
    s_add_u32 s34, s34, 32768
    s_add_u32 m0, s27, 126976
    s_nop 0
    buffer_load_dwordx4 v2, s[4:7], s34 offen lds
    s_add_u32 s34, s34, 32768
    s_add_u32 m0, s27, 131072
    s_nop 0
    buffer_load_dwordx4 v2, s[4:7], s34 offen lds
    s_add_u32 s34, s34, 32768
    s_add_u32 m0, s27, 135168
    s_nop 0
    buffer_load_dwordx4 v2, s[4:7], s34 offen lds
    s_mul_i32 s34, s23, 196608
    s_add_u32 s34, s34, s26
    s_add_u32 s34, s34, 1024
    s_add_u32 m0, s27, 139264
    s_nop 0
    buffer_load_dwordx4 v7, s[96:99], s34 offen lds
    s_add_u32 s34, s34, 98304
    s_add_u32 m0, s27, 143360
    s_nop 0
    buffer_load_dwordx4 v7, s[96:99], s34 offen lds
    s_mul_i32 s34, s23, 196608
    s_add_u32 s34, s34, s26
    s_add_u32 s34, s34, 2048
    s_add_u32 m0, s27, 147456
    s_nop 0
    buffer_load_dwordx4 v7, s[96:99], s34 offen lds
    s_add_u32 s34, s34, 98304
    s_add_u32 m0, s27, 151552
    s_nop 0
    buffer_load_dwordx4 v7, s[96:99], s34 offen lds
    s_mul_i32 s34, s23, 196608
    s_add_u32 s34, s34, s26
    s_add_u32 m0, s27, 155648
    s_nop 0
    buffer_load_dwordx4 v7, s[96:99], s34 offen lds
    s_add_u32 s34, s34, 98304
    s_add_u32 m0, s27, 159744
    s_nop 0
    buffer_load_dwordx4 v7, s[96:99], s34 offen lds
    s_waitcnt vmcnt(10)
    s_barrier
    s_add_u32 s23, s21, 4
    s_and_b32 s23, s23, 7
    s_lshl_b32 s34, s23, 7
    s_add_u32 s34, s34, s24
    s_add_u32 m0, s27, 0
    s_nop 0
    buffer_load_dwordx4 v2, s[4:7], s34 offen lds
    s_add_u32 s34, s34, 32768
    s_add_u32 m0, s27, 4096
    s_nop 0
    buffer_load_dwordx4 v2, s[4:7], s34 offen lds
    s_add_u32 s34, s34, 32768
    s_add_u32 m0, s27, 8192
    s_nop 0
    buffer_load_dwordx4 v2, s[4:7], s34 offen lds
    s_add_u32 s34, s34, 32768
    s_add_u32 m0, s27, 12288
    s_nop 0
    buffer_load_dwordx4 v2, s[4:7], s34 offen lds
    s_mul_i32 s34, s23, 196608
    s_add_u32 s34, s34, s26
    s_add_u32 s34, s34, 1024
    s_add_u32 m0, s27, 16384
    s_nop 0
    buffer_load_dwordx4 v7, s[96:99], s34 offen lds
    s_add_u32 s34, s34, 98304
    s_add_u32 m0, s27, 20480
    s_nop 0
    buffer_load_dwordx4 v7, s[96:99], s34 offen lds
    s_mul_i32 s34, s23, 196608
    s_add_u32 s34, s34, s26
    s_add_u32 s34, s34, 2048
    s_add_u32 m0, s27, 24576
    s_nop 0
    buffer_load_dwordx4 v7, s[96:99], s34 offen lds
    s_add_u32 s34, s34, 98304
    s_add_u32 m0, s27, 28672
    s_nop 0
    buffer_load_dwordx4 v7, s[96:99], s34 offen lds
    s_mul_i32 s34, s23, 196608
    s_add_u32 s34, s34, s26
    s_add_u32 m0, s27, 32768
    s_nop 0
    buffer_load_dwordx4 v7, s[96:99], s34 offen lds
    s_add_u32 s34, s34, 98304
    s_add_u32 m0, s27, 36864
    s_nop 0
    buffer_load_dwordx4 v7, s[96:99], s34 offen lds
    s_waitcnt vmcnt(10)
    s_barrier
    s_add_u32 s23, s21, 5
    s_and_b32 s23, s23, 7
    s_lshl_b32 s34, s23, 7
    s_add_u32 s34, s34, s24
    s_add_u32 m0, s27, 40960
    s_nop 0
    buffer_load_dwordx4 v2, s[4:7], s34 offen lds
    s_add_u32 s34, s34, 32768
    s_add_u32 m0, s27, 45056
    s_nop 0
    buffer_load_dwordx4 v2, s[4:7], s34 offen lds
    s_add_u32 s34, s34, 32768
    s_add_u32 m0, s27, 49152
    s_nop 0
    buffer_load_dwordx4 v2, s[4:7], s34 offen lds
    s_add_u32 s34, s34, 32768
    s_add_u32 m0, s27, 53248
    s_nop 0
    buffer_load_dwordx4 v2, s[4:7], s34 offen lds
    s_mul_i32 s34, s23, 196608
    s_add_u32 s34, s34, s26
    s_add_u32 s34, s34, 1024
    s_add_u32 m0, s27, 57344
    s_nop 0
    buffer_load_dwordx4 v7, s[96:99], s34 offen lds
    s_add_u32 s34, s34, 98304
    s_add_u32 m0, s27, 61440
    s_nop 0
    buffer_load_dwordx4 v7, s[96:99], s34 offen lds
    s_mul_i32 s34, s23, 196608
    s_add_u32 s34, s34, s26
    s_add_u32 s34, s34, 2048
    s_add_u32 m0, s27, 65536
    s_nop 0
    buffer_load_dwordx4 v7, s[96:99], s34 offen lds
    s_add_u32 s34, s34, 98304
    s_add_u32 m0, s27, 69632
    s_nop 0
    buffer_load_dwordx4 v7, s[96:99], s34 offen lds
    s_mul_i32 s34, s23, 196608
    s_add_u32 s34, s34, s26
    s_add_u32 m0, s27, 73728
    s_nop 0
    buffer_load_dwordx4 v7, s[96:99], s34 offen lds
    s_add_u32 s34, s34, 98304
    s_add_u32 m0, s27, 77824
    s_nop 0
    buffer_load_dwordx4 v7, s[96:99], s34 offen lds
    s_waitcnt vmcnt(10)
    s_barrier
    s_add_u32 s23, s21, 6
    s_and_b32 s23, s23, 7
    s_lshl_b32 s34, s23, 7
    s_add_u32 s34, s34, s24
    s_add_u32 m0, s27, 81920
    s_nop 0
    buffer_load_dwordx4 v2, s[4:7], s34 offen lds
    s_add_u32 s34, s34, 32768
    s_add_u32 m0, s27, 86016
    s_nop 0
    buffer_load_dwordx4 v2, s[4:7], s34 offen lds
    s_add_u32 s34, s34, 32768
    s_add_u32 m0, s27, 90112
    s_nop 0
    buffer_load_dwordx4 v2, s[4:7], s34 offen lds
    s_add_u32 s34, s34, 32768
    s_add_u32 m0, s27, 94208
    s_nop 0
    buffer_load_dwordx4 v2, s[4:7], s34 offen lds
    s_mul_i32 s34, s23, 196608
    s_add_u32 s34, s34, s26
    s_add_u32 s34, s34, 1024
    s_add_u32 m0, s27, 98304
    s_nop 0
    buffer_load_dwordx4 v7, s[96:99], s34 offen lds
    s_add_u32 s34, s34, 98304
    s_add_u32 m0, s27, 102400
    s_nop 0
    buffer_load_dwordx4 v7, s[96:99], s34 offen lds
    s_mul_i32 s34, s23, 196608
    s_add_u32 s34, s34, s26
    s_add_u32 s34, s34, 2048
    s_add_u32 m0, s27, 106496
    s_nop 0
    buffer_load_dwordx4 v7, s[96:99], s34 offen lds
    s_add_u32 s34, s34, 98304
    s_add_u32 m0, s27, 110592
    s_nop 0
    buffer_load_dwordx4 v7, s[96:99], s34 offen lds
    s_mul_i32 s34, s23, 196608
    s_add_u32 s34, s34, s26
    s_add_u32 m0, s27, 114688
    s_nop 0
    buffer_load_dwordx4 v7, s[96:99], s34 offen lds
    s_add_u32 s34, s34, 98304
    s_add_u32 m0, s27, 118784
    s_nop 0
    buffer_load_dwordx4 v7, s[96:99], s34 offen lds
    s_waitcnt vmcnt(10)
    s_barrier
    s_add_u32 s23, s21, 7
    s_and_b32 s23, s23, 7
    s_lshl_b32 s34, s23, 7
    s_add_u32 s34, s34, s24
    s_add_u32 m0, s27, 122880
    s_nop 0
    buffer_load_dwordx4 v2, s[4:7], s34 offen lds
    s_add_u32 s34, s34, 32768
    s_add_u32 m0, s27, 126976
    s_nop 0
    buffer_load_dwordx4 v2, s[4:7], s34 offen lds
    s_add_u32 s34, s34, 32768
    s_add_u32 m0, s27, 131072
    s_nop 0
    buffer_load_dwordx4 v2, s[4:7], s34 offen lds
    s_add_u32 s34, s34, 32768
    s_add_u32 m0, s27, 135168
    s_nop 0
    buffer_load_dwordx4 v2, s[4:7], s34 offen lds
    s_mul_i32 s34, s23, 196608
    s_add_u32 s34, s34, s26
    s_add_u32 s34, s34, 1024
    s_add_u32 m0, s27, 139264
    s_nop 0
    buffer_load_dwordx4 v7, s[96:99], s34 offen lds
    s_add_u32 s34, s34, 98304
    s_add_u32 m0, s27, 143360
    s_nop 0
    buffer_load_dwordx4 v7, s[96:99], s34 offen lds
    s_mul_i32 s34, s23, 196608
    s_add_u32 s34, s34, s26
    s_add_u32 s34, s34, 2048
    s_add_u32 m0, s27, 147456
    s_nop 0
    buffer_load_dwordx4 v7, s[96:99], s34 offen lds
    s_add_u32 s34, s34, 98304
    s_add_u32 m0, s27, 151552
    s_nop 0
    buffer_load_dwordx4 v7, s[96:99], s34 offen lds
    s_mul_i32 s34, s23, 196608
    s_add_u32 s34, s34, s26
    s_add_u32 m0, s27, 155648
    s_nop 0
    buffer_load_dwordx4 v7, s[96:99], s34 offen lds
    s_add_u32 s34, s34, 98304
    s_add_u32 m0, s27, 159744
    s_nop 0
    buffer_load_dwordx4 v7, s[96:99], s34 offen lds
    s_waitcnt lgkmcnt(0)
    s_add_u32 s28, s28, 0x9e3779b9
    s_lshl_b32 s22, s19, 7
    s_add_u32 s22, s22, 0x1683800
    v_mov_b32 v18, s22
    buffer_load_dword v20, v18, s[12:15], 0 offen sc1
    v_lshrrev_b32 v19, 3, v6
    v_lshlrev_b32 v19, 12, v19
    v_and_b32 v9, 7, v6
    v_lshl_add_u32 v19, v9, 7, v19
    s_lshl_b32 s23, s19, 2
    s_and_b32 s34, s31, 3
    s_add_u32 s23, s23, s34
    s_lshl_b32 s23, s23, 17
    s_lshl_b32 s34, s30, 11
    s_add_u32 s23, s23, s34
    v_add_u32 v19, s23, v19
    global_load_dword v11, v19, s[46:47] offset:1024
    s_mul_i32 s23, s2, 3584
    s_mul_i32 s34, s17, 896
    s_add_u32 s23, s23, s34
    v_lshlrev_b32 v9, 7, v1
    v_add_u32 v9, s23, v9
    s_mov_b64 exec, 0x7f
    global_load_dword v13, v9, s[50:51]
    s_lshl_b32 s23, s2, 11
    s_lshl_b32 s34, s17, 9
    s_add_u32 s23, s23, s34
    v_lshlrev_b32 v9, 7, v1
    v_add_u32 v9, s23, v9
    s_mov_b64 exec, 15
    global_load_dword v12, v9, s[40:41]
    s_mov_b64 exec, -1
    v_lshrrev_b32 v4, 3, v6
    v_lshlrev_b32 v2, 12, v4
    v_lshrrev_b32 v4, 4, v6
    v_xor_b32 v4, v4, v6
    v_and_b32 v4, 7, v4
    v_lshl_add_u32 v2, v4, 4, v2
    s_lshl_b32 s24, s19, 19
    s_lshl_b32 s23, s30, 11
    s_add_u32 s24, s24, s23
    s_mov_b32 s4, s46
    s_mov_b32 s5, s47
    s_mov_b32 s6, 0x800000
    s_mov_b32 s96, s40
    s_mov_b32 s97, s41
    s_mov_b32 s98, 0x80000
    v_lshrrev_b32 v4, 3, v1
    v_lshlrev_b32 v7, 10, v4
    v_bfe_u32 v4, v1, 4, 1
    v_lshlrev_b32 v4, 2, v4
    v_and_b32 v5, 7, v1
    v_xor_b32 v4, v4, v5
    v_lshl_add_u32 v7, v4, 4, v7
    s_lshl_b32 s23, s17, 15
    v_add_u32 v7, s23, v7
    s_waitcnt vmcnt(14)
    s_barrier
    s_cmp_eq_u32 s20, 7
    s_cbranch_scc1 L_hq_at
    s_mul_i32 s34, s17, 98304
    s_lshl_b32 s23, s31, 7
    s_add_u32 s34, s34, s23
    s_lshl_b32 s23, s17, 12
    buffer_load_dwordx4 v[144:147], v7, s[96:99], s34 offen
    s_add_u32 s34, s34, 8192
    buffer_load_dwordx4 v[148:151], v7, s[96:99], s34 offen
    s_add_u32 s34, s34, 8192
    buffer_load_dwordx4 v[152:155], v7, s[96:99], s34 offen
    s_add_u32 s34, s34, 8192
    buffer_load_dwordx4 v[156:159], v7, s[96:99], s34 offen
    s_waitcnt vmcnt(8)
    s_barrier
    s_add_u32 s23, s21, 4
    s_and_b32 s23, s23, 7
    s_mul_i32 s34, s23, 229376
    s_add_u32 s34, s34, s25
    s_add_u32 s34, s34, 128
    s_add_u32 m0, s27, 16384
    s_nop 0
    buffer_load_dwordx4 v3, s[8:11], s34 offen lds
    s_add_u32 s34, s34, 114688
    s_add_u32 m0, s27, 20480
    s_nop 0
    buffer_load_dwordx4 v3, s[8:11], s34 offen lds
    s_add_u32 s23, s21, 8
    s_and_b32 s23, s23, 7
    s_mul_i32 s34, s23, 229376
    s_add_u32 s34, s34, s25
    s_add_u32 s34, s34, 128
    s_add_u32 m0, s27, 24576
    s_nop 0
    buffer_load_dwordx4 v3, s[8:11], s34 offen lds
    s_add_u32 s34, s34, 114688
    s_add_u32 m0, s27, 28672
    s_nop 0
    buffer_load_dwordx4 v3, s[8:11], s34 offen lds
    s_add_u32 s23, s21, 5
    s_and_b32 s23, s23, 7
    s_mul_i32 s34, s23, 229376
    s_add_u32 s34, s34, s25
    s_add_u32 s34, s34, 128
    s_add_u32 m0, s27, 57344
    s_nop 0
    buffer_load_dwordx4 v3, s[8:11], s34 offen lds
    s_add_u32 s34, s34, 114688
    s_add_u32 m0, s27, 61440
    s_nop 0
    buffer_load_dwordx4 v3, s[8:11], s34 offen lds
    s_add_u32 s23, s21, 9
    s_and_b32 s23, s23, 7
    s_mul_i32 s34, s23, 229376
    s_add_u32 s34, s34, s25
    s_add_u32 s34, s34, 128
    s_add_u32 m0, s27, 65536
    s_nop 0
    buffer_load_dwordx4 v3, s[8:11], s34 offen lds
    s_add_u32 s34, s34, 114688
    s_add_u32 m0, s27, 69632
    s_nop 0
    buffer_load_dwordx4 v3, s[8:11], s34 offen lds
    s_mul_i32 s34, s17, 98304
    s_lshl_b32 s23, s31, 7
    s_add_u32 s34, s34, s23
    s_add_u32 s34, s34, 32768
    s_lshl_b32 s23, s17, 12
    buffer_load_dwordx4 v[160:163], v7, s[96:99], s34 offen
    s_add_u32 s34, s34, 8192
    buffer_load_dwordx4 v[164:167], v7, s[96:99], s34 offen
    s_add_u32 s34, s34, 8192
    buffer_load_dwordx4 v[168:171], v7, s[96:99], s34 offen
    s_add_u32 s34, s34, 8192
    buffer_load_dwordx4 v[172:175], v7, s[96:99], s34 offen
    s_barrier
    s_add_u32 s23, s21, 6
    s_and_b32 s23, s23, 7
    s_mul_i32 s34, s23, 229376
    s_add_u32 s34, s34, s25
    s_add_u32 s34, s34, 128
    s_add_u32 m0, s27, 98304
    s_nop 0
    buffer_load_dwordx4 v3, s[8:11], s34 offen lds
    s_add_u32 s34, s34, 114688
    s_add_u32 m0, s27, 102400
    s_nop 0
    buffer_load_dwordx4 v3, s[8:11], s34 offen lds
    s_add_u32 s23, s21, 10
    s_and_b32 s23, s23, 7
    s_mul_i32 s34, s23, 229376
    s_add_u32 s34, s34, s25
    s_add_u32 s34, s34, 128
    s_add_u32 m0, s27, 106496
    s_nop 0
    buffer_load_dwordx4 v3, s[8:11], s34 offen lds
    s_add_u32 s34, s34, 114688
    s_add_u32 m0, s27, 110592
    s_nop 0
    buffer_load_dwordx4 v3, s[8:11], s34 offen lds
    s_add_u32 s23, s21, 7
    s_and_b32 s23, s23, 7
    s_mul_i32 s34, s23, 229376
    s_add_u32 s34, s34, s25
    s_add_u32 s34, s34, 128
    s_add_u32 m0, s27, 139264
    s_nop 0
    buffer_load_dwordx4 v3, s[8:11], s34 offen lds
    s_add_u32 s34, s34, 114688
    s_add_u32 m0, s27, 143360
    s_nop 0
    buffer_load_dwordx4 v3, s[8:11], s34 offen lds
    s_add_u32 s23, s21, 11
    s_and_b32 s23, s23, 7
    s_mul_i32 s34, s23, 229376
    s_add_u32 s34, s34, s25
    s_add_u32 s34, s34, 128
    s_add_u32 m0, s27, 147456
    s_nop 0
    buffer_load_dwordx4 v3, s[8:11], s34 offen lds
    s_add_u32 s34, s34, 114688
    s_add_u32 m0, s27, 151552
    s_nop 0
    buffer_load_dwordx4 v3, s[8:11], s34 offen lds
    v_mov_b32 v3, v7
    s_mov_b32 s8, s50
    s_mov_b32 s9, s51
    s_mov_b32 s10, 0xe0000
    s_lshl_b32 s23, s19, 8
    v_lshlrev_b32 v22, 2, v1
    v_add_u32 v70, s23, v22
    global_load_dword v70, v70, s[48:49]
    v_lshlrev_b32 v17, 4, v1
    v_add_u32 v14, s27, v17
    v_add_u32 v15, 65536, v14
    v_add_u32 v16, 131072, v14
    s_mul_i32 s34, s17, 98304
    s_lshl_b32 s23, s31, 7
    s_add_u32 s34, s34, s23
    s_add_u32 s34, s34, 65536
    s_lshl_b32 s23, s17, 12
    buffer_load_dwordx4 v[176:179], v7, s[96:99], s34 offen
    s_add_u32 s34, s34, 8192
    buffer_load_dwordx4 v[180:183], v7, s[96:99], s34 offen
    s_add_u32 s34, s34, 8192
    buffer_load_dwordx4 v[184:187], v7, s[96:99], s34 offen
    s_add_u32 s34, s34, 8192
    buffer_load_dwordx4 v[188:191], v7, s[96:99], s34 offen
    s_mul_i32 s34, s17, 98304
    s_lshl_b32 s23, s31, 7
    s_add_u32 s34, s34, s23
    s_add_u32 s34, s34, 98304
    s_lshl_b32 s23, s17, 12
    buffer_load_dwordx4 v[192:195], v7, s[96:99], s34 offen
    s_add_u32 s34, s34, 8192
    buffer_load_dwordx4 v[196:199], v7, s[96:99], s34 offen
    s_add_u32 s34, s34, 8192
    buffer_load_dwordx4 v[200:203], v7, s[96:99], s34 offen
    s_add_u32 s34, s34, 8192
    buffer_load_dwordx4 v[204:207], v7, s[96:99], s34 offen
    s_branch L_hq_kv
L_hq_at:
    s_waitcnt vmcnt(4)
    s_barrier
    s_barrier
    s_waitcnt vmcnt(0)
    v_lshrrev_b32 v4, 3, v6
    v_lshlrev_b32 v2, 12, v4
    v_lshrrev_b32 v4, 4, v6
    v_xor_b32 v4, v4, v6
    v_and_b32 v4, 7, v4
    v_lshl_add_u32 v2, v4, 4, v2
    s_lshl_b32 s24, s19, 19
    s_lshl_b32 s23, s30, 11
    s_add_u32 s24, s24, s23
    s_mov_b32 s4, s46
    s_mov_b32 s5, s47
    s_mov_b32 s6, 0x800000
    s_mov_b32 s96, s40
    s_mov_b32 s97, s41
    s_mov_b32 s98, 0x80000
    v_lshrrev_b32 v4, 3, v1
    v_lshlrev_b32 v7, 10, v4
    v_bfe_u32 v4, v1, 4, 1
    v_lshlrev_b32 v4, 2, v4
    v_and_b32 v5, 7, v1
    v_xor_b32 v4, v4, v5
    v_lshl_add_u32 v7, v4, 4, v7
    s_lshl_b32 s23, s17, 15
    v_add_u32 v7, s23, v7
    v_mov_b32 v3, v7
    s_mov_b32 s8, s50
    s_mov_b32 s9, s51
    s_mov_b32 s10, 0xe0000
    s_lshl_b32 s23, s19, 8
    v_lshlrev_b32 v22, 2, v1
    v_add_u32 v70, s23, v22
    global_load_dword v70, v70, s[48:49]
    v_lshlrev_b32 v17, 4, v1
    v_add_u32 v14, s27, v17
    v_add_u32 v15, 65536, v14
    v_add_u32 v16, 131072, v14
L_hq_kv:
    s_waitcnt vmcnt(8)
    v_cmp_ne_u32 vcc, s28, v20
    s_nop 0
    s_cbranch_vccz L_hq0
    s_mov_b32 s22, 0
L_poll4:
    buffer_load_dword v20, v18, s[12:15], s22 offen sc1
    s_add_u32 s33, s33, 1
    s_waitcnt vmcnt(0)
    v_cmp_ne_u32 vcc, s28, v20
    s_cmp_gt_u32 s33, 262144
    s_cbranch_scc1 L_poll4_d
    s_cbranch_vccnz L_poll4
L_poll4_d:
L_hq0:
    s_lshl_b32 s25, s63, 4
    s_add_u32 s25, s25, s19
    s_mul_i32 s25, s25, 4352
    s_add_u32 s25, s25, 0x1500000
    s_add_u32 s26, s25, 4096
    v_lshlrev_b32 v8, 4, v6
    v_add_u32 v9, 32768, v8
    v_add_u32 v10, 81920, v9
    s_barrier
    ds_read_b128 v[24:27], v9 offset:0
    ds_read_b128 v[28:31], v9 offset:40960
    ds_read_b128 v[32:35], v10 offset:0
    ds_read_b128 v[36:39], v10 offset:40960
    ds_read_b128 v[40:43], v9 offset:4096
    ds_read_b128 v[44:47], v9 offset:45056
    ds_read_b128 v[48:51], v10 offset:4096
    ds_read_b128 v[52:55], v10 offset:45056
    s_waitcnt lgkmcnt(0)
    v_add_f32 v24, v24, v28
    v_add_f32 v32, v32, v36
    v_add_f32 v56, v24, v32
    v_add_f32 v25, v25, v29
    v_add_f32 v33, v33, v37
    v_add_f32 v57, v25, v33
    v_add_f32 v26, v26, v30
    v_add_f32 v34, v34, v38
    v_add_f32 v58, v26, v34
    v_add_f32 v27, v27, v31
    v_add_f32 v35, v35, v39
    v_add_f32 v59, v27, v35
    v_add_f32 v40, v40, v44
    v_add_f32 v48, v48, v52
    v_add_f32 v60, v40, v48
    v_add_f32 v41, v41, v45
    v_add_f32 v49, v49, v53
    v_add_f32 v61, v41, v49
    v_add_f32 v42, v42, v46
    v_add_f32 v50, v50, v54
    v_add_f32 v62, v42, v50
    v_add_f32 v43, v43, v47
    v_add_f32 v51, v51, v55
    v_add_f32 v63, v43, v51
    buffer_store_dwordx4 v[56:59], v8, s[12:15], s25 offen sc1
    s_cmp_lg_u32 s16, 4
    s_cbranch_scc1 L_hq2
    s_mov_b64 exec, 0xffff
    buffer_store_dwordx4 v[60:63], v8, s[12:15], s26 offen sc1
    s_mov_b64 exec, -1
L_hq2:
    s_cmp_eq_u32 s20, 7
    s_cbranch_scc0 L_hq3
    s_branch L_o
L_hq3:
    s_add_u32 s34, s24, 0
    buffer_load_dwordx4 v[80:83], v2, s[4:7], s34 offen
    s_add_u32 s34, s34, 131072
    buffer_load_dwordx4 v[84:87], v2, s[4:7], s34 offen
    s_add_u32 s34, s34, 131072
    buffer_load_dwordx4 v[88:91], v2, s[4:7], s34 offen
    s_add_u32 s34, s34, 131072
    buffer_load_dwordx4 v[92:95], v2, s[4:7], s34 offen
    s_add_u32 s34, s24, 128
    buffer_load_dwordx4 v[96:99], v2, s[4:7], s34 offen
    s_add_u32 s34, s34, 131072
    buffer_load_dwordx4 v[100:103], v2, s[4:7], s34 offen
    s_add_u32 s34, s34, 131072
    buffer_load_dwordx4 v[104:107], v2, s[4:7], s34 offen
    s_add_u32 s34, s34, 131072
    buffer_load_dwordx4 v[108:111], v2, s[4:7], s34 offen
    s_waitcnt vmcnt(8)
    s_barrier
    s_add_u32 s34, s24, 256
    buffer_load_dwordx4 v[112:115], v2, s[4:7], s34 offen
    s_add_u32 s34, s34, 131072
    s_waitcnt vmcnt(6)
    buffer_load_dwordx4 v[116:119], v2, s[4:7], s34 offen
    s_add_u32 s34, s34, 131072
    s_waitcnt vmcnt(6)
    buffer_load_dwordx4 v[120:123], v2, s[4:7], s34 offen
    s_add_u32 s34, s34, 131072
    s_waitcnt vmcnt(6)
    buffer_load_dwordx4 v[124:127], v2, s[4:7], s34 offen
    s_waitcnt vmcnt(6)
    s_add_u32 s34, s24, 384
    buffer_load_dwordx4 v[128:131], v2, s[4:7], s34 offen
    s_add_u32 s34, s34, 131072
    s_waitcnt vmcnt(6)
    buffer_load_dwordx4 v[132:135], v2, s[4:7], s34 offen
    s_add_u32 s34, s34, 131072
    s_waitcnt vmcnt(6)
    buffer_load_dwordx4 v[136:139], v2, s[4:7], s34 offen
    s_add_u32 s34, s34, 131072
    s_waitcnt vmcnt(6)
    buffer_load_dwordx4 v[140:143], v2, s[4:7], s34 offen
    s_waitcnt vmcnt(6)
    s_add_u32 s34, s24, 512
    buffer_load_dwordx4 v[240:243], v2, s[4:7], s34 offen
    s_add_u32 s34, s34, 131072
    s_waitcnt vmcnt(6)
    buffer_load_dwordx4 v[244:247], v2, s[4:7], s34 offen
    s_add_u32 s34, s34, 131072
    s_waitcnt vmcnt(6)
    buffer_load_dwordx4 v[248:251], v2, s[4:7], s34 offen
    s_add_u32 s34, s34, 131072
    s_waitcnt vmcnt(6)
    buffer_load_dwordx4 v[252:255], v2, s[4:7], s34 offen
    s_waitcnt vmcnt(6)
    s_waitcnt vmcnt(0)
    s_lshl_b32 s23, s30, 3
    v_and_b32 v8, 7, v1
    v_add_u32 v8, s23, v8
    s_xor_b32 s23, s23, 15
    v_mov_b32 v9, s23
    v_cmp_gt_u32 vcc, 8, v1
    s_nop 1
    v_cndmask_b32 v8, v9, v8, vcc
    v_lshlrev_b32 v8, 7, v8
    s_lshl_b32 s25, s20, 11
    s_add_u32 s25, s25, 0x1680000
    v_lshrrev_b32 v19, 3, v1
    v_lshlrev_b32 v19, 12, v19
    v_and_b32 v9, 7, v1
    v_lshl_add_u32 v19, v9, 7, v19
    s_lshl_b32 s26, s20, 2
    s_add_u32 s26, s26, s17
    s_lshl_b32 s26, s26, 1
    s_add_u32 s26, s26, s30
    s_lshl_b32 s26, s26, 16
    s_and_b32 s23, s19, 3
    s_lshl_b32 s23, s23, 10
    s_add_u32 s26, s26, s23
    v_lshlrev_b32 v22, 2, v1
    v_add_u32 v22, 135168, v22
    s_barrier
    ds_write_b32 v22, v70
    ds_write_b128 v14, v[80:83] offset:0
    ds_write_b128 v14, v[84:87] offset:4096
    ds_write_b128 v14, v[88:91] offset:8192
    ds_write_b128 v14, v[92:95] offset:12288
    ds_write_b128 v14, v[96:99] offset:16384
    ds_write_b128 v14, v[100:103] offset:20480
    ds_write_b128 v14, v[104:107] offset:24576
    ds_write_b128 v14, v[108:111] offset:28672
    s_cmp_lg_u32 s16, 4
    s_cbranch_scc1 L_zp5
L_poll6:
    buffer_load_dword v9, v8, s[12:15], s25 offen sc1
    s_add_u32 s33, s33, 1
    s_waitcnt vmcnt(0)
    v_cmp_ne_u32 vcc, s28, v9
    s_cmp_gt_u32 s33, 262144
    s_cbranch_scc1 L_poll6_d
    s_cbranch_vccz L_poll6_d
    s_sleep 4
    s_branch L_poll6
L_poll6_d:
L_zp5:
    s_waitcnt lgkmcnt(8)
    s_barrier
    ds_write_b128 v14, v[112:115] offset:32768
    ds_write_b128 v14, v[116:119] offset:36864
    ds_write_b128 v14, v[120:123] offset:40960
    ds_write_b128 v14, v[124:127] offset:45056
    ds_write_b128 v14, v[128:131] offset:49152
    ds_write_b128 v14, v[132:135] offset:53248
    ds_write_b128 v14, v[136:139] offset:57344
    ds_write_b128 v14, v[140:143] offset:61440
    ds_write_b128 v15, v[240:243] offset:0
    ds_write_b128 v15, v[244:247] offset:4096
    ds_write_b128 v15, v[248:251] offset:8192
    ds_write_b128 v15, v[252:255] offset:12288
    s_add_u32 s34, s24, 640
    s_add_u32 m0, s27, 81920
    s_nop 0
    buffer_load_dwordx4 v2, s[4:7], s34 offen lds
    s_add_u32 s34, s34, 131072
    s_add_u32 m0, s27, 86016
    s_nop 0
    buffer_load_dwordx4 v2, s[4:7], s34 offen lds
    s_add_u32 s34, s34, 131072
    s_add_u32 m0, s27, 90112
    s_nop 0
    buffer_load_dwordx4 v2, s[4:7], s34 offen lds
    s_add_u32 s34, s34, 131072
    s_add_u32 m0, s27, 94208
    s_nop 0
    buffer_load_dwordx4 v2, s[4:7], s34 offen lds
    s_add_u32 s34, s24, 768
    s_add_u32 m0, s27, 98304
    s_nop 0
    buffer_load_dwordx4 v2, s[4:7], s34 offen lds
    s_add_u32 s34, s34, 131072
    s_add_u32 m0, s27, 102400
    s_nop 0
    buffer_load_dwordx4 v2, s[4:7], s34 offen lds
    s_add_u32 s34, s34, 131072
    s_add_u32 m0, s27, 106496
    s_nop 0
    buffer_load_dwordx4 v2, s[4:7], s34 offen lds
    s_add_u32 s34, s34, 131072
    s_add_u32 m0, s27, 110592
    s_nop 0
    buffer_load_dwordx4 v2, s[4:7], s34 offen lds
    s_add_u32 s34, s24, 896
    s_add_u32 m0, s27, 114688
    s_nop 0
    buffer_load_dwordx4 v2, s[4:7], s34 offen lds
    s_add_u32 s34, s34, 131072
    s_add_u32 m0, s27, 118784
    s_nop 0
    buffer_load_dwordx4 v2, s[4:7], s34 offen lds
    s_add_u32 s34, s34, 131072
    s_add_u32 m0, s27, 122880
    s_nop 0
    buffer_load_dwordx4 v2, s[4:7], s34 offen lds
    s_add_u32 s34, s34, 131072
    s_add_u32 m0, s27, 126976
    s_nop 0
    buffer_load_dwordx4 v2, s[4:7], s34 offen lds
    s_branch L_sp_help
L_p1_comp:
    s_cmp_lg_u32 s16, 0
    s_cbranch_scc1 L_nopf
    s_getpc_b64 s[60:61]
L_pc0:
    s_sub_u32 s60, s60, L_pc0-gated_mix__linear_attn_block__mixer_gmlp__prompt_kernel
    s_subb_u32 s61, s61, 0
    v_and_b32 v3, 31, v0
    v_lshlrev_b32 v3, 12, v3
    s_lshl_b32 s23, s29, 7
    v_add_u32 v3, s23, v3
    v_cmp_gt_u32 vcc, L_codeend-gated_mix__linear_attn_block__mixer_gmlp__prompt_kernel, v3
    s_mov_b32 exec_lo, vcc_lo
    s_mov_b32 exec_hi, 0
    global_load_dword v7, v3, s[60:61]
    s_mov_b64 exec, -1
L_nopf:
    v_and_b32 v4, 15, v1
    v_lshrrev_b32 v5, 4, v1
    v_bfe_u32 v8, v1, 1, 3
    v_xor_b32 v8, v8, v5
    v_lshlrev_b32 v8, 4, v8
    v_lshl_add_u32 v8, v4, 7, v8
    s_lshl_b32 s23, s17, 12
    v_add_u32 v8, s23, v8
    v_xor_b32 v9, 64, v8
    v_bfe_u32 v4, v1, 2, 2
    v_lshl_add_u32 v10, v5, 3, v4
    v_lshlrev_b32 v10, 7, v10
    v_bfe_u32 v4, v1, 3, 1
    v_lshl_add_u32 v10, v4, 6, v10
    v_and_b32 v4, 1, v5
    v_lshl_add_u32 v10, v4, 5, v10
    v_and_b32 v4, 3, v1
    v_lshl_add_u32 v10, v4, 3, v10
    v_add_u32 v10, 16384, v10
    v_xor_b32 v11, 32, v10
    v_xor_b32 v12, 64, v10
    v_xor_b32 v13, 96, v10
    v_lshlrev_b32 v2, 4, v1
    v_mov_b32 v16, 0xbdd2d3e8
    v_mov_b32 v17, 0xbdd2d3e8
    v_mov_b32 v18, 0xc0135761
    v_mov_b32 v19, 0xc0135761
    v_mov_b32 v20, 0x3fb8aa3b
    v_mov_b32 v21, 0x3fb8aa3b
    v_mov_b32 v22, 0x358637bd
    v_mov_b32 v23, 0x358637bd
    s_waitcnt lgkmcnt(0)
    s_mov_b32 s12, s58
    s_mov_b32 s13, s59
    s_mov_b32 s14, 0x1800000
    s_mov_b32 s15, 0x20000
    s_add_u32 s60, s58, 0x16f0000
    s_addc_u32 s61, s59, 0
    s_load_dword s28, s[60:61], 0
    s_waitcnt lgkmcnt(0)
    s_add_u32 s28, s28, 0x9e3779b9
    s_cmp_ge_u32 s31, 4
    s_cbranch_scc1 L_cq
    v_and_b32 v242, 15, v1
    v_lshlrev_b32 v242, 4, v242
    v_lshrrev_b32 v240, 5, v1
    v_lshl_add_u32 v242, v240, 8, v242
    v_bfe_u32 v240, v1, 4, 1
    v_lshl_add_u32 v240, v240, 11, v242
    v_add_u32 v241, 4096, v242
    v_and_b32 v244, 15, v1
    v_bfe_u32 v245, v1, 1, 1
    v_lshlrev_b32 v245, 2, v245
    v_bfe_u32 v246, v1, 2, 1
    v_lshl_add_u32 v245, v246, 1, v245
    v_and_b32 v246, 1, v1
    v_add_u32 v245, v245, v246
    v_lshrrev_b32 v246, 4, v1
    v_xor_b32 v245, v245, v246
    v_lshlrev_b32 v245, 4, v245
    v_lshl_add_u32 v244, v244, 7, v245
    s_lshr_b32 s25, s17, 1
    s_lshl_b32 s25, s25, 15
    s_and_b32 s26, s17, 1
    s_lshl_b32 s26, s26, 12
    s_add_u32 s25, s25, s26
    s_add_u32 s25, s25, 57344
    v_add_u32 v244, s25, v244
    v_xor_b32 v245, 64, v244
    v_lshrrev_b32 v248, 4, v1
    v_bfe_u32 v249, v1, 2, 2
    v_lshl_add_u32 v248, v248, 3, v249
    v_lshlrev_b32 v248, 7, v248
    v_bfe_u32 v249, v1, 2, 1
    v_and_b32 v250, 3, v1
    v_xor_b32 v249, v249, v250
    v_lshl_add_u32 v248, v249, 4, v248
    v_bfe_u32 v249, v1, 3, 1
    v_lshl_add_u32 v248, v249, 6, v248
    v_add_u32 v248, s25, v248
    v_xor_b32 v249, 32, v248
    v_xor_b32 v250, 64, v248
    v_xor_b32 v251, 96, v248
    s_lshl_b32 s25, s20, 9
    s_lshl_b32 s26, s19, 3
    s_add_u32 s25, s25, s26
    s_lshl_b32 s26, s17, 1
    s_add_u32 s25, s25, s26
    s_lshl_b32 s25, s25, 10
    s_barrier
    ds_read_b128 v[96:99], v8 offset:0
    ds_read_b128 v[100:103], v8 offset:2048
    ds_read_b64_tr_b16 v[40:41], v10 offset:0
    ds_read_b64_tr_b16 v[42:43], v10 offset:512
    ds_read_b64_tr_b16 v[44:45], v11 offset:0
    ds_read_b64_tr_b16 v[46:47], v11 offset:512
    ds_read_b64_tr_b16 v[48:49], v12 offset:0
    ds_read_b64_tr_b16 v[50:51], v12 offset:512
    ds_read_b64_tr_b16 v[52:53], v13 offset:0
    ds_read_b64_tr_b16 v[54:55], v13 offset:512
    s_waitcnt lgkmcnt(4)
    v_mfma_f32_16x16x32_bf16 v[128:131], v[40:43], v[96:99], 0
    ds_read_b64_tr_b16 v[56:57], v10 offset:8192
    v_mfma_f32_16x16x32_bf16 v[136:139], v[40:43], v[100:103], 0
    ds_read_b64_tr_b16 v[58:59], v10 offset:8704
    v_mfma_f32_16x16x32_bf16 v[132:135], v[44:47], v[96:99], 0
    ds_read_b64_tr_b16 v[60:61], v11 offset:8192
    v_mfma_f32_16x16x32_bf16 v[140:143], v[44:47], v[100:103], 0
    ds_read_b64_tr_b16 v[62:63], v11 offset:8704
    s_waitcnt lgkmcnt(4)
    v_mfma_f32_16x16x32_bf16 v[144:147], v[48:51], v[96:99], 0
    ds_read_b64_tr_b16 v[40:41], v12 offset:8192
    v_mfma_f32_16x16x32_bf16 v[152:155], v[48:51], v[100:103], 0
    ds_read_b64_tr_b16 v[42:43], v12 offset:8704
    v_mfma_f32_16x16x32_bf16 v[148:151], v[52:55], v[96:99], 0
    ds_read_b64_tr_b16 v[44:45], v13 offset:8192
    v_mfma_f32_16x16x32_bf16 v[156:159], v[52:55], v[100:103], 0
    ds_read_b64_tr_b16 v[46:47], v13 offset:8704
    s_waitcnt lgkmcnt(4)
    v_mfma_f32_16x16x32_bf16 v[160:163], v[56:59], v[96:99], 0
    ds_read_b64_tr_b16 v[48:49], v10 offset:4096
    v_mfma_f32_16x16x32_bf16 v[168:171], v[56:59], v[100:103], 0
    ds_read_b64_tr_b16 v[50:51], v10 offset:4608
    ds_read_b128 v[104:107], v9 offset:0
    v_mfma_f32_16x16x32_bf16 v[164:167], v[60:63], v[96:99], 0
    ds_read_b64_tr_b16 v[52:53], v11 offset:4096
    v_mfma_f32_16x16x32_bf16 v[172:175], v[60:63], v[100:103], 0
    ds_read_b64_tr_b16 v[54:55], v11 offset:4608
    ds_read_b128 v[108:111], v9 offset:2048
    s_waitcnt lgkmcnt(6)
    v_mfma_f32_16x16x32_bf16 v[176:179], v[40:43], v[96:99], 0
    ds_read_b64_tr_b16 v[56:57], v12 offset:4096
    v_mfma_f32_16x16x32_bf16 v[184:187], v[40:43], v[100:103], 0
    ds_read_b64_tr_b16 v[58:59], v12 offset:4608
    v_mfma_f32_16x16x32_bf16 v[180:183], v[44:47], v[96:99], 0
    ds_read_b64_tr_b16 v[60:61], v13 offset:4096
    v_mfma_f32_16x16x32_bf16 v[188:191], v[44:47], v[100:103], 0
    ds_read_b64_tr_b16 v[62:63], v13 offset:4608
    s_waitcnt lgkmcnt(4)
    v_mfma_f32_16x16x32_bf16 v[128:131], v[48:51], v[104:107], v[128:131]
    ds_read_b64_tr_b16 v[40:41], v10 offset:12288
    v_mfma_f32_16x16x32_bf16 v[136:139], v[48:51], v[108:111], v[136:139]
    ds_read_b64_tr_b16 v[42:43], v10 offset:12800
    v_mfma_f32_16x16x32_bf16 v[132:135], v[52:55], v[104:107], v[132:135]
    ds_read_b64_tr_b16 v[44:45], v11 offset:12288
    v_mfma_f32_16x16x32_bf16 v[140:143], v[52:55], v[108:111], v[140:143]
    ds_read_b64_tr_b16 v[46:47], v11 offset:12800
    s_waitcnt lgkmcnt(4)
    v_mfma_f32_16x16x32_bf16 v[144:147], v[56:59], v[104:107], v[144:147]
    ds_read_b64_tr_b16 v[48:49], v12 offset:12288
    v_mfma_f32_16x16x32_bf16 v[152:155], v[56:59], v[108:111], v[152:155]
    ds_read_b64_tr_b16 v[50:51], v12 offset:12800
    v_mfma_f32_16x16x32_bf16 v[148:151], v[60:63], v[104:107], v[148:151]
    ds_read_b64_tr_b16 v[52:53], v13 offset:12288
    v_mfma_f32_16x16x32_bf16 v[156:159], v[60:63], v[108:111], v[156:159]
    ds_read_b64_tr_b16 v[54:55], v13 offset:12800
    s_waitcnt lgkmcnt(4)
    v_mfma_f32_16x16x32_bf16 v[160:163], v[40:43], v[104:107], v[160:163]
    s_barrier
    v_add_u32 v10, 32768, v10
    ds_read_b64_tr_b16 v[56:57], v10 offset:0
    v_mfma_f32_16x16x32_bf16 v[168:171], v[40:43], v[108:111], v[168:171]
    ds_read_b64_tr_b16 v[58:59], v10 offset:512
    v_add_u32 v8, 32768, v8
    ds_read_b128 v[112:115], v8 offset:0
    v_mfma_f32_16x16x32_bf16 v[164:167], v[44:47], v[104:107], v[164:167]
    v_add_u32 v11, 32768, v11
    ds_read_b64_tr_b16 v[60:61], v11 offset:0
    v_mfma_f32_16x16x32_bf16 v[172:175], v[44:47], v[108:111], v[172:175]
    ds_read_b64_tr_b16 v[62:63], v11 offset:512
    ds_read_b128 v[116:119], v8 offset:2048
    s_waitcnt lgkmcnt(6)
    v_mfma_f32_16x16x32_bf16 v[176:179], v[48:51], v[104:107], v[176:179]
    v_add_u32 v12, 32768, v12
    ds_read_b64_tr_b16 v[40:41], v12 offset:0
    v_mfma_f32_16x16x32_bf16 v[184:187], v[48:51], v[108:111], v[184:187]
    ds_read_b64_tr_b16 v[42:43], v12 offset:512
    v_mfma_f32_16x16x32_bf16 v[180:183], v[52:55], v[104:107], v[180:183]
    v_add_u32 v13, 32768, v13
    ds_read_b64_tr_b16 v[44:45], v13 offset:0
    v_mfma_f32_16x16x32_bf16 v[188:191], v[52:55], v[108:111], v[188:191]
    ds_read_b64_tr_b16 v[46:47], v13 offset:512
    s_waitcnt lgkmcnt(4)
    v_mfma_f32_16x16x32_bf16 v[128:131], v[56:59], v[112:115], v[128:131]
    ds_read_b64_tr_b16 v[48:49], v10 offset:8192
    v_mfma_f32_16x16x32_bf16 v[136:139], v[56:59], v[116:119], v[136:139]
    ds_read_b64_tr_b16 v[50:51], v10 offset:8704
    v_mfma_f32_16x16x32_bf16 v[132:135], v[60:63], v[112:115], v[132:135]
    ds_read_b64_tr_b16 v[52:53], v11 offset:8192
    v_mfma_f32_16x16x32_bf16 v[140:143], v[60:63], v[116:119], v[140:143]
    ds_read_b64_tr_b16 v[54:55], v11 offset:8704
    s_waitcnt lgkmcnt(4)
    v_mfma_f32_16x16x32_bf16 v[144:147], v[40:43], v[112:115], v[144:147]
    ds_read_b64_tr_b16 v[56:57], v12 offset:8192
    v_mfma_f32_16x16x32_bf16 v[152:155], v[40:43], v[116:119], v[152:155]
    ds_read_b64_tr_b16 v[58:59], v12 offset:8704
    v_mfma_f32_16x16x32_bf16 v[148:151], v[44:47], v[112:115], v[148:151]
    ds_read_b64_tr_b16 v[60:61], v13 offset:8192
    v_mfma_f32_16x16x32_bf16 v[156:159], v[44:47], v[116:119], v[156:159]
    ds_read_b64_tr_b16 v[62:63], v13 offset:8704
    s_waitcnt lgkmcnt(4)
    v_mfma_f32_16x16x32_bf16 v[160:163], v[48:51], v[112:115], v[160:163]
    ds_read_b64_tr_b16 v[40:41], v10 offset:4096
    v_mfma_f32_16x16x32_bf16 v[168:171], v[48:51], v[116:119], v[168:171]
    ds_read_b64_tr_b16 v[42:43], v10 offset:4608
    v_add_u32 v9, 32768, v9
    ds_read_b128 v[120:123], v9 offset:0
    v_mfma_f32_16x16x32_bf16 v[164:167], v[52:55], v[112:115], v[164:167]
    ds_read_b64_tr_b16 v[44:45], v11 offset:4096
    v_mfma_f32_16x16x32_bf16 v[172:175], v[52:55], v[116:119], v[172:175]
    ds_read_b64_tr_b16 v[46:47], v11 offset:4608
    ds_read_b128 v[124:127], v9 offset:2048
    s_waitcnt lgkmcnt(6)
    v_mfma_f32_16x16x32_bf16 v[176:179], v[56:59], v[112:115], v[176:179]
    ds_read_b64_tr_b16 v[48:49], v12 offset:4096
    v_mfma_f32_16x16x32_bf16 v[184:187], v[56:59], v[116:119], v[184:187]
    ds_read_b64_tr_b16 v[50:51], v12 offset:4608
    v_mfma_f32_16x16x32_bf16 v[180:183], v[60:63], v[112:115], v[180:183]
    ds_read_b64_tr_b16 v[52:53], v13 offset:4096
    v_mfma_f32_16x16x32_bf16 v[188:191], v[60:63], v[116:119], v[188:191]
    ds_read_b64_tr_b16 v[54:55], v13 offset:4608
    s_waitcnt lgkmcnt(4)
    v_mfma_f32_16x16x32_bf16 v[128:131], v[40:43], v[120:123], v[128:131]
    ds_read_b64_tr_b16 v[56:57], v10 offset:12288
    v_mfma_f32_16x16x32_bf16 v[136:139], v[40:43], v[124:127], v[136:139]
    ds_read_b64_tr_b16 v[58:59], v10 offset:12800
    v_mfma_f32_16x16x32_bf16 v[132:135], v[44:47], v[120:123], v[132:135]
    ds_read_b64_tr_b16 v[60:61], v11 offset:12288
    v_mfma_f32_16x16x32_bf16 v[140:143], v[44:47], v[124:127], v[140:143]
    ds_read_b64_tr_b16 v[62:63], v11 offset:12800
    s_waitcnt lgkmcnt(4)
    v_mfma_f32_16x16x32_bf16 v[144:147], v[48:51], v[120:123], v[144:147]
    ds_read_b64_tr_b16 v[40:41], v12 offset:12288
    v_mfma_f32_16x16x32_bf16 v[152:155], v[48:51], v[124:127], v[152:155]
    ds_read_b64_tr_b16 v[42:43], v12 offset:12800
    v_mfma_f32_16x16x32_bf16 v[148:151], v[52:55], v[120:123], v[148:151]
    ds_read_b64_tr_b16 v[44:45], v13 offset:12288
    v_mfma_f32_16x16x32_bf16 v[156:159], v[52:55], v[124:127], v[156:159]
    ds_read_b64_tr_b16 v[46:47], v13 offset:12800
    s_waitcnt lgkmcnt(4)
    v_mfma_f32_16x16x32_bf16 v[160:163], v[56:59], v[120:123], v[160:163]
    s_barrier
    v_add_u32 v10, 32768, v10
    ds_read_b64_tr_b16 v[48:49], v10 offset:0
    v_mfma_f32_16x16x32_bf16 v[168:171], v[56:59], v[124:127], v[168:171]
    ds_read_b64_tr_b16 v[50:51], v10 offset:512
    v_add_u32 v8, 32768, v8
    ds_read_b128 v[224:227], v8 offset:0
    v_mfma_f32_16x16x32_bf16 v[164:167], v[60:63], v[120:123], v[164:167]
    v_add_u32 v11, 32768, v11
    ds_read_b64_tr_b16 v[52:53], v11 offset:0
    v_mfma_f32_16x16x32_bf16 v[172:175], v[60:63], v[124:127], v[172:175]
    ds_read_b64_tr_b16 v[54:55], v11 offset:512
    ds_read_b128 v[228:231], v8 offset:2048
    s_waitcnt lgkmcnt(6)
    v_mfma_f32_16x16x32_bf16 v[176:179], v[40:43], v[120:123], v[176:179]
    v_add_u32 v12, 32768, v12
    ds_read_b64_tr_b16 v[56:57], v12 offset:0
    v_mfma_f32_16x16x32_bf16 v[184:187], v[40:43], v[124:127], v[184:187]
    ds_read_b64_tr_b16 v[58:59], v12 offset:512
    v_mfma_f32_16x16x32_bf16 v[180:183], v[44:47], v[120:123], v[180:183]
    v_add_u32 v13, 32768, v13
    ds_read_b64_tr_b16 v[60:61], v13 offset:0
    v_mfma_f32_16x16x32_bf16 v[188:191], v[44:47], v[124:127], v[188:191]
    ds_read_b64_tr_b16 v[62:63], v13 offset:512
    s_waitcnt lgkmcnt(4)
    v_mfma_f32_16x16x32_bf16 v[128:131], v[48:51], v[224:227], v[128:131]
    ds_read_b64_tr_b16 v[40:41], v10 offset:8192
    v_mfma_f32_16x16x32_bf16 v[136:139], v[48:51], v[228:231], v[136:139]
    ds_read_b64_tr_b16 v[42:43], v10 offset:8704
    v_mfma_f32_16x16x32_bf16 v[132:135], v[52:55], v[224:227], v[132:135]
    ds_read_b64_tr_b16 v[44:45], v11 offset:8192
    v_mfma_f32_16x16x32_bf16 v[140:143], v[52:55], v[228:231], v[140:143]
    ds_read_b64_tr_b16 v[46:47], v11 offset:8704
    s_waitcnt lgkmcnt(4)
    v_mfma_f32_16x16x32_bf16 v[144:147], v[56:59], v[224:227], v[144:147]
    ds_read_b64_tr_b16 v[48:49], v12 offset:8192
    v_mfma_f32_16x16x32_bf16 v[152:155], v[56:59], v[228:231], v[152:155]
    ds_read_b64_tr_b16 v[50:51], v12 offset:8704
    v_mfma_f32_16x16x32_bf16 v[148:151], v[60:63], v[224:227], v[148:151]
    ds_read_b64_tr_b16 v[52:53], v13 offset:8192
    v_mfma_f32_16x16x32_bf16 v[156:159], v[60:63], v[228:231], v[156:159]
    ds_read_b64_tr_b16 v[54:55], v13 offset:8704
    s_waitcnt lgkmcnt(4)
    v_mfma_f32_16x16x32_bf16 v[160:163], v[40:43], v[224:227], v[160:163]
    ds_read_b64_tr_b16 v[56:57], v10 offset:4096
    v_mfma_f32_16x16x32_bf16 v[168:171], v[40:43], v[228:231], v[168:171]
    ds_read_b64_tr_b16 v[58:59], v10 offset:4608
    v_add_u32 v9, 32768, v9
    ds_read_b128 v[232:235], v9 offset:0
    v_mfma_f32_16x16x32_bf16 v[164:167], v[44:47], v[224:227], v[164:167]
    ds_read_b64_tr_b16 v[60:61], v11 offset:4096
    v_mfma_f32_16x16x32_bf16 v[172:175], v[44:47], v[228:231], v[172:175]
    ds_read_b64_tr_b16 v[62:63], v11 offset:4608
    ds_read_b128 v[236:239], v9 offset:2048
    s_waitcnt lgkmcnt(6)
    v_mfma_f32_16x16x32_bf16 v[176:179], v[48:51], v[224:227], v[176:179]
    ds_read_b64_tr_b16 v[40:41], v12 offset:4096
    v_mfma_f32_16x16x32_bf16 v[184:187], v[48:51], v[228:231], v[184:187]
    ds_read_b64_tr_b16 v[42:43], v12 offset:4608
    v_mfma_f32_16x16x32_bf16 v[180:183], v[52:55], v[224:227], v[180:183]
    ds_read_b64_tr_b16 v[44:45], v13 offset:4096
    v_mfma_f32_16x16x32_bf16 v[188:191], v[52:55], v[228:231], v[188:191]
    ds_read_b64_tr_b16 v[46:47], v13 offset:4608
    s_waitcnt lgkmcnt(4)
    v_mfma_f32_16x16x32_bf16 v[128:131], v[56:59], v[232:235], v[128:131]
    ds_read_b64_tr_b16 v[48:49], v10 offset:12288
    v_mfma_f32_16x16x32_bf16 v[136:139], v[56:59], v[236:239], v[136:139]
    ds_read_b64_tr_b16 v[50:51], v10 offset:12800
    v_mfma_f32_16x16x32_bf16 v[132:135], v[60:63], v[232:235], v[132:135]
    ds_read_b64_tr_b16 v[52:53], v11 offset:12288
    v_mfma_f32_16x16x32_bf16 v[140:143], v[60:63], v[236:239], v[140:143]
    ds_read_b64_tr_b16 v[54:55], v11 offset:12800
    s_waitcnt lgkmcnt(4)
    v_mfma_f32_16x16x32_bf16 v[144:147], v[40:43], v[232:235], v[144:147]
    ds_read_b64_tr_b16 v[56:57], v12 offset:12288
    v_mfma_f32_16x16x32_bf16 v[152:155], v[40:43], v[236:239], v[152:155]
    ds_read_b64_tr_b16 v[58:59], v12 offset:12800
    v_mfma_f32_16x16x32_bf16 v[148:151], v[44:47], v[232:235], v[148:151]
    ds_read_b64_tr_b16 v[60:61], v13 offset:12288
    v_mfma_f32_16x16x32_bf16 v[156:159], v[44:47], v[236:239], v[156:159]
    ds_read_b64_tr_b16 v[62:63], v13 offset:12800
    s_waitcnt lgkmcnt(4)
    v_mfma_f32_16x16x32_bf16 v[160:163], v[48:51], v[232:235], v[160:163]
    s_barrier
    v_add_u32 v10, 32768, v10
    ds_read_b64_tr_b16 v[40:41], v10 offset:0
    v_mfma_f32_16x16x32_bf16 v[168:171], v[48:51], v[236:239], v[168:171]
    ds_read_b64_tr_b16 v[42:43], v10 offset:512
    v_add_u32 v8, 32768, v8
    ds_read_b128 v[24:27], v8 offset:0
    v_mfma_f32_16x16x32_bf16 v[164:167], v[52:55], v[232:235], v[164:167]
    v_add_u32 v11, 32768, v11
    ds_read_b64_tr_b16 v[44:45], v11 offset:0
    v_mfma_f32_16x16x32_bf16 v[172:175], v[52:55], v[236:239], v[172:175]
    ds_read_b64_tr_b16 v[46:47], v11 offset:512
    ds_read_b128 v[28:31], v8 offset:2048
    s_waitcnt lgkmcnt(6)
    v_mfma_f32_16x16x32_bf16 v[176:179], v[56:59], v[232:235], v[176:179]
    v_add_u32 v12, 32768, v12
    ds_read_b64_tr_b16 v[48:49], v12 offset:0
    v_mfma_f32_16x16x32_bf16 v[184:187], v[56:59], v[236:239], v[184:187]
    ds_read_b64_tr_b16 v[50:51], v12 offset:512
    v_mfma_f32_16x16x32_bf16 v[180:183], v[60:63], v[232:235], v[180:183]
    v_add_u32 v13, 32768, v13
    ds_read_b64_tr_b16 v[52:53], v13 offset:0
    v_mfma_f32_16x16x32_bf16 v[188:191], v[60:63], v[236:239], v[188:191]
    ds_read_b64_tr_b16 v[54:55], v13 offset:512
    s_waitcnt lgkmcnt(4)
    v_mfma_f32_16x16x32_bf16 v[128:131], v[40:43], v[24:27], v[128:131]
    ds_read_b64_tr_b16 v[56:57], v10 offset:8192
    v_mfma_f32_16x16x32_bf16 v[136:139], v[40:43], v[28:31], v[136:139]
    ds_read_b64_tr_b16 v[58:59], v10 offset:8704
    v_mfma_f32_16x16x32_bf16 v[132:135], v[44:47], v[24:27], v[132:135]
    ds_read_b64_tr_b16 v[60:61], v11 offset:8192
    v_mfma_f32_16x16x32_bf16 v[140:143], v[44:47], v[28:31], v[140:143]
    ds_read_b64_tr_b16 v[62:63], v11 offset:8704
    s_waitcnt lgkmcnt(4)
    v_mfma_f32_16x16x32_bf16 v[144:147], v[48:51], v[24:27], v[144:147]
    ds_read_b64_tr_b16 v[40:41], v12 offset:8192
    v_mfma_f32_16x16x32_bf16 v[152:155], v[48:51], v[28:31], v[152:155]
    ds_read_b64_tr_b16 v[42:43], v12 offset:8704
    v_mfma_f32_16x16x32_bf16 v[148:151], v[52:55], v[24:27], v[148:151]
    ds_read_b64_tr_b16 v[44:45], v13 offset:8192
    v_mfma_f32_16x16x32_bf16 v[156:159], v[52:55], v[28:31], v[156:159]
    ds_read_b64_tr_b16 v[46:47], v13 offset:8704
    s_waitcnt lgkmcnt(4)
    v_mfma_f32_16x16x32_bf16 v[160:163], v[56:59], v[24:27], v[160:163]
    ds_read_b64_tr_b16 v[48:49], v10 offset:4096
    v_mfma_f32_16x16x32_bf16 v[168:171], v[56:59], v[28:31], v[168:171]
    ds_read_b64_tr_b16 v[50:51], v10 offset:4608
    v_add_u32 v9, 32768, v9
    ds_read_b128 v[32:35], v9 offset:0
    v_mfma_f32_16x16x32_bf16 v[164:167], v[60:63], v[24:27], v[164:167]
    ds_read_b64_tr_b16 v[52:53], v11 offset:4096
    v_mfma_f32_16x16x32_bf16 v[172:175], v[60:63], v[28:31], v[172:175]
    ds_read_b64_tr_b16 v[54:55], v11 offset:4608
    ds_read_b128 v[36:39], v9 offset:2048
    s_waitcnt lgkmcnt(6)
    v_mfma_f32_16x16x32_bf16 v[176:179], v[40:43], v[24:27], v[176:179]
    ds_read_b64_tr_b16 v[56:57], v12 offset:4096
    v_mfma_f32_16x16x32_bf16 v[184:187], v[40:43], v[28:31], v[184:187]
    ds_read_b64_tr_b16 v[58:59], v12 offset:4608
    v_mfma_f32_16x16x32_bf16 v[180:183], v[44:47], v[24:27], v[180:183]
    ds_read_b64_tr_b16 v[60:61], v13 offset:4096
    v_mfma_f32_16x16x32_bf16 v[188:191], v[44:47], v[28:31], v[188:191]
    ds_read_b64_tr_b16 v[62:63], v13 offset:4608
    s_waitcnt lgkmcnt(4)
    v_mfma_f32_16x16x32_bf16 v[128:131], v[48:51], v[32:35], v[128:131]
    ds_read_b64_tr_b16 v[40:41], v10 offset:12288
    v_mfma_f32_16x16x32_bf16 v[136:139], v[48:51], v[36:39], v[136:139]
    ds_read_b64_tr_b16 v[42:43], v10 offset:12800
    v_mfma_f32_16x16x32_bf16 v[132:135], v[52:55], v[32:35], v[132:135]
    ds_read_b64_tr_b16 v[44:45], v11 offset:12288
    v_mfma_f32_16x16x32_bf16 v[140:143], v[52:55], v[36:39], v[140:143]
    ds_read_b64_tr_b16 v[46:47], v11 offset:12800
    s_waitcnt lgkmcnt(4)
    v_mfma_f32_16x16x32_bf16 v[144:147], v[56:59], v[32:35], v[144:147]
    ds_read_b64_tr_b16 v[48:49], v12 offset:12288
    v_mfma_f32_16x16x32_bf16 v[152:155], v[56:59], v[36:39], v[152:155]
    ds_read_b64_tr_b16 v[50:51], v12 offset:12800
    v_mfma_f32_16x16x32_bf16 v[148:151], v[60:63], v[32:35], v[148:151]
    ds_read_b64_tr_b16 v[52:53], v13 offset:12288
    v_mfma_f32_16x16x32_bf16 v[156:159], v[60:63], v[36:39], v[156:159]
    ds_read_b64_tr_b16 v[54:55], v13 offset:12800
    s_waitcnt lgkmcnt(4)
    v_mfma_f32_16x16x32_bf16 v[160:163], v[40:43], v[32:35], v[160:163]
    s_barrier
    v_add_u32 v10, 32768, v10
    ds_read_b64_tr_b16 v[56:57], v10 offset:0
    v_mfma_f32_16x16x32_bf16 v[168:171], v[40:43], v[36:39], v[168:171]
    ds_read_b64_tr_b16 v[58:59], v10 offset:512
    v_add_u32 v8, 32768, v8
    ds_read_b128 v[24:27], v8 offset:0
    v_mfma_f32_16x16x32_bf16 v[164:167], v[44:47], v[32:35], v[164:167]
    v_add_u32 v11, 32768, v11
    ds_read_b64_tr_b16 v[60:61], v11 offset:0
    v_mfma_f32_16x16x32_bf16 v[172:175], v[44:47], v[36:39], v[172:175]
    ds_read_b64_tr_b16 v[62:63], v11 offset:512
    ds_read_b128 v[28:31], v8 offset:2048
    s_waitcnt lgkmcnt(6)
    v_mfma_f32_16x16x32_bf16 v[176:179], v[48:51], v[32:35], v[176:179]
    v_add_u32 v12, 32768, v12
    ds_read_b64_tr_b16 v[40:41], v12 offset:0
    v_mfma_f32_16x16x32_bf16 v[184:187], v[48:51], v[36:39], v[184:187]
    ds_read_b64_tr_b16 v[42:43], v12 offset:512
    v_mfma_f32_16x16x32_bf16 v[180:183], v[52:55], v[32:35], v[180:183]
    v_add_u32 v13, 32768, v13
    ds_read_b64_tr_b16 v[44:45], v13 offset:0
    v_mfma_f32_16x16x32_bf16 v[188:191], v[52:55], v[36:39], v[188:191]
    ds_read_b64_tr_b16 v[46:47], v13 offset:512
    s_waitcnt lgkmcnt(4)
    v_mfma_f32_16x16x32_bf16 v[128:131], v[56:59], v[24:27], v[128:131]
    ds_read_b64_tr_b16 v[48:49], v10 offset:8192
    v_mfma_f32_16x16x32_bf16 v[136:139], v[56:59], v[28:31], v[136:139]
    ds_read_b64_tr_b16 v[50:51], v10 offset:8704
    v_mfma_f32_16x16x32_bf16 v[132:135], v[60:63], v[24:27], v[132:135]
    ds_read_b64_tr_b16 v[52:53], v11 offset:8192
    v_mfma_f32_16x16x32_bf16 v[140:143], v[60:63], v[28:31], v[140:143]
    ds_read_b64_tr_b16 v[54:55], v11 offset:8704
    s_waitcnt lgkmcnt(4)
    v_mfma_f32_16x16x32_bf16 v[144:147], v[40:43], v[24:27], v[144:147]
    ds_read_b64_tr_b16 v[56:57], v12 offset:8192
    v_mfma_f32_16x16x32_bf16 v[152:155], v[40:43], v[28:31], v[152:155]
    ds_read_b64_tr_b16 v[58:59], v12 offset:8704
    v_mfma_f32_16x16x32_bf16 v[148:151], v[44:47], v[24:27], v[148:151]
    ds_read_b64_tr_b16 v[60:61], v13 offset:8192
    v_mfma_f32_16x16x32_bf16 v[156:159], v[44:47], v[28:31], v[156:159]
    ds_read_b64_tr_b16 v[62:63], v13 offset:8704
    s_waitcnt lgkmcnt(4)
    v_mfma_f32_16x16x32_bf16 v[160:163], v[48:51], v[24:27], v[160:163]
    ds_read_b64_tr_b16 v[40:41], v10 offset:4096
    v_mfma_f32_16x16x32_bf16 v[168:171], v[48:51], v[28:31], v[168:171]
    ds_read_b64_tr_b16 v[42:43], v10 offset:4608
    v_add_u32 v9, 32768, v9
    ds_read_b128 v[32:35], v9 offset:0
    v_mfma_f32_16x16x32_bf16 v[164:167], v[52:55], v[24:27], v[164:167]
    ds_read_b64_tr_b16 v[44:45], v11 offset:4096
    v_mfma_f32_16x16x32_bf16 v[172:175], v[52:55], v[28:31], v[172:175]
    ds_read_b64_tr_b16 v[46:47], v11 offset:4608
    ds_read_b128 v[36:39], v9 offset:2048
    s_waitcnt lgkmcnt(6)
    v_mfma_f32_16x16x32_bf16 v[176:179], v[56:59], v[24:27], v[176:179]
    ds_read_b64_tr_b16 v[48:49], v12 offset:4096
    v_mfma_f32_16x16x32_bf16 v[184:187], v[56:59], v[28:31], v[184:187]
    ds_read_b64_tr_b16 v[50:51], v12 offset:4608
    v_mfma_f32_16x16x32_bf16 v[180:183], v[60:63], v[24:27], v[180:183]
    ds_read_b64_tr_b16 v[52:53], v13 offset:4096
    v_mfma_f32_16x16x32_bf16 v[188:191], v[60:63], v[28:31], v[188:191]
    ds_read_b64_tr_b16 v[54:55], v13 offset:4608
    s_waitcnt lgkmcnt(4)
    v_mfma_f32_16x16x32_bf16 v[128:131], v[40:43], v[32:35], v[128:131]
    ds_read_b64_tr_b16 v[56:57], v10 offset:12288
    v_mfma_f32_16x16x32_bf16 v[136:139], v[40:43], v[36:39], v[136:139]
    ds_read_b64_tr_b16 v[58:59], v10 offset:12800
    v_mfma_f32_16x16x32_bf16 v[132:135], v[44:47], v[32:35], v[132:135]
    ds_read_b64_tr_b16 v[60:61], v11 offset:12288
    v_mfma_f32_16x16x32_bf16 v[140:143], v[44:47], v[36:39], v[140:143]
    ds_read_b64_tr_b16 v[62:63], v11 offset:12800
    s_waitcnt lgkmcnt(4)
    v_mfma_f32_16x16x32_bf16 v[144:147], v[48:51], v[32:35], v[144:147]
    ds_read_b64_tr_b16 v[40:41], v12 offset:12288
    v_mfma_f32_16x16x32_bf16 v[152:155], v[48:51], v[36:39], v[152:155]
    ds_read_b64_tr_b16 v[42:43], v12 offset:12800
    v_mfma_f32_16x16x32_bf16 v[148:151], v[52:55], v[32:35], v[148:151]
    ds_read_b64_tr_b16 v[44:45], v13 offset:12288
    v_mfma_f32_16x16x32_bf16 v[156:159], v[52:55], v[36:39], v[156:159]
    ds_read_b64_tr_b16 v[46:47], v13 offset:12800
    s_waitcnt lgkmcnt(4)
    v_mfma_f32_16x16x32_bf16 v[160:163], v[56:59], v[32:35], v[160:163]
    s_barrier
    v_add_u32 v10, -131072, v10
    ds_read_b64_tr_b16 v[48:49], v10 offset:0
    v_mfma_f32_16x16x32_bf16 v[168:171], v[56:59], v[36:39], v[168:171]
    ds_read_b64_tr_b16 v[50:51], v10 offset:512
    v_add_u32 v8, -131072, v8
    ds_read_b128 v[24:27], v8 offset:0
    v_mfma_f32_16x16x32_bf16 v[164:167], v[60:63], v[32:35], v[164:167]
    v_add_u32 v11, -131072, v11
    ds_read_b64_tr_b16 v[52:53], v11 offset:0
    v_mfma_f32_16x16x32_bf16 v[172:175], v[60:63], v[36:39], v[172:175]
    ds_read_b64_tr_b16 v[54:55], v11 offset:512
    ds_read_b128 v[28:31], v8 offset:2048
    s_waitcnt lgkmcnt(6)
    v_mfma_f32_16x16x32_bf16 v[176:179], v[40:43], v[32:35], v[176:179]
    v_add_u32 v12, -131072, v12
    ds_read_b64_tr_b16 v[56:57], v12 offset:0
    v_mfma_f32_16x16x32_bf16 v[184:187], v[40:43], v[36:39], v[184:187]
    ds_read_b64_tr_b16 v[58:59], v12 offset:512
    v_mfma_f32_16x16x32_bf16 v[180:183], v[44:47], v[32:35], v[180:183]
    v_add_u32 v13, -131072, v13
    ds_read_b64_tr_b16 v[60:61], v13 offset:0
    v_mfma_f32_16x16x32_bf16 v[188:191], v[44:47], v[36:39], v[188:191]
    ds_read_b64_tr_b16 v[62:63], v13 offset:512
    s_waitcnt lgkmcnt(4)
    v_mfma_f32_16x16x32_bf16 v[128:131], v[48:51], v[24:27], v[128:131]
    ds_read_b64_tr_b16 v[40:41], v10 offset:8192
    v_mfma_f32_16x16x32_bf16 v[136:139], v[48:51], v[28:31], v[136:139]
    ds_read_b64_tr_b16 v[42:43], v10 offset:8704
    v_mfma_f32_16x16x32_bf16 v[132:135], v[52:55], v[24:27], v[132:135]
    ds_read_b64_tr_b16 v[44:45], v11 offset:8192
    v_mfma_f32_16x16x32_bf16 v[140:143], v[52:55], v[28:31], v[140:143]
    ds_read_b64_tr_b16 v[46:47], v11 offset:8704
    s_waitcnt lgkmcnt(4)
    v_mfma_f32_16x16x32_bf16 v[144:147], v[56:59], v[24:27], v[144:147]
    ds_read_b64_tr_b16 v[48:49], v12 offset:8192
    v_mfma_f32_16x16x32_bf16 v[152:155], v[56:59], v[28:31], v[152:155]
    ds_read_b64_tr_b16 v[50:51], v12 offset:8704
    v_mfma_f32_16x16x32_bf16 v[148:151], v[60:63], v[24:27], v[148:151]
    ds_read_b64_tr_b16 v[52:53], v13 offset:8192
    v_mfma_f32_16x16x32_bf16 v[156:159], v[60:63], v[28:31], v[156:159]
    ds_read_b64_tr_b16 v[54:55], v13 offset:8704
    s_waitcnt lgkmcnt(4)
    v_mfma_f32_16x16x32_bf16 v[160:163], v[40:43], v[24:27], v[160:163]
    ds_read_b64_tr_b16 v[56:57], v10 offset:4096
    v_mfma_f32_16x16x32_bf16 v[168:171], v[40:43], v[28:31], v[168:171]
    ds_read_b64_tr_b16 v[58:59], v10 offset:4608
    v_add_u32 v9, -131072, v9
    ds_read_b128 v[32:35], v9 offset:0
    v_mfma_f32_16x16x32_bf16 v[164:167], v[44:47], v[24:27], v[164:167]
    ds_read_b64_tr_b16 v[60:61], v11 offset:4096
    v_mfma_f32_16x16x32_bf16 v[172:175], v[44:47], v[28:31], v[172:175]
    ds_read_b64_tr_b16 v[62:63], v11 offset:4608
    ds_read_b128 v[36:39], v9 offset:2048
    s_waitcnt lgkmcnt(6)
    v_mfma_f32_16x16x32_bf16 v[176:179], v[48:51], v[24:27], v[176:179]
    ds_read_b64_tr_b16 v[40:41], v12 offset:4096
    v_mfma_f32_16x16x32_bf16 v[184:187], v[48:51], v[28:31], v[184:187]
    ds_read_b64_tr_b16 v[42:43], v12 offset:4608
    v_mfma_f32_16x16x32_bf16 v[180:183], v[52:55], v[24:27], v[180:183]
    ds_read_b64_tr_b16 v[44:45], v13 offset:4096
    v_mfma_f32_16x16x32_bf16 v[188:191], v[52:55], v[28:31], v[188:191]
    ds_read_b64_tr_b16 v[46:47], v13 offset:4608
    s_waitcnt lgkmcnt(4)
    v_mfma_f32_16x16x32_bf16 v[128:131], v[56:59], v[32:35], v[128:131]
    ds_read_b64_tr_b16 v[48:49], v10 offset:12288
    v_mfma_f32_16x16x32_bf16 v[136:139], v[56:59], v[36:39], v[136:139]
    ds_read_b64_tr_b16 v[50:51], v10 offset:12800
    v_mfma_f32_16x16x32_bf16 v[132:135], v[60:63], v[32:35], v[132:135]
    ds_read_b64_tr_b16 v[52:53], v11 offset:12288
    v_mfma_f32_16x16x32_bf16 v[140:143], v[60:63], v[36:39], v[140:143]
    ds_read_b64_tr_b16 v[54:55], v11 offset:12800
    s_waitcnt lgkmcnt(4)
    v_mfma_f32_16x16x32_bf16 v[144:147], v[40:43], v[32:35], v[144:147]
    ds_read_b64_tr_b16 v[56:57], v12 offset:12288
    v_mfma_f32_16x16x32_bf16 v[152:155], v[40:43], v[36:39], v[152:155]
    ds_read_b64_tr_b16 v[58:59], v12 offset:12800
    v_mfma_f32_16x16x32_bf16 v[148:151], v[44:47], v[32:35], v[148:151]
    ds_read_b64_tr_b16 v[60:61], v13 offset:12288
    v_mfma_f32_16x16x32_bf16 v[156:159], v[44:47], v[36:39], v[156:159]
    ds_read_b64_tr_b16 v[62:63], v13 offset:12800
    s_waitcnt lgkmcnt(4)
    v_mfma_f32_16x16x32_bf16 v[160:163], v[48:51], v[32:35], v[160:163]
    s_barrier
    v_add_u32 v10, 32768, v10
    ds_read_b64_tr_b16 v[40:41], v10 offset:0
    v_mfma_f32_16x16x32_bf16 v[168:171], v[48:51], v[36:39], v[168:171]
    ds_read_b64_tr_b16 v[42:43], v10 offset:512
    v_add_u32 v8, 32768, v8
    ds_read_b128 v[24:27], v8 offset:0
    v_mfma_f32_16x16x32_bf16 v[164:167], v[52:55], v[32:35], v[164:167]
    v_add_u32 v11, 32768, v11
    ds_read_b64_tr_b16 v[44:45], v11 offset:0
    v_mfma_f32_16x16x32_bf16 v[172:175], v[52:55], v[36:39], v[172:175]
    ds_read_b64_tr_b16 v[46:47], v11 offset:512
    ds_read_b128 v[28:31], v8 offset:2048
    s_waitcnt lgkmcnt(6)
    v_mfma_f32_16x16x32_bf16 v[176:179], v[56:59], v[32:35], v[176:179]
    v_add_u32 v12, 32768, v12
    ds_read_b64_tr_b16 v[48:49], v12 offset:0
    v_mfma_f32_16x16x32_bf16 v[184:187], v[56:59], v[36:39], v[184:187]
    ds_read_b64_tr_b16 v[50:51], v12 offset:512
    v_mfma_f32_16x16x32_bf16 v[180:183], v[60:63], v[32:35], v[180:183]
    v_add_u32 v13, 32768, v13
    ds_read_b64_tr_b16 v[52:53], v13 offset:0
    v_mfma_f32_16x16x32_bf16 v[188:191], v[60:63], v[36:39], v[188:191]
    ds_read_b64_tr_b16 v[54:55], v13 offset:512
    s_waitcnt lgkmcnt(4)
    v_mfma_f32_16x16x32_bf16 v[128:131], v[40:43], v[24:27], v[128:131]
    ds_read_b64_tr_b16 v[56:57], v10 offset:8192
    v_mfma_f32_16x16x32_bf16 v[136:139], v[40:43], v[28:31], v[136:139]
    ds_read_b64_tr_b16 v[58:59], v10 offset:8704
    v_mfma_f32_16x16x32_bf16 v[132:135], v[44:47], v[24:27], v[132:135]
    ds_read_b64_tr_b16 v[60:61], v11 offset:8192
    v_mfma_f32_16x16x32_bf16 v[140:143], v[44:47], v[28:31], v[140:143]
    ds_read_b64_tr_b16 v[62:63], v11 offset:8704
    s_waitcnt lgkmcnt(4)
    v_mfma_f32_16x16x32_bf16 v[144:147], v[48:51], v[24:27], v[144:147]
    ds_read_b64_tr_b16 v[40:41], v12 offset:8192
    v_mfma_f32_16x16x32_bf16 v[152:155], v[48:51], v[28:31], v[152:155]
    ds_read_b64_tr_b16 v[42:43], v12 offset:8704
    v_mfma_f32_16x16x32_bf16 v[148:151], v[52:55], v[24:27], v[148:151]
    ds_read_b64_tr_b16 v[44:45], v13 offset:8192
    v_mfma_f32_16x16x32_bf16 v[156:159], v[52:55], v[28:31], v[156:159]
    ds_read_b64_tr_b16 v[46:47], v13 offset:8704
    s_waitcnt lgkmcnt(4)
    v_mfma_f32_16x16x32_bf16 v[160:163], v[56:59], v[24:27], v[160:163]
    ds_read_b64_tr_b16 v[48:49], v10 offset:4096
    v_mfma_f32_16x16x32_bf16 v[168:171], v[56:59], v[28:31], v[168:171]
    ds_read_b64_tr_b16 v[50:51], v10 offset:4608
    v_add_u32 v9, 32768, v9
    ds_read_b128 v[32:35], v9 offset:0
    v_mfma_f32_16x16x32_bf16 v[164:167], v[60:63], v[24:27], v[164:167]
    ds_read_b64_tr_b16 v[52:53], v11 offset:4096
    v_mfma_f32_16x16x32_bf16 v[172:175], v[60:63], v[28:31], v[172:175]
    ds_read_b64_tr_b16 v[54:55], v11 offset:4608
    ds_read_b128 v[36:39], v9 offset:2048
    s_waitcnt lgkmcnt(6)
    v_mfma_f32_16x16x32_bf16 v[176:179], v[40:43], v[24:27], v[176:179]
    ds_read_b64_tr_b16 v[56:57], v12 offset:4096
    v_mfma_f32_16x16x32_bf16 v[184:187], v[40:43], v[28:31], v[184:187]
    ds_read_b64_tr_b16 v[58:59], v12 offset:4608
    v_mfma_f32_16x16x32_bf16 v[180:183], v[44:47], v[24:27], v[180:183]
    ds_read_b64_tr_b16 v[60:61], v13 offset:4096
    v_mfma_f32_16x16x32_bf16 v[188:191], v[44:47], v[28:31], v[188:191]
    ds_read_b64_tr_b16 v[62:63], v13 offset:4608
    s_waitcnt lgkmcnt(4)
    v_mfma_f32_16x16x32_bf16 v[128:131], v[48:51], v[32:35], v[128:131]
    ds_read_b64_tr_b16 v[40:41], v10 offset:12288
    v_mfma_f32_16x16x32_bf16 v[136:139], v[48:51], v[36:39], v[136:139]
    ds_read_b64_tr_b16 v[42:43], v10 offset:12800
    v_mfma_f32_16x16x32_bf16 v[132:135], v[52:55], v[32:35], v[132:135]
    ds_read_b64_tr_b16 v[44:45], v11 offset:12288
    v_mfma_f32_16x16x32_bf16 v[140:143], v[52:55], v[36:39], v[140:143]
    ds_read_b64_tr_b16 v[46:47], v11 offset:12800
    s_waitcnt lgkmcnt(4)
    v_mfma_f32_16x16x32_bf16 v[144:147], v[56:59], v[32:35], v[144:147]
    ds_read_b64_tr_b16 v[48:49], v12 offset:12288
    v_mfma_f32_16x16x32_bf16 v[152:155], v[56:59], v[36:39], v[152:155]
    ds_read_b64_tr_b16 v[50:51], v12 offset:12800
    v_mfma_f32_16x16x32_bf16 v[148:151], v[60:63], v[32:35], v[148:151]
    ds_read_b64_tr_b16 v[52:53], v13 offset:12288
    v_mfma_f32_16x16x32_bf16 v[156:159], v[60:63], v[36:39], v[156:159]
    ds_read_b64_tr_b16 v[54:55], v13 offset:12800
    s_waitcnt lgkmcnt(4)
    v_mfma_f32_16x16x32_bf16 v[160:163], v[40:43], v[32:35], v[160:163]
    s_barrier
    v_add_u32 v10, 32768, v10
    ds_read_b64_tr_b16 v[56:57], v10 offset:0
    v_mfma_f32_16x16x32_bf16 v[168:171], v[40:43], v[36:39], v[168:171]
    ds_read_b64_tr_b16 v[58:59], v10 offset:512
    v_add_u32 v8, 32768, v8
    ds_read_b128 v[24:27], v8 offset:0
    v_mfma_f32_16x16x32_bf16 v[164:167], v[44:47], v[32:35], v[164:167]
    v_add_u32 v11, 32768, v11
    ds_read_b64_tr_b16 v[60:61], v11 offset:0
    v_mfma_f32_16x16x32_bf16 v[172:175], v[44:47], v[36:39], v[172:175]
    ds_read_b64_tr_b16 v[62:63], v11 offset:512
    ds_read_b128 v[28:31], v8 offset:2048
    s_waitcnt lgkmcnt(6)
    v_mfma_f32_16x16x32_bf16 v[176:179], v[48:51], v[32:35], v[176:179]
    v_add_u32 v12, 32768, v12
    ds_read_b64_tr_b16 v[40:41], v12 offset:0
    v_mfma_f32_16x16x32_bf16 v[184:187], v[48:51], v[36:39], v[184:187]
    ds_read_b64_tr_b16 v[42:43], v12 offset:512
    v_mfma_f32_16x16x32_bf16 v[180:183], v[52:55], v[32:35], v[180:183]
    v_add_u32 v13, 32768, v13
    ds_read_b64_tr_b16 v[44:45], v13 offset:0
    v_mfma_f32_16x16x32_bf16 v[188:191], v[52:55], v[36:39], v[188:191]
    ds_read_b64_tr_b16 v[46:47], v13 offset:512
    s_waitcnt lgkmcnt(4)
    v_mfma_f32_16x16x32_bf16 v[128:131], v[56:59], v[24:27], v[128:131]
    ds_read_b64_tr_b16 v[48:49], v10 offset:8192
    v_mfma_f32_16x16x32_bf16 v[136:139], v[56:59], v[28:31], v[136:139]
    ds_read_b64_tr_b16 v[50:51], v10 offset:8704
    v_mfma_f32_16x16x32_bf16 v[132:135], v[60:63], v[24:27], v[132:135]
    ds_read_b64_tr_b16 v[52:53], v11 offset:8192
    v_mfma_f32_16x16x32_bf16 v[140:143], v[60:63], v[28:31], v[140:143]
    ds_read_b64_tr_b16 v[54:55], v11 offset:8704
    s_waitcnt lgkmcnt(4)
    v_mfma_f32_16x16x32_bf16 v[144:147], v[40:43], v[24:27], v[144:147]
    ds_read_b64_tr_b16 v[56:57], v12 offset:8192
    v_mfma_f32_16x16x32_bf16 v[152:155], v[40:43], v[28:31], v[152:155]
    ds_read_b64_tr_b16 v[58:59], v12 offset:8704
    v_mfma_f32_16x16x32_bf16 v[148:151], v[44:47], v[24:27], v[148:151]
    ds_read_b64_tr_b16 v[60:61], v13 offset:8192
    v_mfma_f32_16x16x32_bf16 v[156:159], v[44:47], v[28:31], v[156:159]
    ds_read_b64_tr_b16 v[62:63], v13 offset:8704
    s_waitcnt lgkmcnt(4)
    v_mfma_f32_16x16x32_bf16 v[160:163], v[48:51], v[24:27], v[160:163]
    ds_read_b64_tr_b16 v[40:41], v10 offset:4096
    v_mfma_f32_16x16x32_bf16 v[168:171], v[48:51], v[28:31], v[168:171]
    ds_read_b64_tr_b16 v[42:43], v10 offset:4608
    v_add_u32 v9, 32768, v9
    ds_read_b128 v[32:35], v9 offset:0
    v_mfma_f32_16x16x32_bf16 v[164:167], v[52:55], v[24:27], v[164:167]
    ds_read_b64_tr_b16 v[44:45], v11 offset:4096
    v_mfma_f32_16x16x32_bf16 v[172:175], v[52:55], v[28:31], v[172:175]
    ds_read_b64_tr_b16 v[46:47], v11 offset:4608
    ds_read_b128 v[36:39], v9 offset:2048
    s_waitcnt lgkmcnt(6)
    v_mfma_f32_16x16x32_bf16 v[176:179], v[56:59], v[24:27], v[176:179]
    ds_read_b64_tr_b16 v[48:49], v12 offset:4096
    v_mfma_f32_16x16x32_bf16 v[184:187], v[56:59], v[28:31], v[184:187]
    ds_read_b64_tr_b16 v[50:51], v12 offset:4608
    v_mfma_f32_16x16x32_bf16 v[180:183], v[60:63], v[24:27], v[180:183]
    ds_read_b64_tr_b16 v[52:53], v13 offset:4096
    v_mfma_f32_16x16x32_bf16 v[188:191], v[60:63], v[28:31], v[188:191]
    ds_read_b64_tr_b16 v[54:55], v13 offset:4608
    s_waitcnt lgkmcnt(4)
    v_mfma_f32_16x16x32_bf16 v[128:131], v[40:43], v[32:35], v[128:131]
    ds_read_b64_tr_b16 v[56:57], v10 offset:12288
    v_mfma_f32_16x16x32_bf16 v[136:139], v[40:43], v[36:39], v[136:139]
    ds_read_b64_tr_b16 v[58:59], v10 offset:12800
    v_mfma_f32_16x16x32_bf16 v[132:135], v[44:47], v[32:35], v[132:135]
    ds_read_b64_tr_b16 v[60:61], v11 offset:12288
    v_mfma_f32_16x16x32_bf16 v[140:143], v[44:47], v[36:39], v[140:143]
    ds_read_b64_tr_b16 v[62:63], v11 offset:12800
    s_waitcnt lgkmcnt(4)
    v_mfma_f32_16x16x32_bf16 v[144:147], v[48:51], v[32:35], v[144:147]
    ds_read_b64_tr_b16 v[40:41], v12 offset:12288
    v_mfma_f32_16x16x32_bf16 v[152:155], v[48:51], v[36:39], v[152:155]
    ds_read_b64_tr_b16 v[42:43], v12 offset:12800
    v_mfma_f32_16x16x32_bf16 v[148:151], v[52:55], v[32:35], v[148:151]
    ds_read_b64_tr_b16 v[44:45], v13 offset:12288
    v_mfma_f32_16x16x32_bf16 v[156:159], v[52:55], v[36:39], v[156:159]
    ds_read_b64_tr_b16 v[46:47], v13 offset:12800
    s_waitcnt lgkmcnt(4)
    v_mfma_f32_16x16x32_bf16 v[160:163], v[56:59], v[32:35], v[160:163]
    v_mfma_f32_16x16x32_bf16 v[168:171], v[56:59], v[36:39], v[168:171]
    v_mfma_f32_16x16x32_bf16 v[164:167], v[60:63], v[32:35], v[164:167]
    v_mfma_f32_16x16x32_bf16 v[172:175], v[60:63], v[36:39], v[172:175]
    s_waitcnt lgkmcnt(0)
    v_mfma_f32_16x16x32_bf16 v[176:179], v[40:43], v[32:35], v[176:179]
    v_mfma_f32_16x16x32_bf16 v[184:187], v[40:43], v[36:39], v[184:187]
    v_mfma_f32_16x16x32_bf16 v[180:183], v[44:47], v[32:35], v[180:183]
    v_mfma_f32_16x16x32_bf16 v[188:191], v[44:47], v[36:39], v[188:191]
    v_pk_mul_f32 v[72:73], v[128:129], v[128:129]
    v_pk_mul_f32 v[74:75], v[130:131], v[130:131]
    v_pk_mul_f32 v[76:77], v[132:133], v[132:133]
    v_pk_mul_f32 v[78:79], v[134:135], v[134:135]
    v_pk_mul_f32 v[80:81], v[136:137], v[136:137]
    v_pk_mul_f32 v[82:83], v[138:139], v[138:139]
    v_pk_mul_f32 v[84:85], v[140:141], v[140:141]
    v_pk_mul_f32 v[86:87], v[142:143], v[142:143]
    v_pk_fma_f32 v[72:73], v[72:73], v[16:17], v[18:19]
    v_pk_fma_f32 v[74:75], v[74:75], v[16:17], v[18:19]
    v_pk_fma_f32 v[76:77], v[76:77], v[16:17], v[18:19]
    v_pk_fma_f32 v[78:79], v[78:79], v[16:17], v[18:19]
    v_pk_fma_f32 v[80:81], v[80:81], v[16:17], v[18:19]
    v_pk_fma_f32 v[82:83], v[82:83], v[16:17], v[18:19]
    v_pk_fma_f32 v[84:85], v[84:85], v[16:17], v[18:19]
    v_pk_fma_f32 v[86:87], v[86:87], v[16:17], v[18:19]
    v_pk_mul_f32 v[72:73], v[72:73], v[128:129]
    v_pk_mul_f32 v[74:75], v[74:75], v[130:131]
    v_pk_mul_f32 v[76:77], v[76:77], v[132:133]
    v_pk_mul_f32 v[78:79], v[78:79], v[134:135]
    v_pk_mul_f32 v[80:81], v[80:81], v[136:137]
    v_pk_mul_f32 v[82:83], v[82:83], v[138:139]
    v_pk_mul_f32 v[84:85], v[84:85], v[140:141]
    v_pk_mul_f32 v[86:87], v[86:87], v[142:143]
    v_exp_f32 v72, v72
    v_exp_f32 v73, v73
    v_exp_f32 v74, v74
    v_exp_f32 v75, v75
    v_exp_f32 v76, v76
    v_exp_f32 v77, v77
    v_exp_f32 v78, v78
    v_exp_f32 v79, v79
    v_exp_f32 v80, v80
    v_exp_f32 v81, v81
    v_exp_f32 v82, v82
    v_exp_f32 v83, v83
    v_exp_f32 v84, v84
    v_exp_f32 v85, v85
    v_exp_f32 v86, v86
    v_exp_f32 v87, v87
    v_pk_add_f32 v[72:73], v[72:73], 1.0 op_sel_hi:[1,0]
    v_pk_add_f32 v[74:75], v[74:75], 1.0 op_sel_hi:[1,0]
    v_pk_add_f32 v[76:77], v[76:77], 1.0 op_sel_hi:[1,0]
    v_pk_add_f32 v[78:79], v[78:79], 1.0 op_sel_hi:[1,0]
    v_pk_add_f32 v[80:81], v[80:81], 1.0 op_sel_hi:[1,0]
    v_pk_add_f32 v[82:83], v[82:83], 1.0 op_sel_hi:[1,0]
    v_pk_add_f32 v[84:85], v[84:85], 1.0 op_sel_hi:[1,0]
    v_pk_add_f32 v[86:87], v[86:87], 1.0 op_sel_hi:[1,0]
    v_rcp_f32 v72, v72
    v_rcp_f32 v73, v73
    v_rcp_f32 v74, v74
    v_rcp_f32 v75, v75
    v_rcp_f32 v76, v76
    v_rcp_f32 v77, v77
    v_rcp_f32 v78, v78
    v_rcp_f32 v79, v79
    v_rcp_f32 v80, v80
    v_rcp_f32 v81, v81
    v_rcp_f32 v82, v82
    v_rcp_f32 v83, v83
    v_rcp_f32 v84, v84
    v_rcp_f32 v85, v85
    v_rcp_f32 v86, v86
    v_rcp_f32 v87, v87
    v_pk_mul_f32 v[128:129], v[128:129], v[72:73]
    v_pk_mul_f32 v[130:131], v[130:131], v[74:75]
    v_pk_mul_f32 v[132:133], v[132:133], v[76:77]
    v_pk_mul_f32 v[134:135], v[134:135], v[78:79]
    v_pk_mul_f32 v[136:137], v[136:137], v[80:81]
    v_pk_mul_f32 v[138:139], v[138:139], v[82:83]
    v_pk_mul_f32 v[140:141], v[140:141], v[84:85]
    v_pk_mul_f32 v[142:143], v[142:143], v[86:87]
    s_barrier
    v_pk_mul_f32 v[72:73], v[144:145], v[144:145]
    v_pk_mul_f32 v[74:75], v[146:147], v[146:147]
    v_pk_mul_f32 v[76:77], v[148:149], v[148:149]
    v_pk_mul_f32 v[78:79], v[150:151], v[150:151]
    v_pk_mul_f32 v[80:81], v[152:153], v[152:153]
    v_pk_mul_f32 v[82:83], v[154:155], v[154:155]
    v_pk_mul_f32 v[84:85], v[156:157], v[156:157]
    v_pk_mul_f32 v[86:87], v[158:159], v[158:159]
    v_pk_fma_f32 v[72:73], v[72:73], v[16:17], v[18:19]
    v_pk_fma_f32 v[74:75], v[74:75], v[16:17], v[18:19]
    v_pk_fma_f32 v[76:77], v[76:77], v[16:17], v[18:19]
    v_pk_fma_f32 v[78:79], v[78:79], v[16:17], v[18:19]
    v_pk_fma_f32 v[80:81], v[80:81], v[16:17], v[18:19]
    v_pk_fma_f32 v[82:83], v[82:83], v[16:17], v[18:19]
    v_pk_fma_f32 v[84:85], v[84:85], v[16:17], v[18:19]
    v_pk_fma_f32 v[86:87], v[86:87], v[16:17], v[18:19]
    v_pk_mul_f32 v[72:73], v[72:73], v[144:145]
    v_pk_mul_f32 v[74:75], v[74:75], v[146:147]
    v_pk_mul_f32 v[76:77], v[76:77], v[148:149]
    v_pk_mul_f32 v[78:79], v[78:79], v[150:151]
    v_pk_mul_f32 v[80:81], v[80:81], v[152:153]
    v_pk_mul_f32 v[82:83], v[82:83], v[154:155]
    v_pk_mul_f32 v[84:85], v[84:85], v[156:157]
    v_pk_mul_f32 v[86:87], v[86:87], v[158:159]
    v_exp_f32 v72, v72
    v_exp_f32 v73, v73
    v_exp_f32 v74, v74
    v_exp_f32 v75, v75
    v_exp_f32 v76, v76
    v_exp_f32 v77, v77
    v_exp_f32 v78, v78
    v_exp_f32 v79, v79
    v_exp_f32 v80, v80
    v_exp_f32 v81, v81
    v_exp_f32 v82, v82
    v_exp_f32 v83, v83
    v_exp_f32 v84, v84
    v_exp_f32 v85, v85
    v_exp_f32 v86, v86
    v_exp_f32 v87, v87
    v_pk_add_f32 v[72:73], v[72:73], 1.0 op_sel_hi:[1,0]
    v_pk_add_f32 v[74:75], v[74:75], 1.0 op_sel_hi:[1,0]
    v_pk_add_f32 v[76:77], v[76:77], 1.0 op_sel_hi:[1,0]
    v_pk_add_f32 v[78:79], v[78:79], 1.0 op_sel_hi:[1,0]
    v_pk_add_f32 v[80:81], v[80:81], 1.0 op_sel_hi:[1,0]
    v_pk_add_f32 v[82:83], v[82:83], 1.0 op_sel_hi:[1,0]
    v_pk_add_f32 v[84:85], v[84:85], 1.0 op_sel_hi:[1,0]
    v_pk_add_f32 v[86:87], v[86:87], 1.0 op_sel_hi:[1,0]
    v_rcp_f32 v72, v72
    v_rcp_f32 v73, v73
    v_rcp_f32 v74, v74
    v_rcp_f32 v75, v75
    v_rcp_f32 v76, v76
    v_rcp_f32 v77, v77
    v_rcp_f32 v78, v78
    v_rcp_f32 v79, v79
    v_rcp_f32 v80, v80
    v_rcp_f32 v81, v81
    v_rcp_f32 v82, v82
    v_rcp_f32 v83, v83
    v_rcp_f32 v84, v84
    v_rcp_f32 v85, v85
    v_rcp_f32 v86, v86
    v_rcp_f32 v87, v87
    v_pk_mul_f32 v[144:145], v[144:145], v[72:73]
    v_pk_mul_f32 v[146:147], v[146:147], v[74:75]
    v_pk_mul_f32 v[148:149], v[148:149], v[76:77]
    v_pk_mul_f32 v[150:151], v[150:151], v[78:79]
    v_pk_mul_f32 v[152:153], v[152:153], v[80:81]
    v_pk_mul_f32 v[154:155], v[154:155], v[82:83]
    v_pk_mul_f32 v[156:157], v[156:157], v[84:85]
    v_pk_mul_f32 v[158:159], v[158:159], v[86:87]
    v_pk_mul_f32 v[72:73], v[160:161], v[160:161]
    v_pk_mul_f32 v[74:75], v[162:163], v[162:163]
    v_pk_mul_f32 v[76:77], v[164:165], v[164:165]
    v_pk_mul_f32 v[78:79], v[166:167], v[166:167]
    v_pk_mul_f32 v[80:81], v[168:169], v[168:169]
    v_pk_mul_f32 v[82:83], v[170:171], v[170:171]
    v_pk_mul_f32 v[84:85], v[172:173], v[172:173]
    v_pk_mul_f32 v[86:87], v[174:175], v[174:175]
    v_pk_fma_f32 v[72:73], v[72:73], v[16:17], v[18:19]
    v_pk_fma_f32 v[74:75], v[74:75], v[16:17], v[18:19]
    v_pk_fma_f32 v[76:77], v[76:77], v[16:17], v[18:19]
    v_pk_fma_f32 v[78:79], v[78:79], v[16:17], v[18:19]
    v_pk_fma_f32 v[80:81], v[80:81], v[16:17], v[18:19]
    v_pk_fma_f32 v[82:83], v[82:83], v[16:17], v[18:19]
    v_pk_fma_f32 v[84:85], v[84:85], v[16:17], v[18:19]
    v_pk_fma_f32 v[86:87], v[86:87], v[16:17], v[18:19]
    v_pk_mul_f32 v[72:73], v[72:73], v[160:161]
    v_pk_mul_f32 v[74:75], v[74:75], v[162:163]
    v_pk_mul_f32 v[76:77], v[76:77], v[164:165]
    v_pk_mul_f32 v[78:79], v[78:79], v[166:167]
    v_pk_mul_f32 v[80:81], v[80:81], v[168:169]
    v_pk_mul_f32 v[82:83], v[82:83], v[170:171]
    v_pk_mul_f32 v[84:85], v[84:85], v[172:173]
    v_pk_mul_f32 v[86:87], v[86:87], v[174:175]
    v_exp_f32 v72, v72
    v_exp_f32 v73, v73
    v_exp_f32 v74, v74
    v_exp_f32 v75, v75
    v_exp_f32 v76, v76
    v_exp_f32 v77, v77
    v_exp_f32 v78, v78
    v_exp_f32 v79, v79
    v_exp_f32 v80, v80
    v_exp_f32 v81, v81
    v_exp_f32 v82, v82
    v_exp_f32 v83, v83
    v_exp_f32 v84, v84
    v_exp_f32 v85, v85
    v_exp_f32 v86, v86
    v_exp_f32 v87, v87
    v_pk_add_f32 v[72:73], v[72:73], 1.0 op_sel_hi:[1,0]
    v_pk_add_f32 v[74:75], v[74:75], 1.0 op_sel_hi:[1,0]
    v_pk_add_f32 v[76:77], v[76:77], 1.0 op_sel_hi:[1,0]
    v_pk_add_f32 v[78:79], v[78:79], 1.0 op_sel_hi:[1,0]
    v_pk_add_f32 v[80:81], v[80:81], 1.0 op_sel_hi:[1,0]
    v_pk_add_f32 v[82:83], v[82:83], 1.0 op_sel_hi:[1,0]
    v_pk_add_f32 v[84:85], v[84:85], 1.0 op_sel_hi:[1,0]
    v_pk_add_f32 v[86:87], v[86:87], 1.0 op_sel_hi:[1,0]
    v_rcp_f32 v72, v72
    v_rcp_f32 v73, v73
    v_rcp_f32 v74, v74
    v_rcp_f32 v75, v75
    v_rcp_f32 v76, v76
    v_rcp_f32 v77, v77
    v_rcp_f32 v78, v78
    v_rcp_f32 v79, v79
    v_rcp_f32 v80, v80
    v_rcp_f32 v81, v81
    v_rcp_f32 v82, v82
    v_rcp_f32 v83, v83
    v_rcp_f32 v84, v84
    v_rcp_f32 v85, v85
    v_rcp_f32 v86, v86
    v_rcp_f32 v87, v87
    v_pk_mul_f32 v[160:161], v[160:161], v[72:73]
    v_pk_mul_f32 v[162:163], v[162:163], v[74:75]
    v_pk_mul_f32 v[164:165], v[164:165], v[76:77]
    v_pk_mul_f32 v[166:167], v[166:167], v[78:79]
    v_pk_mul_f32 v[168:169], v[168:169], v[80:81]
    v_pk_mul_f32 v[170:171], v[170:171], v[82:83]
    v_pk_mul_f32 v[172:173], v[172:173], v[84:85]
    v_pk_mul_f32 v[174:175], v[174:175], v[86:87]
    v_pk_mul_f32 v[72:73], v[176:177], v[176:177]
    v_pk_mul_f32 v[74:75], v[178:179], v[178:179]
    v_pk_mul_f32 v[76:77], v[180:181], v[180:181]
    v_pk_mul_f32 v[78:79], v[182:183], v[182:183]
    v_pk_mul_f32 v[80:81], v[184:185], v[184:185]
    v_pk_mul_f32 v[82:83], v[186:187], v[186:187]
    v_pk_mul_f32 v[84:85], v[188:189], v[188:189]
    v_pk_mul_f32 v[86:87], v[190:191], v[190:191]
    v_pk_fma_f32 v[72:73], v[72:73], v[16:17], v[18:19]
    v_pk_fma_f32 v[74:75], v[74:75], v[16:17], v[18:19]
    v_pk_fma_f32 v[76:77], v[76:77], v[16:17], v[18:19]
    v_pk_fma_f32 v[78:79], v[78:79], v[16:17], v[18:19]
    v_pk_fma_f32 v[80:81], v[80:81], v[16:17], v[18:19]
    v_pk_fma_f32 v[82:83], v[82:83], v[16:17], v[18:19]
    v_pk_fma_f32 v[84:85], v[84:85], v[16:17], v[18:19]
    v_pk_fma_f32 v[86:87], v[86:87], v[16:17], v[18:19]
    v_pk_mul_f32 v[72:73], v[72:73], v[176:177]
    v_pk_mul_f32 v[74:75], v[74:75], v[178:179]
    v_pk_mul_f32 v[76:77], v[76:77], v[180:181]
    v_pk_mul_f32 v[78:79], v[78:79], v[182:183]
    v_pk_mul_f32 v[80:81], v[80:81], v[184:185]
    v_pk_mul_f32 v[82:83], v[82:83], v[186:187]
    v_pk_mul_f32 v[84:85], v[84:85], v[188:189]
    v_pk_mul_f32 v[86:87], v[86:87], v[190:191]
    v_exp_f32 v72, v72
    v_exp_f32 v73, v73
    v_exp_f32 v74, v74
    v_exp_f32 v75, v75
    v_exp_f32 v76, v76
    v_exp_f32 v77, v77
    v_exp_f32 v78, v78
    v_exp_f32 v79, v79
    v_exp_f32 v80, v80
    v_exp_f32 v81, v81
    v_exp_f32 v82, v82
    v_exp_f32 v83, v83
    v_exp_f32 v84, v84
    v_exp_f32 v85, v85
    v_exp_f32 v86, v86
    v_exp_f32 v87, v87
    v_pk_add_f32 v[72:73], v[72:73], 1.0 op_sel_hi:[1,0]
    v_pk_add_f32 v[74:75], v[74:75], 1.0 op_sel_hi:[1,0]
    v_pk_add_f32 v[76:77], v[76:77], 1.0 op_sel_hi:[1,0]
    v_pk_add_f32 v[78:79], v[78:79], 1.0 op_sel_hi:[1,0]
    v_pk_add_f32 v[80:81], v[80:81], 1.0 op_sel_hi:[1,0]
    v_pk_add_f32 v[82:83], v[82:83], 1.0 op_sel_hi:[1,0]
    v_pk_add_f32 v[84:85], v[84:85], 1.0 op_sel_hi:[1,0]
    v_pk_add_f32 v[86:87], v[86:87], 1.0 op_sel_hi:[1,0]
    v_rcp_f32 v72, v72
    v_rcp_f32 v73, v73
    v_rcp_f32 v74, v74
    v_rcp_f32 v75, v75
    v_rcp_f32 v76, v76
    v_rcp_f32 v77, v77
    v_rcp_f32 v78, v78
    v_rcp_f32 v79, v79
    v_rcp_f32 v80, v80
    v_rcp_f32 v81, v81
    v_rcp_f32 v82, v82
    v_rcp_f32 v83, v83
    v_rcp_f32 v84, v84
    v_rcp_f32 v85, v85
    v_rcp_f32 v86, v86
    v_rcp_f32 v87, v87
    v_pk_mul_f32 v[176:177], v[176:177], v[72:73]
    v_pk_mul_f32 v[178:179], v[178:179], v[74:75]
    v_pk_mul_f32 v[180:181], v[180:181], v[76:77]
    v_pk_mul_f32 v[182:183], v[182:183], v[78:79]
    v_pk_mul_f32 v[184:185], v[184:185], v[80:81]
    v_pk_mul_f32 v[186:187], v[186:187], v[82:83]
    v_pk_mul_f32 v[188:189], v[188:189], v[84:85]
    v_pk_mul_f32 v[190:191], v[190:191], v[86:87]
    v_pk_add_f32 v[72:73], v[128:129], v[130:131]
    v_pk_add_f32 v[74:75], v[136:137], v[138:139]
    v_pk_add_f32 v[76:77], v[132:133], v[134:135]
    v_pk_add_f32 v[78:79], v[140:141], v[142:143]
    v_pk_add_f32 v[72:73], v[72:73], v[144:145]
    v_pk_add_f32 v[74:75], v[74:75], v[152:153]
    v_pk_add_f32 v[76:77], v[76:77], v[146:147]
    v_pk_add_f32 v[78:79], v[78:79], v[154:155]
    v_pk_add_f32 v[72:73], v[72:73], v[148:149]
    v_pk_add_f32 v[74:75], v[74:75], v[156:157]
    v_pk_add_f32 v[76:77], v[76:77], v[150:151]
    v_pk_add_f32 v[78:79], v[78:79], v[158:159]
    v_pk_add_f32 v[72:73], v[72:73], v[160:161]
    v_pk_add_f32 v[74:75], v[74:75], v[168:169]
    v_pk_add_f32 v[76:77], v[76:77], v[162:163]
    v_pk_add_f32 v[78:79], v[78:79], v[170:171]
    v_pk_add_f32 v[72:73], v[72:73], v[164:165]
    v_pk_add_f32 v[74:75], v[74:75], v[172:173]
    v_pk_add_f32 v[76:77], v[76:77], v[166:167]
    v_pk_add_f32 v[78:79], v[78:79], v[174:175]
    v_pk_add_f32 v[72:73], v[72:73], v[176:177]
    v_pk_add_f32 v[74:75], v[74:75], v[184:185]
    v_pk_add_f32 v[76:77], v[76:77], v[178:179]
    v_pk_add_f32 v[78:79], v[78:79], v[186:187]
    v_pk_add_f32 v[72:73], v[72:73], v[180:181]
    v_pk_add_f32 v[74:75], v[74:75], v[188:189]
    v_pk_add_f32 v[76:77], v[76:77], v[182:183]
    v_pk_add_f32 v[78:79], v[78:79], v[190:191]
    v_pk_add_f32 v[72:73], v[72:73], v[76:77]
    v_pk_add_f32 v[74:75], v[74:75], v[78:79]
    v_add_f32 v72, v72, v73
    v_add_f32 v74, v74, v75
    s_nop 1
    v_permlane32_swap_b32 v72, v74
    v_add_f32 v72, v72, v74
    v_mov_b32 v74, v72
    s_nop 1
    v_permlane16_swap_b32 v72, v74
    v_add_f32 v72, v72, v74
    v_mul_f32 v72, 0x3c000000, v72
    v_mov_b32 v74, v72
    v_mov_b32 v75, v72
    s_nop 1
    v_permlane32_swap_b32 v74, v75
    v_pk_add_f32 v[84:85], v[128:129], v[74:75] op_sel_hi:[1,0] neg_lo:[0,1] neg_hi:[0,1]
    v_pk_add_f32 v[86:87], v[136:137], v[74:75] op_sel:[0,1] op_sel_hi:[1,1] neg_lo:[0,1] neg_hi:[0,1]
    v_pk_add_f32 v[88:89], v[130:131], v[74:75] op_sel_hi:[1,0] neg_lo:[0,1] neg_hi:[0,1]
    v_pk_add_f32 v[90:91], v[138:139], v[74:75] op_sel:[0,1] op_sel_hi:[1,1] neg_lo:[0,1] neg_hi:[0,1]
    v_pk_mul_f32 v[76:77], v[84:85], v[84:85]
    v_pk_mul_f32 v[78:79], v[86:87], v[86:87]
    v_pk_mul_f32 v[80:81], v[88:89], v[88:89]
    v_pk_mul_f32 v[82:83], v[90:91], v[90:91]
    v_pk_add_f32 v[84:85], v[132:133], v[74:75] op_sel_hi:[1,0] neg_lo:[0,1] neg_hi:[0,1]
    v_pk_add_f32 v[86:87], v[140:141], v[74:75] op_sel:[0,1] op_sel_hi:[1,1] neg_lo:[0,1] neg_hi:[0,1]
    v_pk_add_f32 v[88:89], v[134:135], v[74:75] op_sel_hi:[1,0] neg_lo:[0,1] neg_hi:[0,1]
    v_pk_add_f32 v[90:91], v[142:143], v[74:75] op_sel:[0,1] op_sel_hi:[1,1] neg_lo:[0,1] neg_hi:[0,1]
    v_pk_fma_f32 v[76:77], v[84:85], v[84:85], v[76:77]
    v_pk_fma_f32 v[78:79], v[86:87], v[86:87], v[78:79]
    v_pk_fma_f32 v[80:81], v[88:89], v[88:89], v[80:81]
    v_pk_fma_f32 v[82:83], v[90:91], v[90:91], v[82:83]
    v_pk_add_f32 v[84:85], v[144:145], v[74:75] op_sel_hi:[1,0] neg_lo:[0,1] neg_hi:[0,1]
    v_pk_add_f32 v[86:87], v[152:153], v[74:75] op_sel:[0,1] op_sel_hi:[1,1] neg_lo:[0,1] neg_hi:[0,1]
    v_pk_add_f32 v[88:89], v[146:147], v[74:75] op_sel_hi:[1,0] neg_lo:[0,1] neg_hi:[0,1]
    v_pk_add_f32 v[90:91], v[154:155], v[74:75] op_sel:[0,1] op_sel_hi:[1,1] neg_lo:[0,1] neg_hi:[0,1]
    v_pk_fma_f32 v[76:77], v[84:85], v[84:85], v[76:77]
    v_pk_fma_f32 v[78:79], v[86:87], v[86:87], v[78:79]
    v_pk_fma_f32 v[80:81], v[88:89], v[88:89], v[80:81]
    v_pk_fma_f32 v[82:83], v[90:91], v[90:91], v[82:83]
    v_pk_add_f32 v[84:85], v[148:149], v[74:75] op_sel_hi:[1,0] neg_lo:[0,1] neg_hi:[0,1]
    v_pk_add_f32 v[86:87], v[156:157], v[74:75] op_sel:[0,1] op_sel_hi:[1,1] neg_lo:[0,1] neg_hi:[0,1]
    v_pk_add_f32 v[88:89], v[150:151], v[74:75] op_sel_hi:[1,0] neg_lo:[0,1] neg_hi:[0,1]
    v_pk_add_f32 v[90:91], v[158:159], v[74:75] op_sel:[0,1] op_sel_hi:[1,1] neg_lo:[0,1] neg_hi:[0,1]
    v_pk_fma_f32 v[76:77], v[84:85], v[84:85], v[76:77]
    v_pk_fma_f32 v[78:79], v[86:87], v[86:87], v[78:79]
    v_pk_fma_f32 v[80:81], v[88:89], v[88:89], v[80:81]
    v_pk_fma_f32 v[82:83], v[90:91], v[90:91], v[82:83]
    v_pk_add_f32 v[84:85], v[160:161], v[74:75] op_sel_hi:[1,0] neg_lo:[0,1] neg_hi:[0,1]
    v_pk_add_f32 v[86:87], v[168:169], v[74:75] op_sel:[0,1] op_sel_hi:[1,1] neg_lo:[0,1] neg_hi:[0,1]
    v_pk_add_f32 v[88:89], v[162:163], v[74:75] op_sel_hi:[1,0] neg_lo:[0,1] neg_hi:[0,1]
    v_pk_add_f32 v[90:91], v[170:171], v[74:75] op_sel:[0,1] op_sel_hi:[1,1] neg_lo:[0,1] neg_hi:[0,1]
    v_pk_fma_f32 v[76:77], v[84:85], v[84:85], v[76:77]
    v_pk_fma_f32 v[78:79], v[86:87], v[86:87], v[78:79]
    v_pk_fma_f32 v[80:81], v[88:89], v[88:89], v[80:81]
    v_pk_fma_f32 v[82:83], v[90:91], v[90:91], v[82:83]
    v_pk_add_f32 v[84:85], v[164:165], v[74:75] op_sel_hi:[1,0] neg_lo:[0,1] neg_hi:[0,1]
    v_pk_add_f32 v[86:87], v[172:173], v[74:75] op_sel:[0,1] op_sel_hi:[1,1] neg_lo:[0,1] neg_hi:[0,1]
    v_pk_add_f32 v[88:89], v[166:167], v[74:75] op_sel_hi:[1,0] neg_lo:[0,1] neg_hi:[0,1]
    v_pk_add_f32 v[90:91], v[174:175], v[74:75] op_sel:[0,1] op_sel_hi:[1,1] neg_lo:[0,1] neg_hi:[0,1]
    v_pk_fma_f32 v[76:77], v[84:85], v[84:85], v[76:77]
    v_pk_fma_f32 v[78:79], v[86:87], v[86:87], v[78:79]
    v_pk_fma_f32 v[80:81], v[88:89], v[88:89], v[80:81]
    v_pk_fma_f32 v[82:83], v[90:91], v[90:91], v[82:83]
    v_pk_add_f32 v[84:85], v[176:177], v[74:75] op_sel_hi:[1,0] neg_lo:[0,1] neg_hi:[0,1]
    v_pk_add_f32 v[86:87], v[184:185], v[74:75] op_sel:[0,1] op_sel_hi:[1,1] neg_lo:[0,1] neg_hi:[0,1]
    v_pk_add_f32 v[88:89], v[178:179], v[74:75] op_sel_hi:[1,0] neg_lo:[0,1] neg_hi:[0,1]
    v_pk_add_f32 v[90:91], v[186:187], v[74:75] op_sel:[0,1] op_sel_hi:[1,1] neg_lo:[0,1] neg_hi:[0,1]
    v_pk_fma_f32 v[76:77], v[84:85], v[84:85], v[76:77]
    v_pk_fma_f32 v[78:79], v[86:87], v[86:87], v[78:79]
    v_pk_fma_f32 v[80:81], v[88:89], v[88:89], v[80:81]
    v_pk_fma_f32 v[82:83], v[90:91], v[90:91], v[82:83]
    v_pk_add_f32 v[84:85], v[180:181], v[74:75] op_sel_hi:[1,0] neg_lo:[0,1] neg_hi:[0,1]
    v_pk_add_f32 v[86:87], v[188:189], v[74:75] op_sel:[0,1] op_sel_hi:[1,1] neg_lo:[0,1] neg_hi:[0,1]
    v_pk_add_f32 v[88:89], v[182:183], v[74:75] op_sel_hi:[1,0] neg_lo:[0,1] neg_hi:[0,1]
    v_pk_add_f32 v[90:91], v[190:191], v[74:75] op_sel:[0,1] op_sel_hi:[1,1] neg_lo:[0,1] neg_hi:[0,1]
    v_pk_fma_f32 v[76:77], v[84:85], v[84:85], v[76:77]
    v_pk_fma_f32 v[78:79], v[86:87], v[86:87], v[78:79]
    v_pk_fma_f32 v[80:81], v[88:89], v[88:89], v[80:81]
    v_pk_fma_f32 v[82:83], v[90:91], v[90:91], v[82:83]
    v_pk_add_f32 v[76:77], v[76:77], v[80:81]
    v_pk_add_f32 v[78:79], v[78:79], v[82:83]
    v_add_f32 v73, v76, v77
    v_add_f32 v78, v78, v79
    s_lshl_b32 s23, s19, 3
    s_add_u32 s23, s23, s20
    s_lshl_b32 s23, s23, 11
    s_lshl_b32 s34, s17, 9
    s_add_u32 s35, s23, s34
    s_add_u32 s35, s35, 0x1620000
    v_permlane32_swap_b32 v73, v78
    v_add_f32 v73, v73, v78
    v_mov_b32 v78, v73
    s_nop 1
    v_permlane16_swap_b32 v73, v78
    v_add_f32 v73, v73, v78
    v_mov_b32 v74, s28
    v_not_b32 v75, v74
    s_mov_b32 exec_lo, 0xffff
    s_mov_b32 exec_hi, 0xffff
    buffer_store_dwordx4 v[72:75], v242, s[12:15], s35 offen sc1
    s_mov_b64 exec, -1
    s_lshl_b32 s35, s19, 14
    s_add_u32 s35, s35, s34
    s_add_u32 s35, s35, 0x1620000
    s_barrier
    v_add_u32 v8, 32768, v8
    ds_read_b128 v[24:27], v8 offset:0
    ds_read_b128 v[28:31], v8 offset:2048
    v_add_u32 v10, 32768, v10
    ds_read_b64_tr_b16 v[40:41], v10 offset:0
    ds_read_b64_tr_b16 v[42:43], v10 offset:512
    v_add_u32 v11, 32768, v11
    ds_read_b64_tr_b16 v[44:45], v11 offset:0
    ds_read_b64_tr_b16 v[46:47], v11 offset:512
    v_add_u32 v12, 32768, v12
    ds_read_b64_tr_b16 v[48:49], v12 offset:0
    ds_read_b64_tr_b16 v[50:51], v12 offset:512
    v_add_u32 v13, 32768, v13
    ds_read_b64_tr_b16 v[52:53], v13 offset:0
    ds_read_b64_tr_b16 v[54:55], v13 offset:512
    s_waitcnt lgkmcnt(4)
    v_mfma_f32_16x16x32_bf16 v[192:195], v[40:43], v[24:27], 0
    ds_read_b64_tr_b16 v[56:57], v10 offset:4096
    v_mfma_f32_16x16x32_bf16 v[200:203], v[40:43], v[28:31], 0
    ds_read_b64_tr_b16 v[58:59], v10 offset:4608
    v_add_u32 v9, 32768, v9
    ds_read_b128 v[32:35], v9 offset:0
    v_mfma_f32_16x16x32_bf16 v[196:199], v[44:47], v[24:27], 0
    ds_read_b64_tr_b16 v[60:61], v11 offset:4096
    v_mfma_f32_16x16x32_bf16 v[204:207], v[44:47], v[28:31], 0
    ds_read_b64_tr_b16 v[62:63], v11 offset:4608
    ds_read_b128 v[36:39], v9 offset:2048
    s_waitcnt lgkmcnt(6)
    v_mfma_f32_16x16x32_bf16 v[208:211], v[48:51], v[24:27], 0
    ds_read_b64_tr_b16 v[40:41], v12 offset:4096
    v_mfma_f32_16x16x32_bf16 v[216:219], v[48:51], v[28:31], 0
    ds_read_b64_tr_b16 v[42:43], v12 offset:4608
    v_mfma_f32_16x16x32_bf16 v[212:215], v[52:55], v[24:27], 0
    ds_read_b64_tr_b16 v[44:45], v13 offset:4096
    v_mfma_f32_16x16x32_bf16 v[220:223], v[52:55], v[28:31], 0
    ds_read_b64_tr_b16 v[46:47], v13 offset:4608
    s_waitcnt lgkmcnt(4)
    v_mfma_f32_16x16x32_bf16 v[192:195], v[56:59], v[32:35], v[192:195]
    v_add_u32 v10, 32768, v10
    ds_read_b64_tr_b16 v[48:49], v10 offset:0
    v_mfma_f32_16x16x32_bf16 v[200:203], v[56:59], v[36:39], v[200:203]
    ds_read_b64_tr_b16 v[50:51], v10 offset:512
    v_add_u32 v8, 32768, v8
    ds_read_b128 v[24:27], v8 offset:0
    v_mfma_f32_16x16x32_bf16 v[196:199], v[60:63], v[32:35], v[196:199]
    v_add_u32 v11, 32768, v11
    ds_read_b64_tr_b16 v[52:53], v11 offset:0
    v_mfma_f32_16x16x32_bf16 v[204:207], v[60:63], v[36:39], v[204:207]
    ds_read_b64_tr_b16 v[54:55], v11 offset:512
    ds_read_b128 v[28:31], v8 offset:2048
    s_waitcnt lgkmcnt(6)
    v_mfma_f32_16x16x32_bf16 v[208:211], v[40:43], v[32:35], v[208:211]
    v_add_u32 v12, 32768, v12
    ds_read_b64_tr_b16 v[56:57], v12 offset:0
    v_mfma_f32_16x16x32_bf16 v[216:219], v[40:43], v[36:39], v[216:219]
    ds_read_b64_tr_b16 v[58:59], v12 offset:512
    v_mfma_f32_16x16x32_bf16 v[212:215], v[44:47], v[32:35], v[212:215]
    v_add_u32 v13, 32768, v13
    ds_read_b64_tr_b16 v[60:61], v13 offset:0
    v_mfma_f32_16x16x32_bf16 v[220:223], v[44:47], v[36:39], v[220:223]
    ds_read_b64_tr_b16 v[62:63], v13 offset:512
    s_waitcnt lgkmcnt(4)
    v_mfma_f32_16x16x32_bf16 v[192:195], v[48:51], v[24:27], v[192:195]
    ds_read_b64_tr_b16 v[40:41], v10 offset:4096
    v_mfma_f32_16x16x32_bf16 v[200:203], v[48:51], v[28:31], v[200:203]
    ds_read_b64_tr_b16 v[42:43], v10 offset:4608
    v_add_u32 v9, 32768, v9
    ds_read_b128 v[32:35], v9 offset:0
    v_mfma_f32_16x16x32_bf16 v[196:199], v[52:55], v[24:27], v[196:199]
    ds_read_b64_tr_b16 v[44:45], v11 offset:4096
    v_mfma_f32_16x16x32_bf16 v[204:207], v[52:55], v[28:31], v[204:207]
    ds_read_b64_tr_b16 v[46:47], v11 offset:4608
    ds_read_b128 v[36:39], v9 offset:2048
    s_waitcnt lgkmcnt(6)
    v_mfma_f32_16x16x32_bf16 v[208:211], v[56:59], v[24:27], v[208:211]
    ds_read_b64_tr_b16 v[48:49], v12 offset:4096
    v_mfma_f32_16x16x32_bf16 v[216:219], v[56:59], v[28:31], v[216:219]
    ds_read_b64_tr_b16 v[50:51], v12 offset:4608
    v_mfma_f32_16x16x32_bf16 v[212:215], v[60:63], v[24:27], v[212:215]
    ds_read_b64_tr_b16 v[52:53], v13 offset:4096
    v_mfma_f32_16x16x32_bf16 v[220:223], v[60:63], v[28:31], v[220:223]
    ds_read_b64_tr_b16 v[54:55], v13 offset:4608
    s_waitcnt lgkmcnt(4)
    v_mfma_f32_16x16x32_bf16 v[192:195], v[40:43], v[32:35], v[192:195]
    v_add_u32 v10, -131072, v10
    ds_read_b64_tr_b16 v[56:57], v10 offset:0
    v_mfma_f32_16x16x32_bf16 v[200:203], v[40:43], v[36:39], v[200:203]
    ds_read_b64_tr_b16 v[58:59], v10 offset:512
    v_add_u32 v8, -131072, v8
    ds_read_b128 v[24:27], v8 offset:0
    v_mfma_f32_16x16x32_bf16 v[196:199], v[44:47], v[32:35], v[196:199]
    v_add_u32 v11, -131072, v11
    ds_read_b64_tr_b16 v[60:61], v11 offset:0
    v_mfma_f32_16x16x32_bf16 v[204:207], v[44:47], v[36:39], v[204:207]
    ds_read_b64_tr_b16 v[62:63], v11 offset:512
    ds_read_b128 v[28:31], v8 offset:2048
    s_waitcnt lgkmcnt(6)
    v_mfma_f32_16x16x32_bf16 v[208:211], v[48:51], v[32:35], v[208:211]
    v_add_u32 v12, -131072, v12
    ds_read_b64_tr_b16 v[40:41], v12 offset:0
    v_mfma_f32_16x16x32_bf16 v[216:219], v[48:51], v[36:39], v[216:219]
    ds_read_b64_tr_b16 v[42:43], v12 offset:512
    buffer_load_dwordx4 v[80:83], v240, s[12:15], s35 offen sc1
    s_add_u32 s35, s35, 4096
    v_mfma_f32_16x16x32_bf16 v[212:215], v[52:55], v[32:35], v[212:215]
    v_add_u32 v13, -131072, v13
    ds_read_b64_tr_b16 v[44:45], v13 offset:0
    v_mfma_f32_16x16x32_bf16 v[220:223], v[52:55], v[36:39], v[220:223]
    ds_read_b64_tr_b16 v[46:47], v13 offset:512
    buffer_load_dwordx4 v[84:87], v240, s[12:15], s35 offen sc1
    s_add_u32 s35, s35, 4096
    s_waitcnt lgkmcnt(4)
    v_mfma_f32_16x16x32_bf16 v[192:195], v[56:59], v[24:27], v[192:195]
    ds_read_b64_tr_b16 v[48:49], v10 offset:4096
    v_mfma_f32_16x16x32_bf16 v[200:203], v[56:59], v[28:31], v[200:203]
    ds_read_b64_tr_b16 v[50:51], v10 offset:4608
    v_add_u32 v9, -131072, v9
    ds_read_b128 v[32:35], v9 offset:0
    buffer_load_dwordx4 v[88:91], v240, s[12:15], s35 offen sc1
    v_mfma_f32_16x16x32_bf16 v[196:199], v[60:63], v[24:27], v[196:199]
    ds_read_b64_tr_b16 v[52:53], v11 offset:4096
    v_mfma_f32_16x16x32_bf16 v[204:207], v[60:63], v[28:31], v[204:207]
    ds_read_b64_tr_b16 v[54:55], v11 offset:4608
    ds_read_b128 v[36:39], v9 offset:2048
    buffer_load_dwordx4 v[92:95], v241, s[12:15], s35 offen sc1
    s_sub_u32 s35, s35, 8192
    s_waitcnt lgkmcnt(6)
    v_mfma_f32_16x16x32_bf16 v[208:211], v[40:43], v[24:27], v[208:211]
    ds_read_b64_tr_b16 v[56:57], v12 offset:4096
    v_mfma_f32_16x16x32_bf16 v[216:219], v[40:43], v[28:31], v[216:219]
    ds_read_b64_tr_b16 v[58:59], v12 offset:4608
    v_mfma_f32_16x16x32_bf16 v[212:215], v[44:47], v[24:27], v[212:215]
    ds_read_b64_tr_b16 v[60:61], v13 offset:4096
    v_mfma_f32_16x16x32_bf16 v[220:223], v[44:47], v[28:31], v[220:223]
    ds_read_b64_tr_b16 v[62:63], v13 offset:4608
    s_waitcnt lgkmcnt(4)
    v_mfma_f32_16x16x32_bf16 v[192:195], v[48:51], v[32:35], v[192:195]
    v_add_u32 v10, 32768, v10
    ds_read_b64_tr_b16 v[40:41], v10 offset:0
    v_mfma_f32_16x16x32_bf16 v[200:203], v[48:51], v[36:39], v[200:203]
    ds_read_b64_tr_b16 v[42:43], v10 offset:512
    v_add_u32 v8, 32768, v8
    ds_read_b128 v[24:27], v8 offset:0
    v_mfma_f32_16x16x32_bf16 v[196:199], v[52:55], v[32:35], v[196:199]
    v_add_u32 v11, 32768, v11
    ds_read_b64_tr_b16 v[44:45], v11 offset:0
    v_mfma_f32_16x16x32_bf16 v[204:207], v[52:55], v[36:39], v[204:207]
    ds_read_b64_tr_b16 v[46:47], v11 offset:512
    ds_read_b128 v[28:31], v8 offset:2048
    s_waitcnt lgkmcnt(6)
    v_mfma_f32_16x16x32_bf16 v[208:211], v[56:59], v[32:35], v[208:211]
    v_add_u32 v12, 32768, v12
    ds_read_b64_tr_b16 v[48:49], v12 offset:0
    v_mfma_f32_16x16x32_bf16 v[216:219], v[56:59], v[36:39], v[216:219]
    ds_read_b64_tr_b16 v[50:51], v12 offset:512
    v_mfma_f32_16x16x32_bf16 v[212:215], v[60:63], v[32:35], v[212:215]
    v_add_u32 v13, 32768, v13
    ds_read_b64_tr_b16 v[52:53], v13 offset:0
    v_mfma_f32_16x16x32_bf16 v[220:223], v[60:63], v[36:39], v[220:223]
    ds_read_b64_tr_b16 v[54:55], v13 offset:512
    s_waitcnt lgkmcnt(4)
    v_mfma_f32_16x16x32_bf16 v[192:195], v[40:43], v[24:27], v[192:195]
    ds_read_b64_tr_b16 v[56:57], v10 offset:4096
    v_mfma_f32_16x16x32_bf16 v[200:203], v[40:43], v[28:31], v[200:203]
    ds_read_b64_tr_b16 v[58:59], v10 offset:4608
    v_add_u32 v9, 32768, v9
    ds_read_b128 v[32:35], v9 offset:0
    v_mfma_f32_16x16x32_bf16 v[196:199], v[44:47], v[24:27], v[196:199]
    ds_read_b64_tr_b16 v[60:61], v11 offset:4096
    v_mfma_f32_16x16x32_bf16 v[204:207], v[44:47], v[28:31], v[204:207]
    ds_read_b64_tr_b16 v[62:63], v11 offset:4608
    ds_read_b128 v[36:39], v9 offset:2048
    s_waitcnt lgkmcnt(6)
    v_mfma_f32_16x16x32_bf16 v[208:211], v[48:51], v[24:27], v[208:211]
    ds_read_b64_tr_b16 v[40:41], v12 offset:4096
    v_mfma_f32_16x16x32_bf16 v[216:219], v[48:51], v[28:31], v[216:219]
    ds_read_b64_tr_b16 v[42:43], v12 offset:4608
    v_mfma_f32_16x16x32_bf16 v[212:215], v[52:55], v[24:27], v[212:215]
    ds_read_b64_tr_b16 v[44:45], v13 offset:4096
    v_mfma_f32_16x16x32_bf16 v[220:223], v[52:55], v[28:31], v[220:223]
    ds_read_b64_tr_b16 v[46:47], v13 offset:4608
    s_waitcnt lgkmcnt(4)
    v_mfma_f32_16x16x32_bf16 v[192:195], v[56:59], v[32:35], v[192:195]
    v_add_u32 v10, 32768, v10
    ds_read_b64_tr_b16 v[48:49], v10 offset:0
    v_mfma_f32_16x16x32_bf16 v[200:203], v[56:59], v[36:39], v[200:203]
    ds_read_b64_tr_b16 v[50:51], v10 offset:512
    v_add_u32 v8, 32768, v8
    ds_read_b128 v[24:27], v8 offset:0
    v_mfma_f32_16x16x32_bf16 v[196:199], v[60:63], v[32:35], v[196:199]
    v_add_u32 v11, 32768, v11
    ds_read_b64_tr_b16 v[52:53], v11 offset:0
    v_mfma_f32_16x16x32_bf16 v[204:207], v[60:63], v[36:39], v[204:207]
    ds_read_b64_tr_b16 v[54:55], v11 offset:512
    ds_read_b128 v[28:31], v8 offset:2048
    s_waitcnt lgkmcnt(6)
    v_mfma_f32_16x16x32_bf16 v[208:211], v[40:43], v[32:35], v[208:211]
    v_add_u32 v12, 32768, v12
    ds_read_b64_tr_b16 v[56:57], v12 offset:0
    v_mfma_f32_16x16x32_bf16 v[216:219], v[40:43], v[36:39], v[216:219]
    ds_read_b64_tr_b16 v[58:59], v12 offset:512
    s_branch L_z_chk
L_z_poll:
    buffer_load_dwordx4 v[80:83], v240, s[12:15], s35 offen sc1
    s_add_u32 s35, s35, 4096
    buffer_load_dwordx4 v[84:87], v240, s[12:15], s35 offen sc1
    s_add_u32 s35, s35, 4096
    buffer_load_dwordx4 v[88:91], v240, s[12:15], s35 offen sc1
    buffer_load_dwordx4 v[92:95], v241, s[12:15], s35 offen sc1
    s_sub_u32 s35, s35, 8192
L_z_chk:
    s_add_u32 s33, s33, 1
    s_waitcnt vmcnt(0)
    v_xor_b32 v78, v82, v74
    v_xor_b32 v79, v83, v75
    v_or_b32 v78, v78, v79
    v_xor_b32 v79, v86, v74
    v_xor_b32 v72, v87, v75
    v_or3_b32 v78, v78, v79, v72
    v_xor_b32 v79, v90, v74
    v_xor_b32 v72, v91, v75
    v_or3_b32 v78, v78, v79, v72
    v_xor_b32 v79, v94, v74
    v_xor_b32 v72, v95, v75
    v_or3_b32 v78, v78, v79, v72
    v_cmp_ne_u32 vcc, 0, v78
    s_cmp_gt_u32 s33, 262144
    s_cbranch_scc1 L_z_polled
    s_cbranch_vccnz L_z_poll
L_z_polled:
    v_add_f32 v72, v80, v84
    v_add_f32 v72, v72, v88
    v_fma_f32 v72, v92, 0.5, v72
    v_mov_b32 v73, v72
    v_mov_b32 v79, 0x43000000
    s_nop 0
    v_permlane16_swap_b32 v72, v73
    v_add_f32 v72, v72, v73
    v_mul_f32 v72, 0x3e124925, v72
    v_sub_f32 v80, v80, v72
    v_sub_f32 v84, v84, v72
    v_sub_f32 v88, v88, v72
    v_sub_f32 v92, v92, v72
    v_mul_f32 v80, v80, v80
    v_mul_f32 v84, v84, v84
    v_mul_f32 v88, v88, v88
    v_mul_f32 v92, v92, v92
    v_fma_f32 v81, v80, v79, v81
    v_fma_f32 v85, v84, v79, v85
    v_fma_f32 v89, v88, v79, v89
    v_fma_f32 v93, v92, v79, v93
    v_add_f32 v78, v81, v85
    v_add_f32 v78, v78, v89
    v_fma_f32 v78, v93, 0.5, v78
    v_mov_b32 v79, v78
    v_mov_b32 v81, 0x3727c5ac
    v_mov_b32 v80, 0x3a924925
    v_permlane16_swap_b32 v78, v79
    v_add_f32 v78, v78, v79
    v_fma_f32 v78, v78, v80, v81
    v_rsq_f32 v78, v78
    s_nop 0
    v_mul_f32 v72, v72, v78
    v_mov_b32 v79, v78
    v_mov_b32 v73, v72
    s_nop 0
    v_permlane32_swap_b32 v78, v79
    v_permlane32_swap_b32 v72, v73
    v_pk_fma_f32 v[128:129], v[128:129], v[78:79], v[72:73] op_sel_hi:[1,0,0] neg_lo:[0,0,1] neg_hi:[0,0,1]
    v_pk_fma_f32 v[130:131], v[130:131], v[78:79], v[72:73] op_sel_hi:[1,0,0] neg_lo:[0,0,1] neg_hi:[0,0,1]
    v_pk_fma_f32 v[132:133], v[132:133], v[78:79], v[72:73] op_sel_hi:[1,0,0] neg_lo:[0,0,1] neg_hi:[0,0,1]
    v_pk_fma_f32 v[134:135], v[134:135], v[78:79], v[72:73] op_sel_hi:[1,0,0] neg_lo:[0,0,1] neg_hi:[0,0,1]
    v_pk_fma_f32 v[136:137], v[136:137], v[78:79], v[72:73] op_sel:[0,1,1] op_sel_hi:[1,1,1] neg_lo:[0,0,1] neg_hi:[0,0,1]
    v_pk_fma_f32 v[138:139], v[138:139], v[78:79], v[72:73] op_sel:[0,1,1] op_sel_hi:[1,1,1] neg_lo:[0,0,1] neg_hi:[0,0,1]
    v_pk_fma_f32 v[140:141], v[140:141], v[78:79], v[72:73] op_sel:[0,1,1] op_sel_hi:[1,1,1] neg_lo:[0,0,1] neg_hi:[0,0,1]
    v_pk_fma_f32 v[142:143], v[142:143], v[78:79], v[72:73] op_sel:[0,1,1] op_sel_hi:[1,1,1] neg_lo:[0,0,1] neg_hi:[0,0,1]
    v_cvt_pk_bf16_f32 v128, v128, v129
    v_cvt_pk_bf16_f32 v129, v130, v131
    v_cvt_pk_bf16_f32 v130, v132, v133
    v_cvt_pk_bf16_f32 v131, v134, v135
    v_cvt_pk_bf16_f32 v132, v136, v137
    v_cvt_pk_bf16_f32 v133, v138, v139
    v_cvt_pk_bf16_f32 v134, v140, v141
    v_cvt_pk_bf16_f32 v135, v142, v143
    ds_write_b128 v244, v[128:131] offset:0
    ds_write_b128 v244, v[132:135] offset:2048
    ds_read_b64_tr_b16 v[136:137], v248 offset:0
    ds_read_b64_tr_b16 v[138:139], v249 offset:512
    ds_read_b64_tr_b16 v[140:141], v248 offset:8
    ds_read_b64_tr_b16 v[142:143], v249 offset:520
    v_pk_fma_f32 v[144:145], v[144:145], v[78:79], v[72:73] op_sel_hi:[1,0,0] neg_lo:[0,0,1] neg_hi:[0,0,1]
    v_pk_fma_f32 v[146:147], v[146:147], v[78:79], v[72:73] op_sel_hi:[1,0,0] neg_lo:[0,0,1] neg_hi:[0,0,1]
    v_pk_fma_f32 v[148:149], v[148:149], v[78:79], v[72:73] op_sel_hi:[1,0,0] neg_lo:[0,0,1] neg_hi:[0,0,1]
    v_pk_fma_f32 v[150:151], v[150:151], v[78:79], v[72:73] op_sel_hi:[1,0,0] neg_lo:[0,0,1] neg_hi:[0,0,1]
    v_pk_fma_f32 v[152:153], v[152:153], v[78:79], v[72:73] op_sel:[0,1,1] op_sel_hi:[1,1,1] neg_lo:[0,0,1] neg_hi:[0,0,1]
    v_pk_fma_f32 v[154:155], v[154:155], v[78:79], v[72:73] op_sel:[0,1,1] op_sel_hi:[1,1,1] neg_lo:[0,0,1] neg_hi:[0,0,1]
    v_pk_fma_f32 v[156:157], v[156:157], v[78:79], v[72:73] op_sel:[0,1,1] op_sel_hi:[1,1,1] neg_lo:[0,0,1] neg_hi:[0,0,1]
    v_pk_fma_f32 v[158:159], v[158:159], v[78:79], v[72:73] op_sel:[0,1,1] op_sel_hi:[1,1,1] neg_lo:[0,0,1] neg_hi:[0,0,1]
    v_cvt_pk_bf16_f32 v144, v144, v145
    v_cvt_pk_bf16_f32 v145, v146, v147
    v_cvt_pk_bf16_f32 v146, v148, v149
    v_cvt_pk_bf16_f32 v147, v150, v151
    v_cvt_pk_bf16_f32 v148, v152, v153
    v_cvt_pk_bf16_f32 v149, v154, v155
    v_cvt_pk_bf16_f32 v150, v156, v157
    v_cvt_pk_bf16_f32 v151, v158, v159
    ds_write_b128 v245, v[144:147] offset:0
    ds_write_b128 v245, v[148:151] offset:2048
    ds_read_b64_tr_b16 v[152:153], v250 offset:0
    ds_read_b64_tr_b16 v[154:155], v251 offset:512
    ds_read_b64_tr_b16 v[156:157], v250 offset:8
    ds_read_b64_tr_b16 v[158:159], v251 offset:520
    s_waitcnt lgkmcnt(6)
    buffer_store_dwordx4 v[136:139], v2, s[12:15], s25 offen offset:0 sc1
    buffer_store_dwordx4 v[140:143], v2, s[12:15], s25 offen offset:1024 sc1
    s_add_u32 s25, s25, 131072
    v_pk_fma_f32 v[160:161], v[160:161], v[78:79], v[72:73] op_sel_hi:[1,0,0] neg_lo:[0,0,1] neg_hi:[0,0,1]
    v_pk_fma_f32 v[162:163], v[162:163], v[78:79], v[72:73] op_sel_hi:[1,0,0] neg_lo:[0,0,1] neg_hi:[0,0,1]
    v_pk_fma_f32 v[164:165], v[164:165], v[78:79], v[72:73] op_sel_hi:[1,0,0] neg_lo:[0,0,1] neg_hi:[0,0,1]
    v_pk_fma_f32 v[166:167], v[166:167], v[78:79], v[72:73] op_sel_hi:[1,0,0] neg_lo:[0,0,1] neg_hi:[0,0,1]
    v_pk_fma_f32 v[168:169], v[168:169], v[78:79], v[72:73] op_sel:[0,1,1] op_sel_hi:[1,1,1] neg_lo:[0,0,1] neg_hi:[0,0,1]
    v_pk_fma_f32 v[170:171], v[170:171], v[78:79], v[72:73] op_sel:[0,1,1] op_sel_hi:[1,1,1] neg_lo:[0,0,1] neg_hi:[0,0,1]
    v_pk_fma_f32 v[172:173], v[172:173], v[78:79], v[72:73] op_sel:[0,1,1] op_sel_hi:[1,1,1] neg_lo:[0,0,1] neg_hi:[0,0,1]
    v_pk_fma_f32 v[174:175], v[174:175], v[78:79], v[72:73] op_sel:[0,1,1] op_sel_hi:[1,1,1] neg_lo:[0,0,1] neg_hi:[0,0,1]
    v_cvt_pk_bf16_f32 v160, v160, v161
    v_cvt_pk_bf16_f32 v161, v162, v163
    v_cvt_pk_bf16_f32 v162, v164, v165
    v_cvt_pk_bf16_f32 v163, v166, v167
    v_cvt_pk_bf16_f32 v164, v168, v169
    v_cvt_pk_bf16_f32 v165, v170, v171
    v_cvt_pk_bf16_f32 v166, v172, v173
    v_cvt_pk_bf16_f32 v167, v174, v175
    ds_write_b128 v244, v[160:163] offset:0
    ds_write_b128 v244, v[164:167] offset:2048
    ds_read_b64_tr_b16 v[168:169], v248 offset:0
    ds_read_b64_tr_b16 v[170:171], v249 offset:512
    ds_read_b64_tr_b16 v[172:173], v248 offset:8
    ds_read_b64_tr_b16 v[174:175], v249 offset:520
    s_waitcnt lgkmcnt(6)
    buffer_store_dwordx4 v[152:155], v2, s[12:15], s25 offen offset:0 sc1
    buffer_store_dwordx4 v[156:159], v2, s[12:15], s25 offen offset:1024 sc1
    s_add_u32 s25, s25, 131072
    v_pk_fma_f32 v[176:177], v[176:177], v[78:79], v[72:73] op_sel_hi:[1,0,0] neg_lo:[0,0,1] neg_hi:[0,0,1]
    v_pk_fma_f32 v[178:179], v[178:179], v[78:79], v[72:73] op_sel_hi:[1,0,0] neg_lo:[0,0,1] neg_hi:[0,0,1]
    v_pk_fma_f32 v[180:181], v[180:181], v[78:79], v[72:73] op_sel_hi:[1,0,0] neg_lo:[0,0,1] neg_hi:[0,0,1]
    v_pk_fma_f32 v[182:183], v[182:183], v[78:79], v[72:73] op_sel_hi:[1,0,0] neg_lo:[0,0,1] neg_hi:[0,0,1]
    v_pk_fma_f32 v[184:185], v[184:185], v[78:79], v[72:73] op_sel:[0,1,1] op_sel_hi:[1,1,1] neg_lo:[0,0,1] neg_hi:[0,0,1]
    v_pk_fma_f32 v[186:187], v[186:187], v[78:79], v[72:73] op_sel:[0,1,1] op_sel_hi:[1,1,1] neg_lo:[0,0,1] neg_hi:[0,0,1]
    v_pk_fma_f32 v[188:189], v[188:189], v[78:79], v[72:73] op_sel:[0,1,1] op_sel_hi:[1,1,1] neg_lo:[0,0,1] neg_hi:[0,0,1]
    v_pk_fma_f32 v[190:191], v[190:191], v[78:79], v[72:73] op_sel:[0,1,1] op_sel_hi:[1,1,1] neg_lo:[0,0,1] neg_hi:[0,0,1]
    v_cvt_pk_bf16_f32 v176, v176, v177
    v_cvt_pk_bf16_f32 v177, v178, v179
    v_cvt_pk_bf16_f32 v178, v180, v181
    v_cvt_pk_bf16_f32 v179, v182, v183
    v_cvt_pk_bf16_f32 v180, v184, v185
    v_cvt_pk_bf16_f32 v181, v186, v187
    v_cvt_pk_bf16_f32 v182, v188, v189
    v_cvt_pk_bf16_f32 v183, v190, v191
    ds_write_b128 v245, v[176:179] offset:0
    ds_write_b128 v245, v[180:183] offset:2048
    ds_read_b64_tr_b16 v[184:185], v250 offset:0
    ds_read_b64_tr_b16 v[186:187], v251 offset:512
    ds_read_b64_tr_b16 v[188:189], v250 offset:8
    ds_read_b64_tr_b16 v[190:191], v251 offset:520
    s_waitcnt lgkmcnt(6)
    buffer_store_dwordx4 v[168:171], v2, s[12:15], s25 offen offset:0 sc1
    buffer_store_dwordx4 v[172:175], v2, s[12:15], s25 offen offset:1024 sc1
    s_add_u32 s25, s25, 131072
    s_waitcnt lgkmcnt(0)
    buffer_store_dwordx4 v[184:187], v2, s[12:15], s25 offen offset:0 sc1
    buffer_store_dwordx4 v[188:191], v2, s[12:15], s25 offen offset:1024 sc1
    v_and_b32 v4, 15, v1
    v_lshlrev_b32 v4, 2, v4
    s_lshl_b32 s23, s19, 9
    s_lshl_b32 s22, s17, 7
    s_add_u32 s23, s23, s22
    s_add_u32 s23, s23, 0x1610000
    buffer_load_dword v6, v4, s[12:15], s23 offen offset:0 sc1
    buffer_load_dword v7, v4, s[12:15], s23 offen offset:64 sc1
    v_mfma_f32_16x16x32_bf16 v[212:215], v[44:47], v[32:35], v[212:215]
    v_add_u32 v13, 32768, v13
    ds_read_b64_tr_b16 v[60:61], v13 offset:0
    v_mfma_f32_16x16x32_bf16 v[220:223], v[44:47], v[36:39], v[220:223]
    ds_read_b64_tr_b16 v[62:63], v13 offset:512
    s_waitcnt lgkmcnt(4)
    v_mfma_f32_16x16x32_bf16 v[192:195], v[48:51], v[24:27], v[192:195]
    ds_read_b64_tr_b16 v[40:41], v10 offset:4096
    v_mfma_f32_16x16x32_bf16 v[200:203], v[48:51], v[28:31], v[200:203]
    ds_read_b64_tr_b16 v[42:43], v10 offset:4608
    v_add_u32 v9, 32768, v9
    ds_read_b128 v[32:35], v9 offset:0
    v_mfma_f32_16x16x32_bf16 v[196:199], v[52:55], v[24:27], v[196:199]
    ds_read_b64_tr_b16 v[44:45], v11 offset:4096
    v_mfma_f32_16x16x32_bf16 v[204:207], v[52:55], v[28:31], v[204:207]
    ds_read_b64_tr_b16 v[46:47], v11 offset:4608
    ds_read_b128 v[36:39], v9 offset:2048
    s_waitcnt lgkmcnt(6)
    v_mfma_f32_16x16x32_bf16 v[208:211], v[56:59], v[24:27], v[208:211]
    ds_read_b64_tr_b16 v[48:49], v12 offset:4096
    v_mfma_f32_16x16x32_bf16 v[216:219], v[56:59], v[28:31], v[216:219]
    ds_read_b64_tr_b16 v[50:51], v12 offset:4608
    v_mfma_f32_16x16x32_bf16 v[212:215], v[60:63], v[24:27], v[212:215]
    ds_read_b64_tr_b16 v[52:53], v13 offset:4096
    v_mfma_f32_16x16x32_bf16 v[220:223], v[60:63], v[28:31], v[220:223]
    ds_read_b64_tr_b16 v[54:55], v13 offset:4608
    s_waitcnt lgkmcnt(4)
    v_mfma_f32_16x16x32_bf16 v[192:195], v[40:43], v[32:35], v[192:195]
    v_add_u32 v10, 32768, v10
    ds_read_b64_tr_b16 v[56:57], v10 offset:8192
    v_mfma_f32_16x16x32_bf16 v[200:203], v[40:43], v[36:39], v[200:203]
    ds_read_b64_tr_b16 v[58:59], v10 offset:8704
    v_mfma_f32_16x16x32_bf16 v[196:199], v[44:47], v[32:35], v[196:199]
    v_add_u32 v11, 32768, v11
    ds_read_b64_tr_b16 v[60:61], v11 offset:8192
    v_mfma_f32_16x16x32_bf16 v[204:207], v[44:47], v[36:39], v[204:207]
    ds_read_b64_tr_b16 v[62:63], v11 offset:8704
    s_waitcnt lgkmcnt(4)
    v_mfma_f32_16x16x32_bf16 v[208:211], v[48:51], v[32:35], v[208:211]
    v_add_u32 v12, 32768, v12
    ds_read_b64_tr_b16 v[40:41], v12 offset:8192
    v_mfma_f32_16x16x32_bf16 v[216:219], v[48:51], v[36:39], v[216:219]
    ds_read_b64_tr_b16 v[42:43], v12 offset:8704
    v_mfma_f32_16x16x32_bf16 v[212:215], v[52:55], v[32:35], v[212:215]
    v_add_u32 v13, 32768, v13
    ds_read_b64_tr_b16 v[44:45], v13 offset:8192
    v_mfma_f32_16x16x32_bf16 v[220:223], v[52:55], v[36:39], v[220:223]
    ds_read_b64_tr_b16 v[46:47], v13 offset:8704
    s_waitcnt lgkmcnt(4)
    v_mfma_f32_16x16x32_bf16 v[192:195], v[56:59], v[96:99], v[192:195]
    ds_read_b64_tr_b16 v[48:49], v10 offset:12288
    v_mfma_f32_16x16x32_bf16 v[200:203], v[56:59], v[100:103], v[200:203]
    ds_read_b64_tr_b16 v[50:51], v10 offset:12800
    v_mfma_f32_16x16x32_bf16 v[196:199], v[60:63], v[96:99], v[196:199]
    ds_read_b64_tr_b16 v[52:53], v11 offset:12288
    v_mfma_f32_16x16x32_bf16 v[204:207], v[60:63], v[100:103], v[204:207]
    ds_read_b64_tr_b16 v[54:55], v11 offset:12800
    s_waitcnt lgkmcnt(4)
    v_mfma_f32_16x16x32_bf16 v[208:211], v[40:43], v[96:99], v[208:211]
    ds_read_b64_tr_b16 v[56:57], v12 offset:12288
    v_mfma_f32_16x16x32_bf16 v[216:219], v[40:43], v[100:103], v[216:219]
    ds_read_b64_tr_b16 v[58:59], v12 offset:12800
    v_mfma_f32_16x16x32_bf16 v[212:215], v[44:47], v[96:99], v[212:215]
    ds_read_b64_tr_b16 v[60:61], v13 offset:12288
    v_mfma_f32_16x16x32_bf16 v[220:223], v[44:47], v[100:103], v[220:223]
    ds_read_b64_tr_b16 v[62:63], v13 offset:12800
    s_waitcnt lgkmcnt(4)
    v_mfma_f32_16x16x32_bf16 v[192:195], v[48:51], v[104:107], v[192:195]
    v_add_u32 v10, 32768, v10
    ds_read_b64_tr_b16 v[40:41], v10 offset:8192
    v_mfma_f32_16x16x32_bf16 v[200:203], v[48:51], v[108:111], v[200:203]
    ds_read_b64_tr_b16 v[42:43], v10 offset:8704
    v_mfma_f32_16x16x32_bf16 v[196:199], v[52:55], v[104:107], v[196:199]
    v_add_u32 v11, 32768, v11
    ds_read_b64_tr_b16 v[44:45], v11 offset:8192
    v_mfma_f32_16x16x32_bf16 v[204:207], v[52:55], v[108:111], v[204:207]
    ds_read_b64_tr_b16 v[46:47], v11 offset:8704
    s_waitcnt lgkmcnt(4)
    v_mfma_f32_16x16x32_bf16 v[208:211], v[56:59], v[104:107], v[208:211]
    v_add_u32 v12, 32768, v12
    ds_read_b64_tr_b16 v[48:49], v12 offset:8192
    v_mfma_f32_16x16x32_bf16 v[216:219], v[56:59], v[108:111], v[216:219]
    ds_read_b64_tr_b16 v[50:51], v12 offset:8704
    v_mfma_f32_16x16x32_bf16 v[212:215], v[60:63], v[104:107], v[212:215]
    v_add_u32 v13, 32768, v13
    ds_read_b64_tr_b16 v[52:53], v13 offset:8192
    v_mfma_f32_16x16x32_bf16 v[220:223], v[60:63], v[108:111], v[220:223]
    ds_read_b64_tr_b16 v[54:55], v13 offset:8704
    s_waitcnt lgkmcnt(4)
    v_mfma_f32_16x16x32_bf16 v[192:195], v[40:43], v[112:115], v[192:195]
    ds_read_b64_tr_b16 v[56:57], v10 offset:12288
    v_mfma_f32_16x16x32_bf16 v[200:203], v[40:43], v[116:119], v[200:203]
    ds_read_b64_tr_b16 v[58:59], v10 offset:12800
    v_mfma_f32_16x16x32_bf16 v[196:199], v[44:47], v[112:115], v[196:199]
    ds_read_b64_tr_b16 v[60:61], v11 offset:12288
    v_mfma_f32_16x16x32_bf16 v[204:207], v[44:47], v[116:119], v[204:207]
    ds_read_b64_tr_b16 v[62:63], v11 offset:12800
    s_waitcnt lgkmcnt(4)
    v_mfma_f32_16x16x32_bf16 v[208:211], v[48:51], v[112:115], v[208:211]
    ds_read_b64_tr_b16 v[40:41], v12 offset:12288
    v_mfma_f32_16x16x32_bf16 v[216:219], v[48:51], v[116:119], v[216:219]
    ds_read_b64_tr_b16 v[42:43], v12 offset:12800
    v_mfma_f32_16x16x32_bf16 v[212:215], v[52:55], v[112:115], v[212:215]
    ds_read_b64_tr_b16 v[44:45], v13 offset:12288
    v_mfma_f32_16x16x32_bf16 v[220:223], v[52:55], v[116:119], v[220:223]
    ds_read_b64_tr_b16 v[46:47], v13 offset:12800
    s_waitcnt lgkmcnt(4)
    v_mfma_f32_16x16x32_bf16 v[192:195], v[56:59], v[120:123], v[192:195]
    v_add_u32 v10, -131072, v10
    ds_read_b64_tr_b16 v[48:49], v10 offset:8192
    v_mfma_f32_16x16x32_bf16 v[200:203], v[56:59], v[124:127], v[200:203]
    ds_read_b64_tr_b16 v[50:51], v10 offset:8704
    s_mul_i32 s23, s20, 16
    s_add_u32 s23, s23, s19
    s_lshl_b32 s23, s23, 7
    s_add_u32 s23, s23, 0x1680000
    s_waitcnt vmcnt(0)
    s_barrier
    s_cmp_lg_u32 s16, 0
    s_cbranch_scc1 L_of7
    v_mov_b32 v4, s28
    v_mov_b32 v5, 0
    s_mov_b64 exec, 1
    buffer_store_dword v4, v5, s[12:15], s23 offen sc1
    s_mov_b64 exec, -1
L_of7:
    v_mfma_f32_16x16x32_bf16 v[196:199], v[60:63], v[120:123], v[196:199]
    v_add_u32 v11, -131072, v11
    ds_read_b64_tr_b16 v[52:53], v11 offset:8192
    v_mfma_f32_16x16x32_bf16 v[204:207], v[60:63], v[124:127], v[204:207]
    ds_read_b64_tr_b16 v[54:55], v11 offset:8704
    s_waitcnt lgkmcnt(4)
    v_mfma_f32_16x16x32_bf16 v[208:211], v[40:43], v[120:123], v[208:211]
    v_add_u32 v12, -131072, v12
    ds_read_b64_tr_b16 v[56:57], v12 offset:8192
    v_mfma_f32_16x16x32_bf16 v[216:219], v[40:43], v[124:127], v[216:219]
    ds_read_b64_tr_b16 v[58:59], v12 offset:8704
    v_mfma_f32_16x16x32_bf16 v[212:215], v[44:47], v[120:123], v[212:215]
    v_add_u32 v13, -131072, v13
    ds_read_b64_tr_b16 v[60:61], v13 offset:8192
    v_mfma_f32_16x16x32_bf16 v[220:223], v[44:47], v[124:127], v[220:223]
    ds_read_b64_tr_b16 v[62:63], v13 offset:8704
    s_waitcnt lgkmcnt(4)
    v_mfma_f32_16x16x32_bf16 v[192:195], v[48:51], v[224:227], v[192:195]
    ds_read_b64_tr_b16 v[40:41], v10 offset:12288
    v_mfma_f32_16x16x32_bf16 v[200:203], v[48:51], v[228:231], v[200:203]
    ds_read_b64_tr_b16 v[42:43], v10 offset:12800
    v_mfma_f32_16x16x32_bf16 v[196:199], v[52:55], v[224:227], v[196:199]
    ds_read_b64_tr_b16 v[44:45], v11 offset:12288
    v_mfma_f32_16x16x32_bf16 v[204:207], v[52:55], v[228:231], v[204:207]
    ds_read_b64_tr_b16 v[46:47], v11 offset:12800
    s_waitcnt lgkmcnt(4)
    v_mfma_f32_16x16x32_bf16 v[208:211], v[56:59], v[224:227], v[208:211]
    ds_read_b64_tr_b16 v[48:49], v12 offset:12288
    v_mfma_f32_16x16x32_bf16 v[216:219], v[56:59], v[228:231], v[216:219]
    ds_read_b64_tr_b16 v[50:51], v12 offset:12800
    v_mfma_f32_16x16x32_bf16 v[212:215], v[60:63], v[224:227], v[212:215]
    ds_read_b64_tr_b16 v[52:53], v13 offset:12288
    v_mfma_f32_16x16x32_bf16 v[220:223], v[60:63], v[228:231], v[220:223]
    ds_read_b64_tr_b16 v[54:55], v13 offset:12800
    s_waitcnt lgkmcnt(4)
    v_mfma_f32_16x16x32_bf16 v[192:195], v[40:43], v[232:235], v[192:195]
    v_mfma_f32_16x16x32_bf16 v[200:203], v[40:43], v[236:239], v[200:203]
    v_mfma_f32_16x16x32_bf16 v[196:199], v[44:47], v[232:235], v[196:199]
    v_mfma_f32_16x16x32_bf16 v[204:207], v[44:47], v[236:239], v[204:207]
    s_waitcnt lgkmcnt(0)
    v_mfma_f32_16x16x32_bf16 v[208:211], v[48:51], v[232:235], v[208:211]
    v_mfma_f32_16x16x32_bf16 v[216:219], v[48:51], v[236:239], v[216:219]
    v_mfma_f32_16x16x32_bf16 v[212:215], v[52:55], v[232:235], v[212:215]
    v_mfma_f32_16x16x32_bf16 v[220:223], v[52:55], v[236:239], v[220:223]
    s_branch L_tail
L_cq:
    s_mul_i32 s23, s17, 40960
    s_add_u32 s23, s23, 32768
    v_add_u32 v84, s23, v2
    v_add_u32 v85, s23, v1
    s_lshl_b32 s25, s19, 2
    s_add_u32 s25, s25, s17
    s_lshl_b32 s25, s25, 4
    s_add_u32 s25, s25, s63
    s_lshl_b32 s25, s25, 11
    s_add_u32 s25, s25, 0x800000
    s_add_u32 s24, s25, 16384
    s_mul_i32 s26, s63, 16
    s_add_u32 s26, s26, s19
    s_lshl_b32 s26, s26, 7
    s_add_u32 s26, s26, 0x1684000
    s_barrier
    ds_read_b128 v[96:99], v8 offset:0
    ds_read_b128 v[100:103], v8 offset:2048
    ds_read_b64_tr_b16 v[40:41], v10 offset:0
    ds_read_b64_tr_b16 v[42:43], v10 offset:512
    ds_read_b64_tr_b16 v[44:45], v11 offset:0
    ds_read_b64_tr_b16 v[46:47], v11 offset:512
    ds_read_b64_tr_b16 v[48:49], v12 offset:0
    ds_read_b64_tr_b16 v[50:51], v12 offset:512
    ds_read_b64_tr_b16 v[52:53], v13 offset:0
    ds_read_b64_tr_b16 v[54:55], v13 offset:512
    s_waitcnt lgkmcnt(4)
    v_mfma_f32_16x16x32_bf16 v[160:163], v[96:99], v[40:43], 0
    ds_read_b64_tr_b16 v[56:57], v10 offset:8192
    v_mfma_f32_16x16x32_bf16 v[164:167], v[100:103], v[40:43], 0
    ds_read_b64_tr_b16 v[58:59], v10 offset:8704
    v_mfma_f32_16x16x32_bf16 v[168:171], v[96:99], v[44:47], 0
    ds_read_b64_tr_b16 v[60:61], v11 offset:8192
    v_mfma_f32_16x16x32_bf16 v[172:175], v[100:103], v[44:47], 0
    ds_read_b64_tr_b16 v[62:63], v11 offset:8704
    s_waitcnt lgkmcnt(4)
    v_mfma_f32_16x16x32_bf16 v[176:179], v[96:99], v[48:51], 0
    ds_read_b64_tr_b16 v[40:41], v12 offset:8192
    v_mfma_f32_16x16x32_bf16 v[180:183], v[100:103], v[48:51], 0
    ds_read_b64_tr_b16 v[42:43], v12 offset:8704
    v_mfma_f32_16x16x32_bf16 v[184:187], v[96:99], v[52:55], 0
    ds_read_b64_tr_b16 v[44:45], v13 offset:8192
    v_mfma_f32_16x16x32_bf16 v[188:191], v[100:103], v[52:55], 0
    ds_read_b64_tr_b16 v[46:47], v13 offset:8704
    s_waitcnt lgkmcnt(4)
    v_mfma_f32_16x16x32_bf16 v[192:195], v[96:99], v[56:59], 0
    ds_read_b64_tr_b16 v[48:49], v10 offset:16384
    v_mfma_f32_16x16x32_bf16 v[196:199], v[100:103], v[56:59], 0
    ds_read_b64_tr_b16 v[50:51], v10 offset:16896
    v_mfma_f32_16x16x32_bf16 v[200:203], v[96:99], v[60:63], 0
    ds_read_b64_tr_b16 v[52:53], v11 offset:16384
    v_mfma_f32_16x16x32_bf16 v[204:207], v[100:103], v[60:63], 0
    ds_read_b64_tr_b16 v[54:55], v11 offset:16896
    s_waitcnt lgkmcnt(4)
    v_mfma_f32_16x16x32_bf16 v[208:211], v[96:99], v[40:43], 0
    ds_read_b64_tr_b16 v[56:57], v12 offset:16384
    v_mfma_f32_16x16x32_bf16 v[212:215], v[100:103], v[40:43], 0
    ds_read_b64_tr_b16 v[58:59], v12 offset:16896
    v_mfma_f32_16x16x32_bf16 v[216:219], v[96:99], v[44:47], 0
    ds_read_b64_tr_b16 v[60:61], v13 offset:16384
    v_mfma_f32_16x16x32_bf16 v[220:223], v[100:103], v[44:47], 0
    ds_read_b64_tr_b16 v[62:63], v13 offset:16896
    s_waitcnt lgkmcnt(4)
    v_mfma_f32_16x16x32_bf16 v[128:131], v[48:51], v[96:99], 0
    ds_read_b64_tr_b16 v[40:41], v10 offset:4096
    v_mfma_f32_16x16x32_bf16 v[136:139], v[48:51], v[100:103], 0
    ds_read_b64_tr_b16 v[42:43], v10 offset:4608
    ds_read_b128 v[104:107], v9 offset:0
    v_mfma_f32_16x16x32_bf16 v[132:135], v[52:55], v[96:99], 0
    ds_read_b64_tr_b16 v[44:45], v11 offset:4096
    v_mfma_f32_16x16x32_bf16 v[140:143], v[52:55], v[100:103], 0
    ds_read_b64_tr_b16 v[46:47], v11 offset:4608
    ds_read_b128 v[108:111], v9 offset:2048
    s_waitcnt lgkmcnt(6)
    v_mfma_f32_16x16x32_bf16 v[144:147], v[56:59], v[96:99], 0
    ds_read_b64_tr_b16 v[48:49], v12 offset:4096
    v_mfma_f32_16x16x32_bf16 v[152:155], v[56:59], v[100:103], 0
    ds_read_b64_tr_b16 v[50:51], v12 offset:4608
    v_mfma_f32_16x16x32_bf16 v[148:151], v[60:63], v[96:99], 0
    ds_read_b64_tr_b16 v[52:53], v13 offset:4096
    v_mfma_f32_16x16x32_bf16 v[156:159], v[60:63], v[100:103], 0
    ds_read_b64_tr_b16 v[54:55], v13 offset:4608
    s_waitcnt lgkmcnt(4)
    v_mfma_f32_16x16x32_bf16 v[160:163], v[104:107], v[40:43], v[160:163]
    ds_read_b64_tr_b16 v[56:57], v10 offset:12288
    v_mfma_f32_16x16x32_bf16 v[164:167], v[108:111], v[40:43], v[164:167]
    ds_read_b64_tr_b16 v[58:59], v10 offset:12800
    v_mfma_f32_16x16x32_bf16 v[168:171], v[104:107], v[44:47], v[168:171]
    ds_read_b64_tr_b16 v[60:61], v11 offset:12288
    v_mfma_f32_16x16x32_bf16 v[172:175], v[108:111], v[44:47], v[172:175]
    ds_read_b64_tr_b16 v[62:63], v11 offset:12800
    s_waitcnt lgkmcnt(4)
    v_mfma_f32_16x16x32_bf16 v[176:179], v[104:107], v[48:51], v[176:179]
    ds_read_b64_tr_b16 v[40:41], v12 offset:12288
    v_mfma_f32_16x16x32_bf16 v[180:183], v[108:111], v[48:51], v[180:183]
    ds_read_b64_tr_b16 v[42:43], v12 offset:12800
    v_mfma_f32_16x16x32_bf16 v[184:187], v[104:107], v[52:55], v[184:187]
    ds_read_b64_tr_b16 v[44:45], v13 offset:12288
    v_mfma_f32_16x16x32_bf16 v[188:191], v[108:111], v[52:55], v[188:191]
    ds_read_b64_tr_b16 v[46:47], v13 offset:12800
    s_waitcnt lgkmcnt(4)
    v_mfma_f32_16x16x32_bf16 v[192:195], v[104:107], v[56:59], v[192:195]
    ds_read_b64_tr_b16 v[48:49], v10 offset:20480
    v_mfma_f32_16x16x32_bf16 v[196:199], v[108:111], v[56:59], v[196:199]
    ds_read_b64_tr_b16 v[50:51], v10 offset:20992
    v_mfma_f32_16x16x32_bf16 v[200:203], v[104:107], v[60:63], v[200:203]
    ds_read_b64_tr_b16 v[52:53], v11 offset:20480
    v_mfma_f32_16x16x32_bf16 v[204:207], v[108:111], v[60:63], v[204:207]
    ds_read_b64_tr_b16 v[54:55], v11 offset:20992
    s_waitcnt lgkmcnt(4)
    v_mfma_f32_16x16x32_bf16 v[208:211], v[104:107], v[40:43], v[208:211]
    ds_read_b64_tr_b16 v[56:57], v12 offset:20480
    v_mfma_f32_16x16x32_bf16 v[212:215], v[108:111], v[40:43], v[212:215]
    ds_read_b64_tr_b16 v[58:59], v12 offset:20992
    v_mfma_f32_16x16x32_bf16 v[216:219], v[104:107], v[44:47], v[216:219]
    ds_read_b64_tr_b16 v[60:61], v13 offset:20480
    v_mfma_f32_16x16x32_bf16 v[220:223], v[108:111], v[44:47], v[220:223]
    ds_read_b64_tr_b16 v[62:63], v13 offset:20992
    s_waitcnt lgkmcnt(4)
    v_mfma_f32_16x16x32_bf16 v[128:131], v[48:51], v[104:107], v[128:131]
    s_barrier
    v_add_u32 v10, 40960, v10
    ds_read_b64_tr_b16 v[40:41], v10 offset:0
    v_mfma_f32_16x16x32_bf16 v[136:139], v[48:51], v[108:111], v[136:139]
    ds_read_b64_tr_b16 v[42:43], v10 offset:512
    v_add_u32 v8, 40960, v8
    ds_read_b128 v[112:115], v8 offset:0
    v_mfma_f32_16x16x32_bf16 v[132:135], v[52:55], v[104:107], v[132:135]
    v_add_u32 v11, 40960, v11
    ds_read_b64_tr_b16 v[44:45], v11 offset:0
    v_mfma_f32_16x16x32_bf16 v[140:143], v[52:55], v[108:111], v[140:143]
    ds_read_b64_tr_b16 v[46:47], v11 offset:512
    ds_read_b128 v[116:119], v8 offset:2048
    s_waitcnt lgkmcnt(6)
    v_mfma_f32_16x16x32_bf16 v[144:147], v[56:59], v[104:107], v[144:147]
    v_add_u32 v12, 40960, v12
    ds_read_b64_tr_b16 v[48:49], v12 offset:0
    v_mfma_f32_16x16x32_bf16 v[152:155], v[56:59], v[108:111], v[152:155]
    ds_read_b64_tr_b16 v[50:51], v12 offset:512
    v_mfma_f32_16x16x32_bf16 v[148:151], v[60:63], v[104:107], v[148:151]
    v_add_u32 v13, 40960, v13
    ds_read_b64_tr_b16 v[52:53], v13 offset:0
    v_mfma_f32_16x16x32_bf16 v[156:159], v[60:63], v[108:111], v[156:159]
    ds_read_b64_tr_b16 v[54:55], v13 offset:512
    s_waitcnt lgkmcnt(4)
    v_mfma_f32_16x16x32_bf16 v[160:163], v[112:115], v[40:43], v[160:163]
    ds_read_b64_tr_b16 v[56:57], v10 offset:8192
    v_mfma_f32_16x16x32_bf16 v[164:167], v[116:119], v[40:43], v[164:167]
    ds_read_b64_tr_b16 v[58:59], v10 offset:8704
    v_mfma_f32_16x16x32_bf16 v[168:171], v[112:115], v[44:47], v[168:171]
    ds_read_b64_tr_b16 v[60:61], v11 offset:8192
    v_mfma_f32_16x16x32_bf16 v[172:175], v[116:119], v[44:47], v[172:175]
    ds_read_b64_tr_b16 v[62:63], v11 offset:8704
    s_waitcnt lgkmcnt(4)
    v_mfma_f32_16x16x32_bf16 v[176:179], v[112:115], v[48:51], v[176:179]
    ds_read_b64_tr_b16 v[40:41], v12 offset:8192
    v_mfma_f32_16x16x32_bf16 v[180:183], v[116:119], v[48:51], v[180:183]
    ds_read_b64_tr_b16 v[42:43], v12 offset:8704
    v_mfma_f32_16x16x32_bf16 v[184:187], v[112:115], v[52:55], v[184:187]
    ds_read_b64_tr_b16 v[44:45], v13 offset:8192
    v_mfma_f32_16x16x32_bf16 v[188:191], v[116:119], v[52:55], v[188:191]
    ds_read_b64_tr_b16 v[46:47], v13 offset:8704
    s_waitcnt lgkmcnt(4)
    v_mfma_f32_16x16x32_bf16 v[192:195], v[112:115], v[56:59], v[192:195]
    ds_read_b64_tr_b16 v[48:49], v10 offset:16384
    v_mfma_f32_16x16x32_bf16 v[196:199], v[116:119], v[56:59], v[196:199]
    ds_read_b64_tr_b16 v[50:51], v10 offset:16896
    v_mfma_f32_16x16x32_bf16 v[200:203], v[112:115], v[60:63], v[200:203]
    ds_read_b64_tr_b16 v[52:53], v11 offset:16384
    v_mfma_f32_16x16x32_bf16 v[204:207], v[116:119], v[60:63], v[204:207]
    ds_read_b64_tr_b16 v[54:55], v11 offset:16896
    s_waitcnt lgkmcnt(4)
    v_mfma_f32_16x16x32_bf16 v[208:211], v[112:115], v[40:43], v[208:211]
    ds_read_b64_tr_b16 v[56:57], v12 offset:16384
    v_mfma_f32_16x16x32_bf16 v[212:215], v[116:119], v[40:43], v[212:215]
    ds_read_b64_tr_b16 v[58:59], v12 offset:16896
    v_mfma_f32_16x16x32_bf16 v[216:219], v[112:115], v[44:47], v[216:219]
    ds_read_b64_tr_b16 v[60:61], v13 offset:16384
    v_mfma_f32_16x16x32_bf16 v[220:223], v[116:119], v[44:47], v[220:223]
    ds_read_b64_tr_b16 v[62:63], v13 offset:16896
    s_waitcnt lgkmcnt(4)
    v_mfma_f32_16x16x32_bf16 v[128:131], v[48:51], v[112:115], v[128:131]
    ds_read_b64_tr_b16 v[40:41], v10 offset:4096
    v_mfma_f32_16x16x32_bf16 v[136:139], v[48:51], v[116:119], v[136:139]
    ds_read_b64_tr_b16 v[42:43], v10 offset:4608
    v_add_u32 v9, 40960, v9
    ds_read_b128 v[120:123], v9 offset:0
    v_mfma_f32_16x16x32_bf16 v[132:135], v[52:55], v[112:115], v[132:135]
    ds_read_b64_tr_b16 v[44:45], v11 offset:4096
    v_mfma_f32_16x16x32_bf16 v[140:143], v[52:55], v[116:119], v[140:143]
    ds_read_b64_tr_b16 v[46:47], v11 offset:4608
    ds_read_b128 v[124:127], v9 offset:2048
    s_waitcnt lgkmcnt(6)
    v_mfma_f32_16x16x32_bf16 v[144:147], v[56:59], v[112:115], v[144:147]
    ds_read_b64_tr_b16 v[48:49], v12 offset:4096
    v_mfma_f32_16x16x32_bf16 v[152:155], v[56:59], v[116:119], v[152:155]
    ds_read_b64_tr_b16 v[50:51], v12 offset:4608
    v_mfma_f32_16x16x32_bf16 v[148:151], v[60:63], v[112:115], v[148:151]
    ds_read_b64_tr_b16 v[52:53], v13 offset:4096
    v_mfma_f32_16x16x32_bf16 v[156:159], v[60:63], v[116:119], v[156:159]
    ds_read_b64_tr_b16 v[54:55], v13 offset:4608
    s_waitcnt lgkmcnt(4)
    v_mfma_f32_16x16x32_bf16 v[160:163], v[120:123], v[40:43], v[160:163]
    ds_read_b64_tr_b16 v[56:57], v10 offset:12288
    v_mfma_f32_16x16x32_bf16 v[164:167], v[124:127], v[40:43], v[164:167]
    ds_read_b64_tr_b16 v[58:59], v10 offset:12800
    v_mfma_f32_16x16x32_bf16 v[168:171], v[120:123], v[44:47], v[168:171]
    ds_read_b64_tr_b16 v[60:61], v11 offset:12288
    v_mfma_f32_16x16x32_bf16 v[172:175], v[124:127], v[44:47], v[172:175]
    ds_read_b64_tr_b16 v[62:63], v11 offset:12800
    s_waitcnt lgkmcnt(4)
    v_mfma_f32_16x16x32_bf16 v[176:179], v[120:123], v[48:51], v[176:179]
    ds_read_b64_tr_b16 v[40:41], v12 offset:12288
    v_mfma_f32_16x16x32_bf16 v[180:183], v[124:127], v[48:51], v[180:183]
    ds_read_b64_tr_b16 v[42:43], v12 offset:12800
    v_mfma_f32_16x16x32_bf16 v[184:187], v[120:123], v[52:55], v[184:187]
    ds_read_b64_tr_b16 v[44:45], v13 offset:12288
    v_mfma_f32_16x16x32_bf16 v[188:191], v[124:127], v[52:55], v[188:191]
    ds_read_b64_tr_b16 v[46:47], v13 offset:12800
    s_waitcnt lgkmcnt(4)
    v_mfma_f32_16x16x32_bf16 v[192:195], v[120:123], v[56:59], v[192:195]
    ds_read_b64_tr_b16 v[48:49], v10 offset:20480
    v_mfma_f32_16x16x32_bf16 v[196:199], v[124:127], v[56:59], v[196:199]
    ds_read_b64_tr_b16 v[50:51], v10 offset:20992
    v_mfma_f32_16x16x32_bf16 v[200:203], v[120:123], v[60:63], v[200:203]
    ds_read_b64_tr_b16 v[52:53], v11 offset:20480
    v_mfma_f32_16x16x32_bf16 v[204:207], v[124:127], v[60:63], v[204:207]
    ds_read_b64_tr_b16 v[54:55], v11 offset:20992
    s_waitcnt lgkmcnt(4)
    v_mfma_f32_16x16x32_bf16 v[208:211], v[120:123], v[40:43], v[208:211]
    ds_read_b64_tr_b16 v[56:57], v12 offset:20480
    v_mfma_f32_16x16x32_bf16 v[212:215], v[124:127], v[40:43], v[212:215]
    ds_read_b64_tr_b16 v[58:59], v12 offset:20992
    v_mfma_f32_16x16x32_bf16 v[216:219], v[120:123], v[44:47], v[216:219]
    ds_read_b64_tr_b16 v[60:61], v13 offset:20480
    v_mfma_f32_16x16x32_bf16 v[220:223], v[124:127], v[44:47], v[220:223]
    ds_read_b64_tr_b16 v[62:63], v13 offset:20992
    s_waitcnt lgkmcnt(4)
    v_mfma_f32_16x16x32_bf16 v[128:131], v[48:51], v[120:123], v[128:131]
    s_barrier
    v_add_u32 v10, 40960, v10
    ds_read_b64_tr_b16 v[40:41], v10 offset:0
    v_mfma_f32_16x16x32_bf16 v[136:139], v[48:51], v[124:127], v[136:139]
    ds_read_b64_tr_b16 v[42:43], v10 offset:512
    v_add_u32 v8, 40960, v8
    ds_read_b128 v[224:227], v8 offset:0
    v_mfma_f32_16x16x32_bf16 v[132:135], v[52:55], v[120:123], v[132:135]
    v_add_u32 v11, 40960, v11
    ds_read_b64_tr_b16 v[44:45], v11 offset:0
    v_mfma_f32_16x16x32_bf16 v[140:143], v[52:55], v[124:127], v[140:143]
    ds_read_b64_tr_b16 v[46:47], v11 offset:512
    ds_read_b128 v[228:231], v8 offset:2048
    s_waitcnt lgkmcnt(6)
    v_mfma_f32_16x16x32_bf16 v[144:147], v[56:59], v[120:123], v[144:147]
    v_add_u32 v12, 40960, v12
    ds_read_b64_tr_b16 v[48:49], v12 offset:0
    v_mfma_f32_16x16x32_bf16 v[152:155], v[56:59], v[124:127], v[152:155]
    ds_read_b64_tr_b16 v[50:51], v12 offset:512
    v_mfma_f32_16x16x32_bf16 v[148:151], v[60:63], v[120:123], v[148:151]
    v_add_u32 v13, 40960, v13
    ds_read_b64_tr_b16 v[52:53], v13 offset:0
    v_mfma_f32_16x16x32_bf16 v[156:159], v[60:63], v[124:127], v[156:159]
    ds_read_b64_tr_b16 v[54:55], v13 offset:512
    s_waitcnt lgkmcnt(4)
    v_mfma_f32_16x16x32_bf16 v[160:163], v[224:227], v[40:43], v[160:163]
    ds_read_b64_tr_b16 v[56:57], v10 offset:8192
    v_mfma_f32_16x16x32_bf16 v[164:167], v[228:231], v[40:43], v[164:167]
    ds_read_b64_tr_b16 v[58:59], v10 offset:8704
    v_mfma_f32_16x16x32_bf16 v[168:171], v[224:227], v[44:47], v[168:171]
    ds_read_b64_tr_b16 v[60:61], v11 offset:8192
    v_mfma_f32_16x16x32_bf16 v[172:175], v[228:231], v[44:47], v[172:175]
    ds_read_b64_tr_b16 v[62:63], v11 offset:8704
    s_waitcnt lgkmcnt(4)
    v_mfma_f32_16x16x32_bf16 v[176:179], v[224:227], v[48:51], v[176:179]
    ds_read_b64_tr_b16 v[40:41], v12 offset:8192
    v_mfma_f32_16x16x32_bf16 v[180:183], v[228:231], v[48:51], v[180:183]
    ds_read_b64_tr_b16 v[42:43], v12 offset:8704
    v_mfma_f32_16x16x32_bf16 v[184:187], v[224:227], v[52:55], v[184:187]
    ds_read_b64_tr_b16 v[44:45], v13 offset:8192
    v_mfma_f32_16x16x32_bf16 v[188:191], v[228:231], v[52:55], v[188:191]
    ds_read_b64_tr_b16 v[46:47], v13 offset:8704
    s_waitcnt lgkmcnt(4)
    v_mfma_f32_16x16x32_bf16 v[192:195], v[224:227], v[56:59], v[192:195]
    ds_read_b64_tr_b16 v[48:49], v10 offset:16384
    v_mfma_f32_16x16x32_bf16 v[196:199], v[228:231], v[56:59], v[196:199]
    ds_read_b64_tr_b16 v[50:51], v10 offset:16896
    v_mfma_f32_16x16x32_bf16 v[200:203], v[224:227], v[60:63], v[200:203]
    ds_read_b64_tr_b16 v[52:53], v11 offset:16384
    v_mfma_f32_16x16x32_bf16 v[204:207], v[228:231], v[60:63], v[204:207]
    ds_read_b64_tr_b16 v[54:55], v11 offset:16896
    s_waitcnt lgkmcnt(4)
    v_mfma_f32_16x16x32_bf16 v[208:211], v[224:227], v[40:43], v[208:211]
    ds_read_b64_tr_b16 v[56:57], v12 offset:16384
    v_mfma_f32_16x16x32_bf16 v[212:215], v[228:231], v[40:43], v[212:215]
    ds_read_b64_tr_b16 v[58:59], v12 offset:16896
    v_mfma_f32_16x16x32_bf16 v[216:219], v[224:227], v[44:47], v[216:219]
    ds_read_b64_tr_b16 v[60:61], v13 offset:16384
    v_mfma_f32_16x16x32_bf16 v[220:223], v[228:231], v[44:47], v[220:223]
    ds_read_b64_tr_b16 v[62:63], v13 offset:16896
    s_waitcnt lgkmcnt(4)
    v_mfma_f32_16x16x32_bf16 v[128:131], v[48:51], v[224:227], v[128:131]
    ds_read_b64_tr_b16 v[40:41], v10 offset:4096
    v_mfma_f32_16x16x32_bf16 v[136:139], v[48:51], v[228:231], v[136:139]
    ds_read_b64_tr_b16 v[42:43], v10 offset:4608
    v_add_u32 v9, 40960, v9
    ds_read_b128 v[232:235], v9 offset:0
    v_mfma_f32_16x16x32_bf16 v[132:135], v[52:55], v[224:227], v[132:135]
    ds_read_b64_tr_b16 v[44:45], v11 offset:4096
    v_mfma_f32_16x16x32_bf16 v[140:143], v[52:55], v[228:231], v[140:143]
    ds_read_b64_tr_b16 v[46:47], v11 offset:4608
    ds_read_b128 v[236:239], v9 offset:2048
    s_waitcnt lgkmcnt(6)
    v_mfma_f32_16x16x32_bf16 v[144:147], v[56:59], v[224:227], v[144:147]
    ds_read_b64_tr_b16 v[48:49], v12 offset:4096
    v_mfma_f32_16x16x32_bf16 v[152:155], v[56:59], v[228:231], v[152:155]
    ds_read_b64_tr_b16 v[50:51], v12 offset:4608
    v_mfma_f32_16x16x32_bf16 v[148:151], v[60:63], v[224:227], v[148:151]
    ds_read_b64_tr_b16 v[52:53], v13 offset:4096
    v_mfma_f32_16x16x32_bf16 v[156:159], v[60:63], v[228:231], v[156:159]
    ds_read_b64_tr_b16 v[54:55], v13 offset:4608
    s_waitcnt lgkmcnt(4)
    v_mfma_f32_16x16x32_bf16 v[160:163], v[232:235], v[40:43], v[160:163]
    ds_read_b64_tr_b16 v[56:57], v10 offset:12288
    v_mfma_f32_16x16x32_bf16 v[164:167], v[236:239], v[40:43], v[164:167]
    ds_read_b64_tr_b16 v[58:59], v10 offset:12800
    v_mfma_f32_16x16x32_bf16 v[168:171], v[232:235], v[44:47], v[168:171]
    ds_read_b64_tr_b16 v[60:61], v11 offset:12288
    v_mfma_f32_16x16x32_bf16 v[172:175], v[236:239], v[44:47], v[172:175]
    ds_read_b64_tr_b16 v[62:63], v11 offset:12800
    s_waitcnt lgkmcnt(4)
    v_mfma_f32_16x16x32_bf16 v[176:179], v[232:235], v[48:51], v[176:179]
    ds_read_b64_tr_b16 v[40:41], v12 offset:12288
    v_mfma_f32_16x16x32_bf16 v[180:183], v[236:239], v[48:51], v[180:183]
    ds_read_b64_tr_b16 v[42:43], v12 offset:12800
    v_mfma_f32_16x16x32_bf16 v[184:187], v[232:235], v[52:55], v[184:187]
    ds_read_b64_tr_b16 v[44:45], v13 offset:12288
    v_mfma_f32_16x16x32_bf16 v[188:191], v[236:239], v[52:55], v[188:191]
    ds_read_b64_tr_b16 v[46:47], v13 offset:12800
    s_waitcnt lgkmcnt(4)
    v_mfma_f32_16x16x32_bf16 v[192:195], v[232:235], v[56:59], v[192:195]
    ds_read_b64_tr_b16 v[48:49], v10 offset:20480
    v_mfma_f32_16x16x32_bf16 v[196:199], v[236:239], v[56:59], v[196:199]
    ds_read_b64_tr_b16 v[50:51], v10 offset:20992
    v_mfma_f32_16x16x32_bf16 v[200:203], v[232:235], v[60:63], v[200:203]
    ds_read_b64_tr_b16 v[52:53], v11 offset:20480
    v_mfma_f32_16x16x32_bf16 v[204:207], v[236:239], v[60:63], v[204:207]
    ds_read_b64_tr_b16 v[54:55], v11 offset:20992
    s_waitcnt lgkmcnt(4)
    v_mfma_f32_16x16x32_bf16 v[208:211], v[232:235], v[40:43], v[208:211]
    ds_read_b64_tr_b16 v[56:57], v12 offset:20480
    v_mfma_f32_16x16x32_bf16 v[212:215], v[236:239], v[40:43], v[212:215]
    ds_read_b64_tr_b16 v[58:59], v12 offset:20992
    v_mfma_f32_16x16x32_bf16 v[216:219], v[232:235], v[44:47], v[216:219]
    ds_read_b64_tr_b16 v[60:61], v13 offset:20480
    v_mfma_f32_16x16x32_bf16 v[220:223], v[236:239], v[44:47], v[220:223]
    ds_read_b64_tr_b16 v[62:63], v13 offset:20992
    s_waitcnt lgkmcnt(4)
    v_mfma_f32_16x16x32_bf16 v[128:131], v[48:51], v[232:235], v[128:131]
    s_barrier
    v_add_u32 v10, 40960, v10
    ds_read_b64_tr_b16 v[40:41], v10 offset:0
    v_mfma_f32_16x16x32_bf16 v[136:139], v[48:51], v[236:239], v[136:139]
    ds_read_b64_tr_b16 v[42:43], v10 offset:512
    v_add_u32 v8, 40960, v8
    ds_read_b128 v[240:243], v8 offset:0
    v_mfma_f32_16x16x32_bf16 v[132:135], v[52:55], v[232:235], v[132:135]
    v_add_u32 v11, 40960, v11
    ds_read_b64_tr_b16 v[44:45], v11 offset:0
    v_mfma_f32_16x16x32_bf16 v[140:143], v[52:55], v[236:239], v[140:143]
    ds_read_b64_tr_b16 v[46:47], v11 offset:512
    ds_read_b128 v[244:247], v8 offset:2048
    s_waitcnt lgkmcnt(6)
    v_mfma_f32_16x16x32_bf16 v[144:147], v[56:59], v[232:235], v[144:147]
    v_add_u32 v12, 40960, v12
    ds_read_b64_tr_b16 v[48:49], v12 offset:0
    v_mfma_f32_16x16x32_bf16 v[152:155], v[56:59], v[236:239], v[152:155]
    ds_read_b64_tr_b16 v[50:51], v12 offset:512
    v_mfma_f32_16x16x32_bf16 v[148:151], v[60:63], v[232:235], v[148:151]
    v_add_u32 v13, 40960, v13
    ds_read_b64_tr_b16 v[52:53], v13 offset:0
    v_mfma_f32_16x16x32_bf16 v[156:159], v[60:63], v[236:239], v[156:159]
    ds_read_b64_tr_b16 v[54:55], v13 offset:512
    s_waitcnt lgkmcnt(4)
    v_mfma_f32_16x16x32_bf16 v[160:163], v[240:243], v[40:43], v[160:163]
    ds_read_b64_tr_b16 v[56:57], v10 offset:8192
    v_mfma_f32_16x16x32_bf16 v[164:167], v[244:247], v[40:43], v[164:167]
    ds_read_b64_tr_b16 v[58:59], v10 offset:8704
    v_mfma_f32_16x16x32_bf16 v[168:171], v[240:243], v[44:47], v[168:171]
    ds_read_b64_tr_b16 v[60:61], v11 offset:8192
    v_mfma_f32_16x16x32_bf16 v[172:175], v[244:247], v[44:47], v[172:175]
    ds_read_b64_tr_b16 v[62:63], v11 offset:8704
    s_waitcnt lgkmcnt(4)
    v_mfma_f32_16x16x32_bf16 v[176:179], v[240:243], v[48:51], v[176:179]
    ds_read_b64_tr_b16 v[40:41], v12 offset:8192
    v_mfma_f32_16x16x32_bf16 v[180:183], v[244:247], v[48:51], v[180:183]
    ds_read_b64_tr_b16 v[42:43], v12 offset:8704
    v_mfma_f32_16x16x32_bf16 v[184:187], v[240:243], v[52:55], v[184:187]
    ds_read_b64_tr_b16 v[44:45], v13 offset:8192
    v_mfma_f32_16x16x32_bf16 v[188:191], v[244:247], v[52:55], v[188:191]
    ds_read_b64_tr_b16 v[46:47], v13 offset:8704
    s_waitcnt lgkmcnt(4)
    v_mfma_f32_16x16x32_bf16 v[192:195], v[240:243], v[56:59], v[192:195]
    ds_read_b64_tr_b16 v[48:49], v10 offset:16384
    v_mfma_f32_16x16x32_bf16 v[196:199], v[244:247], v[56:59], v[196:199]
    ds_read_b64_tr_b16 v[50:51], v10 offset:16896
    v_mfma_f32_16x16x32_bf16 v[200:203], v[240:243], v[60:63], v[200:203]
    ds_read_b64_tr_b16 v[52:53], v11 offset:16384
    v_mfma_f32_16x16x32_bf16 v[204:207], v[244:247], v[60:63], v[204:207]
    ds_read_b64_tr_b16 v[54:55], v11 offset:16896
    s_waitcnt lgkmcnt(4)
    v_mfma_f32_16x16x32_bf16 v[208:211], v[240:243], v[40:43], v[208:211]
    ds_read_b64_tr_b16 v[56:57], v12 offset:16384
    v_mfma_f32_16x16x32_bf16 v[212:215], v[244:247], v[40:43], v[212:215]
    ds_read_b64_tr_b16 v[58:59], v12 offset:16896
    v_mfma_f32_16x16x32_bf16 v[216:219], v[240:243], v[44:47], v[216:219]
    ds_read_b64_tr_b16 v[60:61], v13 offset:16384
    v_mfma_f32_16x16x32_bf16 v[220:223], v[244:247], v[44:47], v[220:223]
    ds_read_b64_tr_b16 v[62:63], v13 offset:16896
    s_waitcnt lgkmcnt(4)
    v_mfma_f32_16x16x32_bf16 v[128:131], v[48:51], v[240:243], v[128:131]
    ds_read_b64_tr_b16 v[40:41], v10 offset:4096
    v_mfma_f32_16x16x32_bf16 v[136:139], v[48:51], v[244:247], v[136:139]
    ds_read_b64_tr_b16 v[42:43], v10 offset:4608
    v_add_u32 v9, 40960, v9
    ds_read_b128 v[248:251], v9 offset:0
    v_mfma_f32_16x16x32_bf16 v[132:135], v[52:55], v[240:243], v[132:135]
    ds_read_b64_tr_b16 v[44:45], v11 offset:4096
    v_mfma_f32_16x16x32_bf16 v[140:143], v[52:55], v[244:247], v[140:143]
    ds_read_b64_tr_b16 v[46:47], v11 offset:4608
    ds_read_b128 v[252:255], v9 offset:2048
    s_waitcnt lgkmcnt(6)
    v_mfma_f32_16x16x32_bf16 v[144:147], v[56:59], v[240:243], v[144:147]
    ds_read_b64_tr_b16 v[48:49], v12 offset:4096
    v_mfma_f32_16x16x32_bf16 v[152:155], v[56:59], v[244:247], v[152:155]
    ds_read_b64_tr_b16 v[50:51], v12 offset:4608
    v_mfma_f32_16x16x32_bf16 v[148:151], v[60:63], v[240:243], v[148:151]
    ds_read_b64_tr_b16 v[52:53], v13 offset:4096
    v_mfma_f32_16x16x32_bf16 v[156:159], v[60:63], v[244:247], v[156:159]
    ds_read_b64_tr_b16 v[54:55], v13 offset:4608
    s_waitcnt lgkmcnt(4)
    v_mfma_f32_16x16x32_bf16 v[160:163], v[248:251], v[40:43], v[160:163]
    ds_read_b64_tr_b16 v[56:57], v10 offset:12288
    v_mfma_f32_16x16x32_bf16 v[164:167], v[252:255], v[40:43], v[164:167]
    ds_read_b64_tr_b16 v[58:59], v10 offset:12800
    v_mfma_f32_16x16x32_bf16 v[168:171], v[248:251], v[44:47], v[168:171]
    ds_read_b64_tr_b16 v[60:61], v11 offset:12288
    v_mfma_f32_16x16x32_bf16 v[172:175], v[252:255], v[44:47], v[172:175]
    ds_read_b64_tr_b16 v[62:63], v11 offset:12800
    s_waitcnt lgkmcnt(4)
    v_mfma_f32_16x16x32_bf16 v[176:179], v[248:251], v[48:51], v[176:179]
    ds_read_b64_tr_b16 v[40:41], v12 offset:12288
    v_mfma_f32_16x16x32_bf16 v[180:183], v[252:255], v[48:51], v[180:183]
    ds_read_b64_tr_b16 v[42:43], v12 offset:12800
    v_mfma_f32_16x16x32_bf16 v[184:187], v[248:251], v[52:55], v[184:187]
    ds_read_b64_tr_b16 v[44:45], v13 offset:12288
    v_mfma_f32_16x16x32_bf16 v[188:191], v[252:255], v[52:55], v[188:191]
    ds_read_b64_tr_b16 v[46:47], v13 offset:12800
    s_waitcnt lgkmcnt(4)
    v_mfma_f32_16x16x32_bf16 v[192:195], v[248:251], v[56:59], v[192:195]
    ds_read_b64_tr_b16 v[48:49], v10 offset:20480
    v_mfma_f32_16x16x32_bf16 v[196:199], v[252:255], v[56:59], v[196:199]
    ds_read_b64_tr_b16 v[50:51], v10 offset:20992
    v_mfma_f32_16x16x32_bf16 v[200:203], v[248:251], v[60:63], v[200:203]
    ds_read_b64_tr_b16 v[52:53], v11 offset:20480
    v_mfma_f32_16x16x32_bf16 v[204:207], v[252:255], v[60:63], v[204:207]
    ds_read_b64_tr_b16 v[54:55], v11 offset:20992
    s_waitcnt lgkmcnt(4)
    v_mfma_f32_16x16x32_bf16 v[208:211], v[248:251], v[40:43], v[208:211]
    ds_read_b64_tr_b16 v[56:57], v12 offset:20480
    v_mfma_f32_16x16x32_bf16 v[212:215], v[252:255], v[40:43], v[212:215]
    ds_read_b64_tr_b16 v[58:59], v12 offset:20992
    v_mfma_f32_16x16x32_bf16 v[216:219], v[248:251], v[44:47], v[216:219]
    ds_read_b64_tr_b16 v[60:61], v13 offset:20480
    v_mfma_f32_16x16x32_bf16 v[220:223], v[252:255], v[44:47], v[220:223]
    ds_read_b64_tr_b16 v[62:63], v13 offset:20992
    s_waitcnt lgkmcnt(4)
    v_mfma_f32_16x16x32_bf16 v[128:131], v[48:51], v[248:251], v[128:131]
    s_barrier
    v_add_u32 v10, -122880, v10
    ds_read_b64_tr_b16 v[40:41], v10 offset:0
    v_mfma_f32_16x16x32_bf16 v[136:139], v[48:51], v[252:255], v[136:139]
    ds_read_b64_tr_b16 v[42:43], v10 offset:512
    v_add_u32 v8, -122880, v8
    ds_read_b128 v[24:27], v8 offset:0
    v_mfma_f32_16x16x32_bf16 v[132:135], v[52:55], v[248:251], v[132:135]
    v_add_u32 v11, -122880, v11
    ds_read_b64_tr_b16 v[44:45], v11 offset:0
    v_mfma_f32_16x16x32_bf16 v[140:143], v[52:55], v[252:255], v[140:143]
    ds_read_b64_tr_b16 v[46:47], v11 offset:512
    ds_read_b128 v[28:31], v8 offset:2048
    s_waitcnt lgkmcnt(6)
    v_mfma_f32_16x16x32_bf16 v[144:147], v[56:59], v[248:251], v[144:147]
    v_add_u32 v12, -122880, v12
    ds_read_b64_tr_b16 v[48:49], v12 offset:0
    v_mfma_f32_16x16x32_bf16 v[152:155], v[56:59], v[252:255], v[152:155]
    ds_read_b64_tr_b16 v[50:51], v12 offset:512
    v_mfma_f32_16x16x32_bf16 v[148:151], v[60:63], v[248:251], v[148:151]
    v_add_u32 v13, -122880, v13
    ds_read_b64_tr_b16 v[52:53], v13 offset:0
    v_mfma_f32_16x16x32_bf16 v[156:159], v[60:63], v[252:255], v[156:159]
    ds_read_b64_tr_b16 v[54:55], v13 offset:512
    s_waitcnt lgkmcnt(4)
    v_mfma_f32_16x16x32_bf16 v[160:163], v[24:27], v[40:43], v[160:163]
    ds_read_b64_tr_b16 v[56:57], v10 offset:8192
    v_mfma_f32_16x16x32_bf16 v[164:167], v[28:31], v[40:43], v[164:167]
    ds_read_b64_tr_b16 v[58:59], v10 offset:8704
    v_mfma_f32_16x16x32_bf16 v[168:171], v[24:27], v[44:47], v[168:171]
    ds_read_b64_tr_b16 v[60:61], v11 offset:8192
    v_mfma_f32_16x16x32_bf16 v[172:175], v[28:31], v[44:47], v[172:175]
    ds_read_b64_tr_b16 v[62:63], v11 offset:8704
    s_waitcnt lgkmcnt(4)
    v_mfma_f32_16x16x32_bf16 v[176:179], v[24:27], v[48:51], v[176:179]
    ds_read_b64_tr_b16 v[40:41], v12 offset:8192
    v_mfma_f32_16x16x32_bf16 v[180:183], v[28:31], v[48:51], v[180:183]
    ds_read_b64_tr_b16 v[42:43], v12 offset:8704
    v_mfma_f32_16x16x32_bf16 v[184:187], v[24:27], v[52:55], v[184:187]
    ds_read_b64_tr_b16 v[44:45], v13 offset:8192
    v_mfma_f32_16x16x32_bf16 v[188:191], v[28:31], v[52:55], v[188:191]
    ds_read_b64_tr_b16 v[46:47], v13 offset:8704
    s_waitcnt lgkmcnt(4)
    v_mfma_f32_16x16x32_bf16 v[192:195], v[24:27], v[56:59], v[192:195]
    ds_read_b64_tr_b16 v[48:49], v10 offset:16384
    v_mfma_f32_16x16x32_bf16 v[196:199], v[28:31], v[56:59], v[196:199]
    ds_read_b64_tr_b16 v[50:51], v10 offset:16896
    v_mfma_f32_16x16x32_bf16 v[200:203], v[24:27], v[60:63], v[200:203]
    ds_read_b64_tr_b16 v[52:53], v11 offset:16384
    v_mfma_f32_16x16x32_bf16 v[204:207], v[28:31], v[60:63], v[204:207]
    ds_read_b64_tr_b16 v[54:55], v11 offset:16896
    s_waitcnt lgkmcnt(4)
    v_mfma_f32_16x16x32_bf16 v[208:211], v[24:27], v[40:43], v[208:211]
    ds_read_b64_tr_b16 v[56:57], v12 offset:16384
    v_mfma_f32_16x16x32_bf16 v[212:215], v[28:31], v[40:43], v[212:215]
    ds_read_b64_tr_b16 v[58:59], v12 offset:16896
    v_mfma_f32_16x16x32_bf16 v[216:219], v[24:27], v[44:47], v[216:219]
    ds_read_b64_tr_b16 v[60:61], v13 offset:16384
    v_mfma_f32_16x16x32_bf16 v[220:223], v[28:31], v[44:47], v[220:223]
    ds_read_b64_tr_b16 v[62:63], v13 offset:16896
    s_waitcnt lgkmcnt(4)
    v_mfma_f32_16x16x32_bf16 v[128:131], v[48:51], v[24:27], v[128:131]
    ds_read_b64_tr_b16 v[40:41], v10 offset:4096
    v_mfma_f32_16x16x32_bf16 v[136:139], v[48:51], v[28:31], v[136:139]
    ds_read_b64_tr_b16 v[42:43], v10 offset:4608
    v_add_u32 v9, -122880, v9
    ds_read_b128 v[32:35], v9 offset:0
    v_mfma_f32_16x16x32_bf16 v[132:135], v[52:55], v[24:27], v[132:135]
    ds_read_b64_tr_b16 v[44:45], v11 offset:4096
    v_mfma_f32_16x16x32_bf16 v[140:143], v[52:55], v[28:31], v[140:143]
    ds_read_b64_tr_b16 v[46:47], v11 offset:4608
    ds_read_b128 v[36:39], v9 offset:2048
    s_waitcnt lgkmcnt(6)
    v_mfma_f32_16x16x32_bf16 v[144:147], v[56:59], v[24:27], v[144:147]
    ds_read_b64_tr_b16 v[48:49], v12 offset:4096
    v_mfma_f32_16x16x32_bf16 v[152:155], v[56:59], v[28:31], v[152:155]
    ds_read_b64_tr_b16 v[50:51], v12 offset:4608
    v_mfma_f32_16x16x32_bf16 v[148:151], v[60:63], v[24:27], v[148:151]
    ds_read_b64_tr_b16 v[52:53], v13 offset:4096
    v_mfma_f32_16x16x32_bf16 v[156:159], v[60:63], v[28:31], v[156:159]
    ds_read_b64_tr_b16 v[54:55], v13 offset:4608
    s_waitcnt lgkmcnt(4)
    v_mfma_f32_16x16x32_bf16 v[160:163], v[32:35], v[40:43], v[160:163]
    ds_read_b64_tr_b16 v[56:57], v10 offset:12288
    v_mfma_f32_16x16x32_bf16 v[164:167], v[36:39], v[40:43], v[164:167]
    ds_read_b64_tr_b16 v[58:59], v10 offset:12800
    v_mfma_f32_16x16x32_bf16 v[168:171], v[32:35], v[44:47], v[168:171]
    ds_read_b64_tr_b16 v[60:61], v11 offset:12288
    v_mfma_f32_16x16x32_bf16 v[172:175], v[36:39], v[44:47], v[172:175]
    ds_read_b64_tr_b16 v[62:63], v11 offset:12800
    s_waitcnt lgkmcnt(4)
    v_mfma_f32_16x16x32_bf16 v[176:179], v[32:35], v[48:51], v[176:179]
    ds_read_b64_tr_b16 v[40:41], v12 offset:12288
    v_mfma_f32_16x16x32_bf16 v[180:183], v[36:39], v[48:51], v[180:183]
    ds_read_b64_tr_b16 v[42:43], v12 offset:12800
    v_mfma_f32_16x16x32_bf16 v[184:187], v[32:35], v[52:55], v[184:187]
    ds_read_b64_tr_b16 v[44:45], v13 offset:12288
    v_mfma_f32_16x16x32_bf16 v[188:191], v[36:39], v[52:55], v[188:191]
    ds_read_b64_tr_b16 v[46:47], v13 offset:12800
    s_waitcnt lgkmcnt(4)
    v_mfma_f32_16x16x32_bf16 v[192:195], v[32:35], v[56:59], v[192:195]
    ds_read_b64_tr_b16 v[48:49], v10 offset:20480
    v_mfma_f32_16x16x32_bf16 v[196:199], v[36:39], v[56:59], v[196:199]
    ds_read_b64_tr_b16 v[50:51], v10 offset:20992
    v_mfma_f32_16x16x32_bf16 v[200:203], v[32:35], v[60:63], v[200:203]
    ds_read_b64_tr_b16 v[52:53], v11 offset:20480
    v_mfma_f32_16x16x32_bf16 v[204:207], v[36:39], v[60:63], v[204:207]
    ds_read_b64_tr_b16 v[54:55], v11 offset:20992
    s_waitcnt lgkmcnt(4)
    v_mfma_f32_16x16x32_bf16 v[208:211], v[32:35], v[40:43], v[208:211]
    ds_read_b64_tr_b16 v[56:57], v12 offset:20480
    v_mfma_f32_16x16x32_bf16 v[212:215], v[36:39], v[40:43], v[212:215]
    ds_read_b64_tr_b16 v[58:59], v12 offset:20992
    v_mfma_f32_16x16x32_bf16 v[216:219], v[32:35], v[44:47], v[216:219]
    ds_read_b64_tr_b16 v[60:61], v13 offset:20480
    v_mfma_f32_16x16x32_bf16 v[220:223], v[36:39], v[44:47], v[220:223]
    ds_read_b64_tr_b16 v[62:63], v13 offset:20992
    s_waitcnt lgkmcnt(4)
    v_mfma_f32_16x16x32_bf16 v[128:131], v[48:51], v[32:35], v[128:131]
    s_barrier
    v_add_u32 v10, 40960, v10
    ds_read_b64_tr_b16 v[40:41], v10 offset:0
    v_mfma_f32_16x16x32_bf16 v[136:139], v[48:51], v[36:39], v[136:139]
    ds_read_b64_tr_b16 v[42:43], v10 offset:512
    v_add_u32 v8, 40960, v8
    ds_read_b128 v[24:27], v8 offset:0
    v_mfma_f32_16x16x32_bf16 v[132:135], v[52:55], v[32:35], v[132:135]
    v_add_u32 v11, 40960, v11
    ds_read_b64_tr_b16 v[44:45], v11 offset:0
    v_mfma_f32_16x16x32_bf16 v[140:143], v[52:55], v[36:39], v[140:143]
    ds_read_b64_tr_b16 v[46:47], v11 offset:512
    ds_read_b128 v[28:31], v8 offset:2048
    s_waitcnt lgkmcnt(6)
    v_mfma_f32_16x16x32_bf16 v[144:147], v[56:59], v[32:35], v[144:147]
    v_add_u32 v12, 40960, v12
    ds_read_b64_tr_b16 v[48:49], v12 offset:0
    v_mfma_f32_16x16x32_bf16 v[152:155], v[56:59], v[36:39], v[152:155]
    ds_read_b64_tr_b16 v[50:51], v12 offset:512
    v_mfma_f32_16x16x32_bf16 v[148:151], v[60:63], v[32:35], v[148:151]
    v_add_u32 v13, 40960, v13
    ds_read_b64_tr_b16 v[52:53], v13 offset:0
    v_mfma_f32_16x16x32_bf16 v[156:159], v[60:63], v[36:39], v[156:159]
    ds_read_b64_tr_b16 v[54:55], v13 offset:512
    s_waitcnt lgkmcnt(4)
    v_mfma_f32_16x16x32_bf16 v[160:163], v[24:27], v[40:43], v[160:163]
    ds_read_b64_tr_b16 v[56:57], v10 offset:8192
    v_mfma_f32_16x16x32_bf16 v[164:167], v[28:31], v[40:43], v[164:167]
    ds_read_b64_tr_b16 v[58:59], v10 offset:8704
    v_mfma_f32_16x16x32_bf16 v[168:171], v[24:27], v[44:47], v[168:171]
    ds_read_b64_tr_b16 v[60:61], v11 offset:8192
    v_mfma_f32_16x16x32_bf16 v[172:175], v[28:31], v[44:47], v[172:175]
    ds_read_b64_tr_b16 v[62:63], v11 offset:8704
    s_waitcnt lgkmcnt(4)
    v_mfma_f32_16x16x32_bf16 v[176:179], v[24:27], v[48:51], v[176:179]
    ds_read_b64_tr_b16 v[40:41], v12 offset:8192
    v_mfma_f32_16x16x32_bf16 v[180:183], v[28:31], v[48:51], v[180:183]
    ds_read_b64_tr_b16 v[42:43], v12 offset:8704
    v_mfma_f32_16x16x32_bf16 v[184:187], v[24:27], v[52:55], v[184:187]
    ds_read_b64_tr_b16 v[44:45], v13 offset:8192
    v_mfma_f32_16x16x32_bf16 v[188:191], v[28:31], v[52:55], v[188:191]
    ds_read_b64_tr_b16 v[46:47], v13 offset:8704
    s_waitcnt lgkmcnt(4)
    v_mfma_f32_16x16x32_bf16 v[192:195], v[24:27], v[56:59], v[192:195]
    ds_read_b64_tr_b16 v[48:49], v10 offset:16384
    v_mfma_f32_16x16x32_bf16 v[196:199], v[28:31], v[56:59], v[196:199]
    ds_read_b64_tr_b16 v[50:51], v10 offset:16896
    v_mfma_f32_16x16x32_bf16 v[200:203], v[24:27], v[60:63], v[200:203]
    ds_read_b64_tr_b16 v[52:53], v11 offset:16384
    v_mfma_f32_16x16x32_bf16 v[204:207], v[28:31], v[60:63], v[204:207]
    ds_read_b64_tr_b16 v[54:55], v11 offset:16896
    s_waitcnt lgkmcnt(4)
    v_mfma_f32_16x16x32_bf16 v[208:211], v[24:27], v[40:43], v[208:211]
    ds_read_b64_tr_b16 v[56:57], v12 offset:16384
    v_mfma_f32_16x16x32_bf16 v[212:215], v[28:31], v[40:43], v[212:215]
    ds_read_b64_tr_b16 v[58:59], v12 offset:16896
    v_mfma_f32_16x16x32_bf16 v[216:219], v[24:27], v[44:47], v[216:219]
    ds_read_b64_tr_b16 v[60:61], v13 offset:16384
    v_mfma_f32_16x16x32_bf16 v[220:223], v[28:31], v[44:47], v[220:223]
    ds_read_b64_tr_b16 v[62:63], v13 offset:16896
    s_waitcnt lgkmcnt(4)
    v_mfma_f32_16x16x32_bf16 v[128:131], v[48:51], v[24:27], v[128:131]
    ds_read_b64_tr_b16 v[40:41], v10 offset:4096
    v_mfma_f32_16x16x32_bf16 v[136:139], v[48:51], v[28:31], v[136:139]
    ds_read_b64_tr_b16 v[42:43], v10 offset:4608
    v_add_u32 v9, 40960, v9
    ds_read_b128 v[32:35], v9 offset:0
    v_mfma_f32_16x16x32_bf16 v[132:135], v[52:55], v[24:27], v[132:135]
    ds_read_b64_tr_b16 v[44:45], v11 offset:4096
    v_mfma_f32_16x16x32_bf16 v[140:143], v[52:55], v[28:31], v[140:143]
    ds_read_b64_tr_b16 v[46:47], v11 offset:4608
    ds_read_b128 v[36:39], v9 offset:2048
    s_waitcnt lgkmcnt(6)
    v_mfma_f32_16x16x32_bf16 v[144:147], v[56:59], v[24:27], v[144:147]
    ds_read_b64_tr_b16 v[48:49], v12 offset:4096
    v_mfma_f32_16x16x32_bf16 v[152:155], v[56:59], v[28:31], v[152:155]
    ds_read_b64_tr_b16 v[50:51], v12 offset:4608
    v_mfma_f32_16x16x32_bf16 v[148:151], v[60:63], v[24:27], v[148:151]
    ds_read_b64_tr_b16 v[52:53], v13 offset:4096
    v_mfma_f32_16x16x32_bf16 v[156:159], v[60:63], v[28:31], v[156:159]
    ds_read_b64_tr_b16 v[54:55], v13 offset:4608
    s_waitcnt lgkmcnt(4)
    v_mfma_f32_16x16x32_bf16 v[160:163], v[32:35], v[40:43], v[160:163]
    ds_read_b64_tr_b16 v[56:57], v10 offset:12288
    v_mfma_f32_16x16x32_bf16 v[164:167], v[36:39], v[40:43], v[164:167]
    ds_read_b64_tr_b16 v[58:59], v10 offset:12800
    v_mfma_f32_16x16x32_bf16 v[168:171], v[32:35], v[44:47], v[168:171]
    ds_read_b64_tr_b16 v[60:61], v11 offset:12288
    v_mfma_f32_16x16x32_bf16 v[172:175], v[36:39], v[44:47], v[172:175]
    ds_read_b64_tr_b16 v[62:63], v11 offset:12800
    s_waitcnt lgkmcnt(4)
    v_mfma_f32_16x16x32_bf16 v[176:179], v[32:35], v[48:51], v[176:179]
    ds_read_b64_tr_b16 v[40:41], v12 offset:12288
    v_mfma_f32_16x16x32_bf16 v[180:183], v[36:39], v[48:51], v[180:183]
    ds_read_b64_tr_b16 v[42:43], v12 offset:12800
    v_mfma_f32_16x16x32_bf16 v[184:187], v[32:35], v[52:55], v[184:187]
    ds_read_b64_tr_b16 v[44:45], v13 offset:12288
    v_mfma_f32_16x16x32_bf16 v[188:191], v[36:39], v[52:55], v[188:191]
    ds_read_b64_tr_b16 v[46:47], v13 offset:12800
    s_waitcnt lgkmcnt(4)
    v_mfma_f32_16x16x32_bf16 v[192:195], v[32:35], v[56:59], v[192:195]
    ds_read_b64_tr_b16 v[48:49], v10 offset:20480
    v_mfma_f32_16x16x32_bf16 v[196:199], v[36:39], v[56:59], v[196:199]
    ds_read_b64_tr_b16 v[50:51], v10 offset:20992
    v_mfma_f32_16x16x32_bf16 v[200:203], v[32:35], v[60:63], v[200:203]
    ds_read_b64_tr_b16 v[52:53], v11 offset:20480
    v_mfma_f32_16x16x32_bf16 v[204:207], v[36:39], v[60:63], v[204:207]
    ds_read_b64_tr_b16 v[54:55], v11 offset:20992
    s_waitcnt lgkmcnt(4)
    v_mfma_f32_16x16x32_bf16 v[208:211], v[32:35], v[40:43], v[208:211]
    ds_read_b64_tr_b16 v[56:57], v12 offset:20480
    v_mfma_f32_16x16x32_bf16 v[212:215], v[36:39], v[40:43], v[212:215]
    ds_read_b64_tr_b16 v[58:59], v12 offset:20992
    v_mfma_f32_16x16x32_bf16 v[216:219], v[32:35], v[44:47], v[216:219]
    ds_read_b64_tr_b16 v[60:61], v13 offset:20480
    v_mfma_f32_16x16x32_bf16 v[220:223], v[36:39], v[44:47], v[220:223]
    ds_read_b64_tr_b16 v[62:63], v13 offset:20992
    s_waitcnt lgkmcnt(4)
    v_mfma_f32_16x16x32_bf16 v[128:131], v[48:51], v[32:35], v[128:131]
    s_barrier
    v_add_u32 v10, 40960, v10
    ds_read_b64_tr_b16 v[40:41], v10 offset:0
    v_mfma_f32_16x16x32_bf16 v[136:139], v[48:51], v[36:39], v[136:139]
    ds_read_b64_tr_b16 v[42:43], v10 offset:512
    v_add_u32 v8, 40960, v8
    ds_read_b128 v[24:27], v8 offset:0
    v_mfma_f32_16x16x32_bf16 v[132:135], v[52:55], v[32:35], v[132:135]
    v_add_u32 v11, 40960, v11
    ds_read_b64_tr_b16 v[44:45], v11 offset:0
    v_mfma_f32_16x16x32_bf16 v[140:143], v[52:55], v[36:39], v[140:143]
    ds_read_b64_tr_b16 v[46:47], v11 offset:512
    ds_read_b128 v[28:31], v8 offset:2048
    s_waitcnt lgkmcnt(6)
    v_mfma_f32_16x16x32_bf16 v[144:147], v[56:59], v[32:35], v[144:147]
    v_add_u32 v12, 40960, v12
    ds_read_b64_tr_b16 v[48:49], v12 offset:0
    v_mfma_f32_16x16x32_bf16 v[152:155], v[56:59], v[36:39], v[152:155]
    ds_read_b64_tr_b16 v[50:51], v12 offset:512
    v_mfma_f32_16x16x32_bf16 v[148:151], v[60:63], v[32:35], v[148:151]
    v_add_u32 v13, 40960, v13
    ds_read_b64_tr_b16 v[52:53], v13 offset:0
    v_mfma_f32_16x16x32_bf16 v[156:159], v[60:63], v[36:39], v[156:159]
    ds_read_b64_tr_b16 v[54:55], v13 offset:512
    s_waitcnt lgkmcnt(4)
    v_mfma_f32_16x16x32_bf16 v[160:163], v[24:27], v[40:43], v[160:163]
    ds_read_b64_tr_b16 v[56:57], v10 offset:8192
    v_mfma_f32_16x16x32_bf16 v[164:167], v[28:31], v[40:43], v[164:167]
    ds_read_b64_tr_b16 v[58:59], v10 offset:8704
    v_mfma_f32_16x16x32_bf16 v[168:171], v[24:27], v[44:47], v[168:171]
    ds_read_b64_tr_b16 v[60:61], v11 offset:8192
    v_mfma_f32_16x16x32_bf16 v[172:175], v[28:31], v[44:47], v[172:175]
    ds_read_b64_tr_b16 v[62:63], v11 offset:8704
    s_waitcnt lgkmcnt(4)
    v_mfma_f32_16x16x32_bf16 v[176:179], v[24:27], v[48:51], v[176:179]
    ds_read_b64_tr_b16 v[40:41], v12 offset:8192
    v_mfma_f32_16x16x32_bf16 v[180:183], v[28:31], v[48:51], v[180:183]
    ds_read_b64_tr_b16 v[42:43], v12 offset:8704
    v_mfma_f32_16x16x32_bf16 v[184:187], v[24:27], v[52:55], v[184:187]
    ds_read_b64_tr_b16 v[44:45], v13 offset:8192
    v_mfma_f32_16x16x32_bf16 v[188:191], v[28:31], v[52:55], v[188:191]
    ds_read_b64_tr_b16 v[46:47], v13 offset:8704
    s_waitcnt lgkmcnt(4)
    v_mfma_f32_16x16x32_bf16 v[192:195], v[24:27], v[56:59], v[192:195]
    ds_read_b64_tr_b16 v[48:49], v10 offset:16384
    v_mfma_f32_16x16x32_bf16 v[196:199], v[28:31], v[56:59], v[196:199]
    ds_read_b64_tr_b16 v[50:51], v10 offset:16896
    v_mfma_f32_16x16x32_bf16 v[200:203], v[24:27], v[60:63], v[200:203]
    ds_read_b64_tr_b16 v[52:53], v11 offset:16384
    v_mfma_f32_16x16x32_bf16 v[204:207], v[28:31], v[60:63], v[204:207]
    ds_read_b64_tr_b16 v[54:55], v11 offset:16896
    s_waitcnt lgkmcnt(4)
    v_mfma_f32_16x16x32_bf16 v[208:211], v[24:27], v[40:43], v[208:211]
    ds_read_b64_tr_b16 v[56:57], v12 offset:16384
    v_mfma_f32_16x16x32_bf16 v[212:215], v[28:31], v[40:43], v[212:215]
    ds_read_b64_tr_b16 v[58:59], v12 offset:16896
    v_mfma_f32_16x16x32_bf16 v[216:219], v[24:27], v[44:47], v[216:219]
    ds_read_b64_tr_b16 v[60:61], v13 offset:16384
    v_mfma_f32_16x16x32_bf16 v[220:223], v[28:31], v[44:47], v[220:223]
    ds_read_b64_tr_b16 v[62:63], v13 offset:16896
    s_waitcnt lgkmcnt(4)
    v_mfma_f32_16x16x32_bf16 v[128:131], v[48:51], v[24:27], v[128:131]
    ds_read_b64_tr_b16 v[40:41], v10 offset:4096
    v_mfma_f32_16x16x32_bf16 v[136:139], v[48:51], v[28:31], v[136:139]
    ds_read_b64_tr_b16 v[42:43], v10 offset:4608
    v_add_u32 v9, 40960, v9
    ds_read_b128 v[32:35], v9 offset:0
    v_mfma_f32_16x16x32_bf16 v[132:135], v[52:55], v[24:27], v[132:135]
    ds_read_b64_tr_b16 v[44:45], v11 offset:4096
    v_mfma_f32_16x16x32_bf16 v[140:143], v[52:55], v[28:31], v[140:143]
    ds_read_b64_tr_b16 v[46:47], v11 offset:4608
    ds_read_b128 v[36:39], v9 offset:2048
    s_waitcnt lgkmcnt(6)
    v_mfma_f32_16x16x32_bf16 v[144:147], v[56:59], v[24:27], v[144:147]
    ds_read_b64_tr_b16 v[48:49], v12 offset:4096
    v_mfma_f32_16x16x32_bf16 v[152:155], v[56:59], v[28:31], v[152:155]
    ds_read_b64_tr_b16 v[50:51], v12 offset:4608
    v_mfma_f32_16x16x32_bf16 v[148:151], v[60:63], v[24:27], v[148:151]
    ds_read_b64_tr_b16 v[52:53], v13 offset:4096
    v_mfma_f32_16x16x32_bf16 v[156:159], v[60:63], v[28:31], v[156:159]
    ds_read_b64_tr_b16 v[54:55], v13 offset:4608
    s_waitcnt lgkmcnt(4)
    v_mfma_f32_16x16x32_bf16 v[160:163], v[32:35], v[40:43], v[160:163]
    ds_read_b64_tr_b16 v[56:57], v10 offset:12288
    v_mfma_f32_16x16x32_bf16 v[164:167], v[36:39], v[40:43], v[164:167]
    ds_read_b64_tr_b16 v[58:59], v10 offset:12800
    v_mfma_f32_16x16x32_bf16 v[168:171], v[32:35], v[44:47], v[168:171]
    ds_read_b64_tr_b16 v[60:61], v11 offset:12288
    v_mfma_f32_16x16x32_bf16 v[172:175], v[36:39], v[44:47], v[172:175]
    ds_read_b64_tr_b16 v[62:63], v11 offset:12800
    s_waitcnt lgkmcnt(4)
    v_mfma_f32_16x16x32_bf16 v[176:179], v[32:35], v[48:51], v[176:179]
    ds_read_b64_tr_b16 v[40:41], v12 offset:12288
    v_mfma_f32_16x16x32_bf16 v[180:183], v[36:39], v[48:51], v[180:183]
    ds_read_b64_tr_b16 v[42:43], v12 offset:12800
    v_mfma_f32_16x16x32_bf16 v[184:187], v[32:35], v[52:55], v[184:187]
    ds_read_b64_tr_b16 v[44:45], v13 offset:12288
    v_mfma_f32_16x16x32_bf16 v[188:191], v[36:39], v[52:55], v[188:191]
    ds_read_b64_tr_b16 v[46:47], v13 offset:12800
    s_waitcnt lgkmcnt(4)
    v_mfma_f32_16x16x32_bf16 v[192:195], v[32:35], v[56:59], v[192:195]
    ds_read_b64_tr_b16 v[48:49], v10 offset:20480
    v_mfma_f32_16x16x32_bf16 v[196:199], v[36:39], v[56:59], v[196:199]
    ds_read_b64_tr_b16 v[50:51], v10 offset:20992
    v_mfma_f32_16x16x32_bf16 v[200:203], v[32:35], v[60:63], v[200:203]
    ds_read_b64_tr_b16 v[52:53], v11 offset:20480
    v_mfma_f32_16x16x32_bf16 v[204:207], v[36:39], v[60:63], v[204:207]
    ds_read_b64_tr_b16 v[54:55], v11 offset:20992
    s_waitcnt lgkmcnt(4)
    v_mfma_f32_16x16x32_bf16 v[208:211], v[32:35], v[40:43], v[208:211]
    ds_read_b64_tr_b16 v[56:57], v12 offset:20480
    v_mfma_f32_16x16x32_bf16 v[212:215], v[36:39], v[40:43], v[212:215]
    ds_read_b64_tr_b16 v[58:59], v12 offset:20992
    v_mfma_f32_16x16x32_bf16 v[216:219], v[32:35], v[44:47], v[216:219]
    ds_read_b64_tr_b16 v[60:61], v13 offset:20480
    v_mfma_f32_16x16x32_bf16 v[220:223], v[36:39], v[44:47], v[220:223]
    ds_read_b64_tr_b16 v[62:63], v13 offset:20992
    s_waitcnt lgkmcnt(4)
    v_mfma_f32_16x16x32_bf16 v[128:131], v[48:51], v[32:35], v[128:131]
    s_barrier
    v_add_u32 v10, 40960, v10
    ds_read_b64_tr_b16 v[40:41], v10 offset:0
    v_mfma_f32_16x16x32_bf16 v[136:139], v[48:51], v[36:39], v[136:139]
    ds_read_b64_tr_b16 v[42:43], v10 offset:512
    v_add_u32 v8, 40960, v8
    ds_read_b128 v[24:27], v8 offset:0
    v_mfma_f32_16x16x32_bf16 v[132:135], v[52:55], v[32:35], v[132:135]
    v_add_u32 v11, 40960, v11
    ds_read_b64_tr_b16 v[44:45], v11 offset:0
    v_mfma_f32_16x16x32_bf16 v[140:143], v[52:55], v[36:39], v[140:143]
    ds_read_b64_tr_b16 v[46:47], v11 offset:512
    ds_read_b128 v[28:31], v8 offset:2048
    s_waitcnt lgkmcnt(6)
    v_mfma_f32_16x16x32_bf16 v[144:147], v[56:59], v[32:35], v[144:147]
    v_add_u32 v12, 40960, v12
    ds_read_b64_tr_b16 v[48:49], v12 offset:0
    v_mfma_f32_16x16x32_bf16 v[152:155], v[56:59], v[36:39], v[152:155]
    ds_read_b64_tr_b16 v[50:51], v12 offset:512
    v_mfma_f32_16x16x32_bf16 v[148:151], v[60:63], v[32:35], v[148:151]
    v_add_u32 v13, 40960, v13
    ds_read_b64_tr_b16 v[52:53], v13 offset:0
    v_mfma_f32_16x16x32_bf16 v[156:159], v[60:63], v[36:39], v[156:159]
    ds_read_b64_tr_b16 v[54:55], v13 offset:512
    s_waitcnt lgkmcnt(4)
    v_mfma_f32_16x16x32_bf16 v[160:163], v[24:27], v[40:43], v[160:163]
    ds_read_b64_tr_b16 v[56:57], v10 offset:8192
    v_mfma_f32_16x16x32_bf16 v[164:167], v[28:31], v[40:43], v[164:167]
    ds_read_b64_tr_b16 v[58:59], v10 offset:8704
    v_mfma_f32_16x16x32_bf16 v[168:171], v[24:27], v[44:47], v[168:171]
    ds_read_b64_tr_b16 v[60:61], v11 offset:8192
    v_mfma_f32_16x16x32_bf16 v[172:175], v[28:31], v[44:47], v[172:175]
    ds_read_b64_tr_b16 v[62:63], v11 offset:8704
    s_waitcnt lgkmcnt(4)
    v_mfma_f32_16x16x32_bf16 v[176:179], v[24:27], v[48:51], v[176:179]
    ds_read_b64_tr_b16 v[40:41], v12 offset:8192
    v_mfma_f32_16x16x32_bf16 v[180:183], v[28:31], v[48:51], v[180:183]
    ds_read_b64_tr_b16 v[42:43], v12 offset:8704
    v_mfma_f32_16x16x32_bf16 v[184:187], v[24:27], v[52:55], v[184:187]
    ds_read_b64_tr_b16 v[44:45], v13 offset:8192
    v_mfma_f32_16x16x32_bf16 v[188:191], v[28:31], v[52:55], v[188:191]
    ds_read_b64_tr_b16 v[46:47], v13 offset:8704
    s_waitcnt lgkmcnt(4)
    v_mfma_f32_16x16x32_bf16 v[192:195], v[24:27], v[56:59], v[192:195]
    ds_read_b64_tr_b16 v[48:49], v10 offset:16384
    v_mfma_f32_16x16x32_bf16 v[196:199], v[28:31], v[56:59], v[196:199]
    ds_read_b64_tr_b16 v[50:51], v10 offset:16896
    v_mfma_f32_16x16x32_bf16 v[200:203], v[24:27], v[60:63], v[200:203]
    ds_read_b64_tr_b16 v[52:53], v11 offset:16384
    v_mfma_f32_16x16x32_bf16 v[204:207], v[28:31], v[60:63], v[204:207]
    ds_read_b64_tr_b16 v[54:55], v11 offset:16896
    s_waitcnt lgkmcnt(4)
    v_mfma_f32_16x16x32_bf16 v[208:211], v[24:27], v[40:43], v[208:211]
    ds_read_b64_tr_b16 v[56:57], v12 offset:16384
    v_mfma_f32_16x16x32_bf16 v[212:215], v[28:31], v[40:43], v[212:215]
    ds_read_b64_tr_b16 v[58:59], v12 offset:16896
    v_mfma_f32_16x16x32_bf16 v[216:219], v[24:27], v[44:47], v[216:219]
    ds_read_b64_tr_b16 v[60:61], v13 offset:16384
    v_mfma_f32_16x16x32_bf16 v[220:223], v[28:31], v[44:47], v[220:223]
    ds_read_b64_tr_b16 v[62:63], v13 offset:16896
    s_waitcnt lgkmcnt(4)
    v_mfma_f32_16x16x32_bf16 v[128:131], v[48:51], v[24:27], v[128:131]
    ds_read_b64_tr_b16 v[40:41], v10 offset:4096
    v_mfma_f32_16x16x32_bf16 v[136:139], v[48:51], v[28:31], v[136:139]
    ds_read_b64_tr_b16 v[42:43], v10 offset:4608
    v_add_u32 v9, 40960, v9
    ds_read_b128 v[32:35], v9 offset:0
    v_mfma_f32_16x16x32_bf16 v[132:135], v[52:55], v[24:27], v[132:135]
    ds_read_b64_tr_b16 v[44:45], v11 offset:4096
    v_mfma_f32_16x16x32_bf16 v[140:143], v[52:55], v[28:31], v[140:143]
    ds_read_b64_tr_b16 v[46:47], v11 offset:4608
    ds_read_b128 v[36:39], v9 offset:2048
    s_waitcnt lgkmcnt(6)
    v_mfma_f32_16x16x32_bf16 v[144:147], v[56:59], v[24:27], v[144:147]
    ds_read_b64_tr_b16 v[48:49], v12 offset:4096
    v_mfma_f32_16x16x32_bf16 v[152:155], v[56:59], v[28:31], v[152:155]
    ds_read_b64_tr_b16 v[50:51], v12 offset:4608
    v_mfma_f32_16x16x32_bf16 v[148:151], v[60:63], v[24:27], v[148:151]
    ds_read_b64_tr_b16 v[52:53], v13 offset:4096
    v_mfma_f32_16x16x32_bf16 v[156:159], v[60:63], v[28:31], v[156:159]
    ds_read_b64_tr_b16 v[54:55], v13 offset:4608
    s_waitcnt lgkmcnt(4)
    v_mfma_f32_16x16x32_bf16 v[160:163], v[32:35], v[40:43], v[160:163]
    ds_read_b64_tr_b16 v[56:57], v10 offset:12288
    v_mfma_f32_16x16x32_bf16 v[164:167], v[36:39], v[40:43], v[164:167]
    ds_read_b64_tr_b16 v[58:59], v10 offset:12800
    v_mfma_f32_16x16x32_bf16 v[168:171], v[32:35], v[44:47], v[168:171]
    ds_read_b64_tr_b16 v[60:61], v11 offset:12288
    v_mfma_f32_16x16x32_bf16 v[172:175], v[36:39], v[44:47], v[172:175]
    ds_read_b64_tr_b16 v[62:63], v11 offset:12800
    s_waitcnt lgkmcnt(4)
    v_mfma_f32_16x16x32_bf16 v[176:179], v[32:35], v[48:51], v[176:179]
    ds_read_b64_tr_b16 v[40:41], v12 offset:12288
    v_mfma_f32_16x16x32_bf16 v[180:183], v[36:39], v[48:51], v[180:183]
    ds_read_b64_tr_b16 v[42:43], v12 offset:12800
    v_mfma_f32_16x16x32_bf16 v[184:187], v[32:35], v[52:55], v[184:187]
    ds_read_b64_tr_b16 v[44:45], v13 offset:12288
    v_mfma_f32_16x16x32_bf16 v[188:191], v[36:39], v[52:55], v[188:191]
    ds_read_b64_tr_b16 v[46:47], v13 offset:12800
    s_waitcnt lgkmcnt(4)
    v_mfma_f32_16x16x32_bf16 v[192:195], v[32:35], v[56:59], v[192:195]
    ds_read_b64_tr_b16 v[48:49], v10 offset:20480
    v_mfma_f32_16x16x32_bf16 v[196:199], v[36:39], v[56:59], v[196:199]
    ds_read_b64_tr_b16 v[50:51], v10 offset:20992
    v_mfma_f32_16x16x32_bf16 v[200:203], v[32:35], v[60:63], v[200:203]
    ds_read_b64_tr_b16 v[52:53], v11 offset:20480
    v_mfma_f32_16x16x32_bf16 v[204:207], v[36:39], v[60:63], v[204:207]
    ds_read_b64_tr_b16 v[54:55], v11 offset:20992
    s_waitcnt lgkmcnt(4)
    v_mfma_f32_16x16x32_bf16 v[208:211], v[32:35], v[40:43], v[208:211]
    ds_read_b64_tr_b16 v[56:57], v12 offset:20480
    v_mfma_f32_16x16x32_bf16 v[212:215], v[36:39], v[40:43], v[212:215]
    ds_read_b64_tr_b16 v[58:59], v12 offset:20992
    v_mfma_f32_16x16x32_bf16 v[216:219], v[32:35], v[44:47], v[216:219]
    ds_read_b64_tr_b16 v[60:61], v13 offset:20480
    v_mfma_f32_16x16x32_bf16 v[220:223], v[36:39], v[44:47], v[220:223]
    ds_read_b64_tr_b16 v[62:63], v13 offset:20992
    s_waitcnt lgkmcnt(4)
    v_mfma_f32_16x16x32_bf16 v[128:131], v[48:51], v[32:35], v[128:131]
    v_mfma_f32_16x16x32_bf16 v[136:139], v[48:51], v[36:39], v[136:139]
    v_mfma_f32_16x16x32_bf16 v[132:135], v[52:55], v[32:35], v[132:135]
    v_mfma_f32_16x16x32_bf16 v[140:143], v[52:55], v[36:39], v[140:143]
    s_waitcnt lgkmcnt(0)
    v_mfma_f32_16x16x32_bf16 v[144:147], v[56:59], v[32:35], v[144:147]
    v_mfma_f32_16x16x32_bf16 v[152:155], v[56:59], v[36:39], v[152:155]
    v_mfma_f32_16x16x32_bf16 v[148:151], v[60:63], v[32:35], v[148:151]
    v_mfma_f32_16x16x32_bf16 v[156:159], v[60:63], v[36:39], v[156:159]
    v_pk_mul_f32 v[72:73], v[160:161], v[20:21]
    v_pk_mul_f32 v[74:75], v[162:163], v[20:21]
    v_pk_mul_f32 v[76:77], v[164:165], v[20:21]
    v_pk_mul_f32 v[78:79], v[166:167], v[20:21]
    v_exp_f32 v72, v72 clamp
    v_exp_f32 v73, v73 clamp
    v_exp_f32 v74, v74 clamp
    v_exp_f32 v75, v75 clamp
    v_exp_f32 v76, v76 clamp
    v_exp_f32 v77, v77 clamp
    v_exp_f32 v78, v78 clamp
    v_exp_f32 v79, v79 clamp
    v_max_f32 v160, v22, v160
    v_max_f32 v161, v22, v161
    v_max_f32 v162, v22, v162
    v_max_f32 v163, v22, v163
    v_max_f32 v164, v22, v164
    v_max_f32 v165, v22, v165
    v_max_f32 v166, v22, v166
    v_max_f32 v167, v22, v167
    v_pk_add_f32 v[160:161], v[160:161], v[72:73]
    v_pk_add_f32 v[162:163], v[162:163], v[74:75]
    v_pk_add_f32 v[164:165], v[164:165], v[76:77]
    v_pk_add_f32 v[166:167], v[166:167], v[78:79]
    v_pk_mul_f32 v[72:73], v[168:169], v[20:21]
    v_pk_mul_f32 v[74:75], v[170:171], v[20:21]
    v_pk_mul_f32 v[76:77], v[172:173], v[20:21]
    v_pk_mul_f32 v[78:79], v[174:175], v[20:21]
    s_barrier
    v_exp_f32 v72, v72 clamp
    v_exp_f32 v73, v73 clamp
    v_exp_f32 v74, v74 clamp
    v_exp_f32 v75, v75 clamp
    v_exp_f32 v76, v76 clamp
    v_exp_f32 v77, v77 clamp
    v_exp_f32 v78, v78 clamp
    v_exp_f32 v79, v79 clamp
    v_max_f32 v168, v22, v168
    v_max_f32 v169, v22, v169
    v_max_f32 v170, v22, v170
    v_max_f32 v171, v22, v171
    v_max_f32 v172, v22, v172
    v_max_f32 v173, v22, v173
    v_max_f32 v174, v22, v174
    v_max_f32 v175, v22, v175
    v_pk_add_f32 v[168:169], v[168:169], v[72:73]
    v_pk_add_f32 v[170:171], v[170:171], v[74:75]
    v_pk_add_f32 v[172:173], v[172:173], v[76:77]
    v_pk_add_f32 v[174:175], v[174:175], v[78:79]
    v_pk_mul_f32 v[72:73], v[176:177], v[20:21]
    v_pk_mul_f32 v[74:75], v[178:179], v[20:21]
    v_pk_mul_f32 v[76:77], v[180:181], v[20:21]
    v_pk_mul_f32 v[78:79], v[182:183], v[20:21]
    v_exp_f32 v72, v72 clamp
    v_exp_f32 v73, v73 clamp
    v_exp_f32 v74, v74 clamp
    v_exp_f32 v75, v75 clamp
    v_exp_f32 v76, v76 clamp
    v_exp_f32 v77, v77 clamp
    v_exp_f32 v78, v78 clamp
    v_exp_f32 v79, v79 clamp
    v_max_f32 v176, v22, v176
    v_max_f32 v177, v22, v177
    v_max_f32 v178, v22, v178
    v_max_f32 v179, v22, v179
    v_max_f32 v180, v22, v180
    v_max_f32 v181, v22, v181
    v_max_f32 v182, v22, v182
    v_max_f32 v183, v22, v183
    v_pk_add_f32 v[176:177], v[176:177], v[72:73]
    v_pk_add_f32 v[178:179], v[178:179], v[74:75]
    v_pk_add_f32 v[180:181], v[180:181], v[76:77]
    v_pk_add_f32 v[182:183], v[182:183], v[78:79]
    v_pk_mul_f32 v[72:73], v[184:185], v[20:21]
    v_pk_mul_f32 v[74:75], v[186:187], v[20:21]
    v_pk_mul_f32 v[76:77], v[188:189], v[20:21]
    v_pk_mul_f32 v[78:79], v[190:191], v[20:21]
    v_exp_f32 v72, v72 clamp
    v_exp_f32 v73, v73 clamp
    v_exp_f32 v74, v74 clamp
    v_exp_f32 v75, v75 clamp
    v_exp_f32 v76, v76 clamp
    v_exp_f32 v77, v77 clamp
    v_exp_f32 v78, v78 clamp
    v_exp_f32 v79, v79 clamp
    v_max_f32 v184, v22, v184
    v_max_f32 v185, v22, v185
    v_max_f32 v186, v22, v186
    v_max_f32 v187, v22, v187
    v_max_f32 v188, v22, v188
    v_max_f32 v189, v22, v189
    v_max_f32 v190, v22, v190
    v_max_f32 v191, v22, v191
    v_pk_add_f32 v[184:185], v[184:185], v[72:73]
    v_pk_add_f32 v[186:187], v[186:187], v[74:75]
    v_pk_add_f32 v[188:189], v[188:189], v[76:77]
    v_pk_add_f32 v[190:191], v[190:191], v[78:79]
    v_cvt_pk_bf16_f32 v160, v160, v161
    v_cvt_pk_bf16_f32 v161, v162, v163
    v_cvt_pk_bf16_f32 v162, v164, v165
    v_cvt_pk_bf16_f32 v163, v166, v167
    v_cvt_pk_bf16_f32 v164, v168, v169
    v_cvt_pk_bf16_f32 v165, v170, v171
    v_cvt_pk_bf16_f32 v166, v172, v173
    v_cvt_pk_bf16_f32 v167, v174, v175
    v_cvt_pk_bf16_f32 v168, v176, v177
    v_cvt_pk_bf16_f32 v169, v178, v179
    v_cvt_pk_bf16_f32 v170, v180, v181
    v_cvt_pk_bf16_f32 v171, v182, v183
    v_cvt_pk_bf16_f32 v172, v184, v185
    v_cvt_pk_bf16_f32 v173, v186, v187
    v_cvt_pk_bf16_f32 v174, v188, v189
    v_cvt_pk_bf16_f32 v175, v190, v191
    v_cvt_pk_bf16_f32 v176, v192, v193
    v_cvt_pk_bf16_f32 v177, v194, v195
    v_cvt_pk_bf16_f32 v178, v196, v197
    v_cvt_pk_bf16_f32 v179, v198, v199
    v_cvt_pk_bf16_f32 v180, v200, v201
    v_cvt_pk_bf16_f32 v181, v202, v203
    v_cvt_pk_bf16_f32 v182, v204, v205
    v_cvt_pk_bf16_f32 v183, v206, v207
    v_cvt_pk_bf16_f32 v184, v208, v209
    v_cvt_pk_bf16_f32 v185, v210, v211
    v_cvt_pk_bf16_f32 v186, v212, v213
    v_cvt_pk_bf16_f32 v187, v214, v215
    v_cvt_pk_bf16_f32 v188, v216, v217
    v_cvt_pk_bf16_f32 v189, v218, v219
    v_cvt_pk_bf16_f32 v190, v220, v221
    v_cvt_pk_bf16_f32 v191, v222, v223
    v_mov_b32 v24, 0x3f803f80
    v_mov_b32 v25, 0x3f803f80
    v_mov_b32 v26, 0x3f803f80
    v_mov_b32 v27, 0x3f803f80
    v_mfma_f32_16x16x32_bf16 v[192:195], v[160:163], v[176:179], 0
    s_nop 0
    v_mfma_f32_16x16x32_bf16 v[208:211], v[160:163], v[24:27], 0
    v_mfma_f32_16x16x32_bf16 v[196:199], v[164:167], v[180:183], 0
    v_mfma_f32_16x16x32_bf16 v[212:215], v[164:167], v[24:27], 0
    v_mfma_f32_16x16x32_bf16 v[200:203], v[168:171], v[184:187], 0
    v_mfma_f32_16x16x32_bf16 v[216:219], v[168:171], v[24:27], 0
    v_mfma_f32_16x16x32_bf16 v[204:207], v[172:175], v[188:191], 0
    v_mfma_f32_16x16x32_bf16 v[220:223], v[172:175], v[24:27], 0
    v_cvt_pk_bf16_f32 v128, v128, v129
    v_cvt_pk_bf16_f32 v129, v130, v131
    v_cvt_pk_bf16_f32 v130, v132, v133
    v_cvt_pk_bf16_f32 v131, v134, v135
    v_cvt_pk_bf16_f32 v132, v136, v137
    v_cvt_pk_bf16_f32 v133, v138, v139
    v_cvt_pk_bf16_f32 v134, v140, v141
    v_cvt_pk_bf16_f32 v135, v142, v143
    v_cvt_pk_bf16_f32 v136, v144, v145
    v_cvt_pk_bf16_f32 v137, v146, v147
    v_cvt_pk_bf16_f32 v138, v148, v149
    v_cvt_pk_bf16_f32 v139, v150, v151
    v_cvt_pk_bf16_f32 v140, v152, v153
    v_cvt_pk_bf16_f32 v141, v154, v155
    v_cvt_pk_bf16_f32 v142, v156, v157
    v_cvt_pk_bf16_f32 v143, v158, v159
    ds_write_b128 v84, v[192:195] offset:0
    ds_write_b128 v84, v[196:199] offset:1024
    ds_write_b128 v84, v[200:203] offset:2048
    ds_write_b128 v84, v[204:207] offset:3072
    s_mov_b32 exec_lo, 0x10001
    s_mov_b32 exec_hi, 0x10001
    ds_write_b128 v85, v[208:211] offset:4096
    ds_write_b128 v85, v[212:215] offset:4160
    ds_write_b128 v85, v[216:219] offset:4224
    ds_write_b128 v85, v[220:223] offset:4288
    s_mov_b64 exec, -1
    buffer_store_dwordx4 v[128:131], v2, s[12:15], s25 offen offset:0 sc1
    buffer_store_dwordx4 v[132:135], v2, s[12:15], s24 offen offset:0 sc1
    buffer_store_dwordx4 v[136:139], v2, s[12:15], s25 offen offset:1024 sc1
    buffer_store_dwordx4 v[140:143], v2, s[12:15], s24 offen offset:1024 sc1
    s_waitcnt lgkmcnt(0)
    s_barrier
    s_cmp_eq_u32 s20, 7
    s_cbranch_scc0 L_cq_b
    v_lshrrev_b32 v4, 3, v6
    v_lshlrev_b32 v2, 12, v4
    v_lshrrev_b32 v4, 4, v6
    v_xor_b32 v4, v4, v6
    v_and_b32 v4, 7, v4
    v_lshl_add_u32 v2, v4, 4, v2
    s_lshl_b32 s24, s19, 19
    s_lshl_b32 s23, s30, 11
    s_add_u32 s24, s24, s23
    s_mov_b32 s4, s46
    s_mov_b32 s5, s47
    s_mov_b32 s6, 0x800000
    s_mov_b32 s96, s40
    s_mov_b32 s97, s41
    s_mov_b32 s98, 0x80000
    v_lshrrev_b32 v4, 3, v1
    v_lshlrev_b32 v7, 10, v4
    v_bfe_u32 v4, v1, 4, 1
    v_lshlrev_b32 v4, 2, v4
    v_and_b32 v5, 7, v1
    v_xor_b32 v4, v4, v5
    v_lshl_add_u32 v7, v4, 4, v7
    s_lshl_b32 s23, s17, 15
    v_add_u32 v7, s23, v7
    v_mov_b32 v3, v7
    s_mov_b32 s8, s50
    s_mov_b32 s9, s51
    s_mov_b32 s10, 0xe0000
    s_lshl_b32 s23, s19, 8
    v_lshlrev_b32 v22, 2, v1
    v_add_u32 v70, s23, v22
    global_load_dword v70, v70, s[48:49]
    v_lshlrev_b32 v17, 4, v1
    v_add_u32 v14, s27, v17
    v_add_u32 v15, 65536, v14
    v_add_u32 v16, 131072, v14
    s_branch L_o
L_cq_b:
    v_add_u32 v8, -122880, v8
    ds_read_b128 v[24:27], v8 offset:0
    ds_read_b128 v[28:31], v8 offset:2048
    v_add_u32 v10, -122880, v10
    ds_read_b64_tr_b16 v[40:41], v10 offset:0
    ds_read_b64_tr_b16 v[42:43], v10 offset:512
    v_add_u32 v11, -122880, v11
    ds_read_b64_tr_b16 v[44:45], v11 offset:0
    ds_read_b64_tr_b16 v[46:47], v11 offset:512
    v_add_u32 v12, -122880, v12
    ds_read_b64_tr_b16 v[48:49], v12 offset:0
    ds_read_b64_tr_b16 v[50:51], v12 offset:512
    v_add_u32 v13, -122880, v13
    ds_read_b64_tr_b16 v[52:53], v13 offset:0
    ds_read_b64_tr_b16 v[54:55], v13 offset:512
    s_waitcnt lgkmcnt(4)
    v_mfma_f32_16x16x32_bf16 v[192:195], v[40:43], v[24:27], 0
    ds_read_b64_tr_b16 v[56:57], v10 offset:4096
    v_mfma_f32_16x16x32_bf16 v[200:203], v[40:43], v[28:31], 0
    ds_read_b64_tr_b16 v[58:59], v10 offset:4608
    v_add_u32 v9, -122880, v9
    ds_read_b128 v[32:35], v9 offset:0
    v_mfma_f32_16x16x32_bf16 v[196:199], v[44:47], v[24:27], 0
    ds_read_b64_tr_b16 v[60:61], v11 offset:4096
    v_mfma_f32_16x16x32_bf16 v[204:207], v[44:47], v[28:31], 0
    ds_read_b64_tr_b16 v[62:63], v11 offset:4608
    ds_read_b128 v[36:39], v9 offset:2048
    s_waitcnt lgkmcnt(6)
    v_mfma_f32_16x16x32_bf16 v[208:211], v[48:51], v[24:27], 0
    ds_read_b64_tr_b16 v[40:41], v12 offset:4096
    v_mfma_f32_16x16x32_bf16 v[216:219], v[48:51], v[28:31], 0
    ds_read_b64_tr_b16 v[42:43], v12 offset:4608
    v_mfma_f32_16x16x32_bf16 v[212:215], v[52:55], v[24:27], 0
    ds_read_b64_tr_b16 v[44:45], v13 offset:4096
    v_mfma_f32_16x16x32_bf16 v[220:223], v[52:55], v[28:31], 0
    ds_read_b64_tr_b16 v[46:47], v13 offset:4608
    s_waitcnt lgkmcnt(4)
    v_mfma_f32_16x16x32_bf16 v[192:195], v[56:59], v[32:35], v[192:195]
    v_add_u32 v10, 40960, v10
    ds_read_b64_tr_b16 v[48:49], v10 offset:0
    v_mfma_f32_16x16x32_bf16 v[200:203], v[56:59], v[36:39], v[200:203]
    ds_read_b64_tr_b16 v[50:51], v10 offset:512
    v_add_u32 v8, 40960, v8
    ds_read_b128 v[24:27], v8 offset:0
    v_and_b32 v4, 15, v1
    v_lshlrev_b32 v4, 2, v4
    s_lshl_b32 s23, s19, 9
    s_lshl_b32 s22, s17, 7
    s_add_u32 s23, s23, s22
    s_add_u32 s23, s23, 0x1610000
    buffer_load_dword v6, v4, s[12:15], s23 offen offset:0 sc1
    buffer_load_dword v7, v4, s[12:15], s23 offen offset:64 sc1
    v_mfma_f32_16x16x32_bf16 v[196:199], v[60:63], v[32:35], v[196:199]
    v_add_u32 v11, 40960, v11
    ds_read_b64_tr_b16 v[52:53], v11 offset:0
    v_mfma_f32_16x16x32_bf16 v[204:207], v[60:63], v[36:39], v[204:207]
    ds_read_b64_tr_b16 v[54:55], v11 offset:512
    ds_read_b128 v[28:31], v8 offset:2048
    s_waitcnt lgkmcnt(6)
    v_mfma_f32_16x16x32_bf16 v[208:211], v[40:43], v[32:35], v[208:211]
    v_add_u32 v12, 40960, v12
    ds_read_b64_tr_b16 v[56:57], v12 offset:0
    v_mfma_f32_16x16x32_bf16 v[216:219], v[40:43], v[36:39], v[216:219]
    ds_read_b64_tr_b16 v[58:59], v12 offset:512
    v_mfma_f32_16x16x32_bf16 v[212:215], v[44:47], v[32:35], v[212:215]
    v_add_u32 v13, 40960, v13
    ds_read_b64_tr_b16 v[60:61], v13 offset:0
    v_mfma_f32_16x16x32_bf16 v[220:223], v[44:47], v[36:39], v[220:223]
    ds_read_b64_tr_b16 v[62:63], v13 offset:512
    s_waitcnt lgkmcnt(4)
    v_mfma_f32_16x16x32_bf16 v[192:195], v[48:51], v[24:27], v[192:195]
    ds_read_b64_tr_b16 v[40:41], v10 offset:4096
    v_mfma_f32_16x16x32_bf16 v[200:203], v[48:51], v[28:31], v[200:203]
    ds_read_b64_tr_b16 v[42:43], v10 offset:4608
    v_add_u32 v9, 40960, v9
    ds_read_b128 v[32:35], v9 offset:0
    v_mfma_f32_16x16x32_bf16 v[196:199], v[52:55], v[24:27], v[196:199]
    ds_read_b64_tr_b16 v[44:45], v11 offset:4096
    v_mfma_f32_16x16x32_bf16 v[204:207], v[52:55], v[28:31], v[204:207]
    ds_read_b64_tr_b16 v[46:47], v11 offset:4608
    ds_read_b128 v[36:39], v9 offset:2048
    s_waitcnt lgkmcnt(6)
    v_mfma_f32_16x16x32_bf16 v[208:211], v[56:59], v[24:27], v[208:211]
    ds_read_b64_tr_b16 v[48:49], v12 offset:4096
    v_mfma_f32_16x16x32_bf16 v[216:219], v[56:59], v[28:31], v[216:219]
    ds_read_b64_tr_b16 v[50:51], v12 offset:4608
    v_mfma_f32_16x16x32_bf16 v[212:215], v[60:63], v[24:27], v[212:215]
    ds_read_b64_tr_b16 v[52:53], v13 offset:4096
    v_mfma_f32_16x16x32_bf16 v[220:223], v[60:63], v[28:31], v[220:223]
    ds_read_b64_tr_b16 v[54:55], v13 offset:4608
    s_waitcnt lgkmcnt(4)
    v_mfma_f32_16x16x32_bf16 v[192:195], v[40:43], v[32:35], v[192:195]
    v_add_u32 v10, 40960, v10
    ds_read_b64_tr_b16 v[56:57], v10 offset:0
    v_mfma_f32_16x16x32_bf16 v[200:203], v[40:43], v[36:39], v[200:203]
    ds_read_b64_tr_b16 v[58:59], v10 offset:512
    v_add_u32 v8, 40960, v8
    ds_read_b128 v[24:27], v8 offset:0
    v_mfma_f32_16x16x32_bf16 v[196:199], v[44:47], v[32:35], v[196:199]
    v_add_u32 v11, 40960, v11
    ds_read_b64_tr_b16 v[60:61], v11 offset:0
    v_mfma_f32_16x16x32_bf16 v[204:207], v[44:47], v[36:39], v[204:207]
    ds_read_b64_tr_b16 v[62:63], v11 offset:512
    ds_read_b128 v[28:31], v8 offset:2048
    s_waitcnt lgkmcnt(6)
    v_mfma_f32_16x16x32_bf16 v[208:211], v[48:51], v[32:35], v[208:211]
    v_add_u32 v12, 40960, v12
    ds_read_b64_tr_b16 v[40:41], v12 offset:0
    v_mfma_f32_16x16x32_bf16 v[216:219], v[48:51], v[36:39], v[216:219]
    ds_read_b64_tr_b16 v[42:43], v12 offset:512
    v_mfma_f32_16x16x32_bf16 v[212:215], v[52:55], v[32:35], v[212:215]
    v_add_u32 v13, 40960, v13
    ds_read_b64_tr_b16 v[44:45], v13 offset:0
    v_mfma_f32_16x16x32_bf16 v[220:223], v[52:55], v[36:39], v[220:223]
    ds_read_b64_tr_b16 v[46:47], v13 offset:512
    s_waitcnt lgkmcnt(4)
    v_mfma_f32_16x16x32_bf16 v[192:195], v[56:59], v[24:27], v[192:195]
    ds_read_b64_tr_b16 v[48:49], v10 offset:4096
    v_mfma_f32_16x16x32_bf16 v[200:203], v[56:59], v[28:31], v[200:203]
    ds_read_b64_tr_b16 v[50:51], v10 offset:4608
    v_add_u32 v9, 40960, v9
    ds_read_b128 v[32:35], v9 offset:0
    v_mfma_f32_16x16x32_bf16 v[196:199], v[60:63], v[24:27], v[196:199]
    ds_read_b64_tr_b16 v[52:53], v11 offset:4096
    v_mfma_f32_16x16x32_bf16 v[204:207], v[60:63], v[28:31], v[204:207]
    ds_read_b64_tr_b16 v[54:55], v11 offset:4608
    ds_read_b128 v[36:39], v9 offset:2048
    s_waitcnt lgkmcnt(6)
    v_mfma_f32_16x16x32_bf16 v[208:211], v[40:43], v[24:27], v[208:211]
    ds_read_b64_tr_b16 v[56:57], v12 offset:4096
    v_mfma_f32_16x16x32_bf16 v[216:219], v[40:43], v[28:31], v[216:219]
    ds_read_b64_tr_b16 v[58:59], v12 offset:4608
    v_mfma_f32_16x16x32_bf16 v[212:215], v[44:47], v[24:27], v[212:215]
    ds_read_b64_tr_b16 v[60:61], v13 offset:4096
    v_mfma_f32_16x16x32_bf16 v[220:223], v[44:47], v[28:31], v[220:223]
    ds_read_b64_tr_b16 v[62:63], v13 offset:4608
    s_waitcnt lgkmcnt(4)
    v_mfma_f32_16x16x32_bf16 v[192:195], v[48:51], v[32:35], v[192:195]
    v_add_u32 v10, 40960, v10
    ds_read_b64_tr_b16 v[40:41], v10 offset:0
    v_mfma_f32_16x16x32_bf16 v[200:203], v[48:51], v[36:39], v[200:203]
    ds_read_b64_tr_b16 v[42:43], v10 offset:512
    v_add_u32 v8, 40960, v8
    ds_read_b128 v[24:27], v8 offset:0
    v_mfma_f32_16x16x32_bf16 v[196:199], v[52:55], v[32:35], v[196:199]
    v_add_u32 v11, 40960, v11
    ds_read_b64_tr_b16 v[44:45], v11 offset:0
    v_mfma_f32_16x16x32_bf16 v[204:207], v[52:55], v[36:39], v[204:207]
    ds_read_b64_tr_b16 v[46:47], v11 offset:512
    ds_read_b128 v[28:31], v8 offset:2048
    s_waitcnt lgkmcnt(6)
    v_mfma_f32_16x16x32_bf16 v[208:211], v[56:59], v[32:35], v[208:211]
    v_add_u32 v12, 40960, v12
    ds_read_b64_tr_b16 v[48:49], v12 offset:0
    v_mfma_f32_16x16x32_bf16 v[216:219], v[56:59], v[36:39], v[216:219]
    ds_read_b64_tr_b16 v[50:51], v12 offset:512
    v_mfma_f32_16x16x32_bf16 v[212:215], v[60:63], v[32:35], v[212:215]
    v_add_u32 v13, 40960, v13
    ds_read_b64_tr_b16 v[52:53], v13 offset:0
    v_mfma_f32_16x16x32_bf16 v[220:223], v[60:63], v[36:39], v[220:223]
    ds_read_b64_tr_b16 v[54:55], v13 offset:512
    s_waitcnt lgkmcnt(4)
    v_mfma_f32_16x16x32_bf16 v[192:195], v[40:43], v[24:27], v[192:195]
    ds_read_b64_tr_b16 v[56:57], v10 offset:4096
    v_mfma_f32_16x16x32_bf16 v[200:203], v[40:43], v[28:31], v[200:203]
    ds_read_b64_tr_b16 v[58:59], v10 offset:4608
    v_add_u32 v9, 40960, v9
    ds_read_b128 v[32:35], v9 offset:0
    v_mfma_f32_16x16x32_bf16 v[196:199], v[44:47], v[24:27], v[196:199]
    ds_read_b64_tr_b16 v[60:61], v11 offset:4096
    v_mfma_f32_16x16x32_bf16 v[204:207], v[44:47], v[28:31], v[204:207]
    ds_read_b64_tr_b16 v[62:63], v11 offset:4608
    ds_read_b128 v[36:39], v9 offset:2048
    s_waitcnt lgkmcnt(6)
    v_mfma_f32_16x16x32_bf16 v[208:211], v[48:51], v[24:27], v[208:211]
    ds_read_b64_tr_b16 v[40:41], v12 offset:4096
    v_mfma_f32_16x16x32_bf16 v[216:219], v[48:51], v[28:31], v[216:219]
    ds_read_b64_tr_b16 v[42:43], v12 offset:4608
    v_mfma_f32_16x16x32_bf16 v[212:215], v[52:55], v[24:27], v[212:215]
    ds_read_b64_tr_b16 v[44:45], v13 offset:4096
    v_mfma_f32_16x16x32_bf16 v[220:223], v[52:55], v[28:31], v[220:223]
    ds_read_b64_tr_b16 v[46:47], v13 offset:4608
    s_waitcnt lgkmcnt(4)
    v_mfma_f32_16x16x32_bf16 v[192:195], v[56:59], v[32:35], v[192:195]
    v_add_u32 v10, -122880, v10
    ds_read_b64_tr_b16 v[48:49], v10 offset:8192
    v_mfma_f32_16x16x32_bf16 v[200:203], v[56:59], v[36:39], v[200:203]
    ds_read_b64_tr_b16 v[50:51], v10 offset:8704
    v_mfma_f32_16x16x32_bf16 v[196:199], v[60:63], v[32:35], v[196:199]
    v_add_u32 v11, -122880, v11
    ds_read_b64_tr_b16 v[52:53], v11 offset:8192
    v_mfma_f32_16x16x32_bf16 v[204:207], v[60:63], v[36:39], v[204:207]
    ds_read_b64_tr_b16 v[54:55], v11 offset:8704
    s_waitcnt lgkmcnt(4)
    v_mfma_f32_16x16x32_bf16 v[208:211], v[40:43], v[32:35], v[208:211]
    v_add_u32 v12, -122880, v12
    ds_read_b64_tr_b16 v[56:57], v12 offset:8192
    v_mfma_f32_16x16x32_bf16 v[216:219], v[40:43], v[36:39], v[216:219]
    ds_read_b64_tr_b16 v[58:59], v12 offset:8704
    s_waitcnt vmcnt(0)
    s_barrier
    s_cmp_lg_u32 s16, 0
    s_cbranch_scc1 L_of8
    v_mov_b32 v4, s28
    v_mov_b32 v5, 0
    s_mov_b64 exec, 1
    buffer_store_dword v4, v5, s[12:15], s26 offen sc1
    s_mov_b64 exec, -1
L_of8:
    v_mfma_f32_16x16x32_bf16 v[212:215], v[44:47], v[32:35], v[212:215]
    v_add_u32 v13, -122880, v13
    ds_read_b64_tr_b16 v[60:61], v13 offset:8192
    v_mfma_f32_16x16x32_bf16 v[220:223], v[44:47], v[36:39], v[220:223]
    ds_read_b64_tr_b16 v[62:63], v13 offset:8704
    s_waitcnt lgkmcnt(4)
    v_mfma_f32_16x16x32_bf16 v[192:195], v[48:51], v[96:99], v[192:195]
    ds_read_b64_tr_b16 v[40:41], v10 offset:12288
    v_mfma_f32_16x16x32_bf16 v[200:203], v[48:51], v[100:103], v[200:203]
    ds_read_b64_tr_b16 v[42:43], v10 offset:12800
    v_mfma_f32_16x16x32_bf16 v[196:199], v[52:55], v[96:99], v[196:199]
    ds_read_b64_tr_b16 v[44:45], v11 offset:12288
    v_mfma_f32_16x16x32_bf16 v[204:207], v[52:55], v[100:103], v[204:207]
    ds_read_b64_tr_b16 v[46:47], v11 offset:12800
    s_waitcnt lgkmcnt(4)
    v_mfma_f32_16x16x32_bf16 v[208:211], v[56:59], v[96:99], v[208:211]
    ds_read_b64_tr_b16 v[48:49], v12 offset:12288
    v_mfma_f32_16x16x32_bf16 v[216:219], v[56:59], v[100:103], v[216:219]
    ds_read_b64_tr_b16 v[50:51], v12 offset:12800
    v_mfma_f32_16x16x32_bf16 v[212:215], v[60:63], v[96:99], v[212:215]
    ds_read_b64_tr_b16 v[52:53], v13 offset:12288
    v_mfma_f32_16x16x32_bf16 v[220:223], v[60:63], v[100:103], v[220:223]
    ds_read_b64_tr_b16 v[54:55], v13 offset:12800
    s_waitcnt lgkmcnt(4)
    v_mfma_f32_16x16x32_bf16 v[192:195], v[40:43], v[104:107], v[192:195]
    v_add_u32 v10, 40960, v10
    ds_read_b64_tr_b16 v[56:57], v10 offset:8192
    v_mfma_f32_16x16x32_bf16 v[200:203], v[40:43], v[108:111], v[200:203]
    ds_read_b64_tr_b16 v[58:59], v10 offset:8704
    v_mfma_f32_16x16x32_bf16 v[196:199], v[44:47], v[104:107], v[196:199]
    v_add_u32 v11, 40960, v11
    ds_read_b64_tr_b16 v[60:61], v11 offset:8192
    v_mfma_f32_16x16x32_bf16 v[204:207], v[44:47], v[108:111], v[204:207]
    ds_read_b64_tr_b16 v[62:63], v11 offset:8704
    s_waitcnt lgkmcnt(4)
    v_mfma_f32_16x16x32_bf16 v[208:211], v[48:51], v[104:107], v[208:211]
    v_add_u32 v12, 40960, v12
    ds_read_b64_tr_b16 v[40:41], v12 offset:8192
    v_mfma_f32_16x16x32_bf16 v[216:219], v[48:51], v[108:111], v[216:219]
    ds_read_b64_tr_b16 v[42:43], v12 offset:8704
    v_mfma_f32_16x16x32_bf16 v[212:215], v[52:55], v[104:107], v[212:215]
    v_add_u32 v13, 40960, v13
    ds_read_b64_tr_b16 v[44:45], v13 offset:8192
    v_mfma_f32_16x16x32_bf16 v[220:223], v[52:55], v[108:111], v[220:223]
    ds_read_b64_tr_b16 v[46:47], v13 offset:8704
    s_waitcnt lgkmcnt(4)
    v_mfma_f32_16x16x32_bf16 v[192:195], v[56:59], v[112:115], v[192:195]
    ds_read_b64_tr_b16 v[48:49], v10 offset:12288
    v_mfma_f32_16x16x32_bf16 v[200:203], v[56:59], v[116:119], v[200:203]
    ds_read_b64_tr_b16 v[50:51], v10 offset:12800
    v_mfma_f32_16x16x32_bf16 v[196:199], v[60:63], v[112:115], v[196:199]
    ds_read_b64_tr_b16 v[52:53], v11 offset:12288
    v_mfma_f32_16x16x32_bf16 v[204:207], v[60:63], v[116:119], v[204:207]
    ds_read_b64_tr_b16 v[54:55], v11 offset:12800
    s_waitcnt lgkmcnt(4)
    v_mfma_f32_16x16x32_bf16 v[208:211], v[40:43], v[112:115], v[208:211]
    ds_read_b64_tr_b16 v[56:57], v12 offset:12288
    v_mfma_f32_16x16x32_bf16 v[216:219], v[40:43], v[116:119], v[216:219]
    ds_read_b64_tr_b16 v[58:59], v12 offset:12800
    v_mfma_f32_16x16x32_bf16 v[212:215], v[44:47], v[112:115], v[212:215]
    ds_read_b64_tr_b16 v[60:61], v13 offset:12288
    v_mfma_f32_16x16x32_bf16 v[220:223], v[44:47], v[116:119], v[220:223]
    ds_read_b64_tr_b16 v[62:63], v13 offset:12800
    s_waitcnt lgkmcnt(4)
    v_mfma_f32_16x16x32_bf16 v[192:195], v[48:51], v[120:123], v[192:195]
    v_add_u32 v10, 40960, v10
    ds_read_b64_tr_b16 v[40:41], v10 offset:8192
    v_mfma_f32_16x16x32_bf16 v[200:203], v[48:51], v[124:127], v[200:203]
    ds_read_b64_tr_b16 v[42:43], v10 offset:8704
    v_mfma_f32_16x16x32_bf16 v[196:199], v[52:55], v[120:123], v[196:199]
    v_add_u32 v11, 40960, v11
    ds_read_b64_tr_b16 v[44:45], v11 offset:8192
    v_mfma_f32_16x16x32_bf16 v[204:207], v[52:55], v[124:127], v[204:207]
    ds_read_b64_tr_b16 v[46:47], v11 offset:8704
    s_waitcnt lgkmcnt(4)
    v_mfma_f32_16x16x32_bf16 v[208:211], v[56:59], v[120:123], v[208:211]
    v_add_u32 v12, 40960, v12
    ds_read_b64_tr_b16 v[48:49], v12 offset:8192
    v_mfma_f32_16x16x32_bf16 v[216:219], v[56:59], v[124:127], v[216:219]
    ds_read_b64_tr_b16 v[50:51], v12 offset:8704
    v_mfma_f32_16x16x32_bf16 v[212:215], v[60:63], v[120:123], v[212:215]
    v_add_u32 v13, 40960, v13
    ds_read_b64_tr_b16 v[52:53], v13 offset:8192
    v_mfma_f32_16x16x32_bf16 v[220:223], v[60:63], v[124:127], v[220:223]
    ds_read_b64_tr_b16 v[54:55], v13 offset:8704
    s_waitcnt lgkmcnt(4)
    v_mfma_f32_16x16x32_bf16 v[192:195], v[40:43], v[224:227], v[192:195]
    ds_read_b64_tr_b16 v[56:57], v10 offset:12288
    v_mfma_f32_16x16x32_bf16 v[200:203], v[40:43], v[228:231], v[200:203]
    ds_read_b64_tr_b16 v[58:59], v10 offset:12800
    v_mfma_f32_16x16x32_bf16 v[196:199], v[44:47], v[224:227], v[196:199]
    ds_read_b64_tr_b16 v[60:61], v11 offset:12288
    v_mfma_f32_16x16x32_bf16 v[204:207], v[44:47], v[228:231], v[204:207]
    ds_read_b64_tr_b16 v[62:63], v11 offset:12800
    s_waitcnt lgkmcnt(4)
    v_mfma_f32_16x16x32_bf16 v[208:211], v[48:51], v[224:227], v[208:211]
    ds_read_b64_tr_b16 v[40:41], v12 offset:12288
    v_mfma_f32_16x16x32_bf16 v[216:219], v[48:51], v[228:231], v[216:219]
    ds_read_b64_tr_b16 v[42:43], v12 offset:12800
    v_mfma_f32_16x16x32_bf16 v[212:215], v[52:55], v[224:227], v[212:215]
    ds_read_b64_tr_b16 v[44:45], v13 offset:12288
    v_mfma_f32_16x16x32_bf16 v[220:223], v[52:55], v[228:231], v[220:223]
    ds_read_b64_tr_b16 v[46:47], v13 offset:12800
    s_waitcnt lgkmcnt(4)
    v_mfma_f32_16x16x32_bf16 v[192:195], v[56:59], v[232:235], v[192:195]
    v_add_u32 v10, 40960, v10
    ds_read_b64_tr_b16 v[48:49], v10 offset:8192
    v_mfma_f32_16x16x32_bf16 v[200:203], v[56:59], v[236:239], v[200:203]
    ds_read_b64_tr_b16 v[50:51], v10 offset:8704
    v_mfma_f32_16x16x32_bf16 v[196:199], v[60:63], v[232:235], v[196:199]
    v_add_u32 v11, 40960, v11
    ds_read_b64_tr_b16 v[52:53], v11 offset:8192
    v_mfma_f32_16x16x32_bf16 v[204:207], v[60:63], v[236:239], v[204:207]
    ds_read_b64_tr_b16 v[54:55], v11 offset:8704
    s_waitcnt lgkmcnt(4)
    v_mfma_f32_16x16x32_bf16 v[208:211], v[40:43], v[232:235], v[208:211]
    v_add_u32 v12, 40960, v12
    ds_read_b64_tr_b16 v[56:57], v12 offset:8192
    v_mfma_f32_16x16x32_bf16 v[216:219], v[40:43], v[236:239], v[216:219]
    ds_read_b64_tr_b16 v[58:59], v12 offset:8704
    v_mfma_f32_16x16x32_bf16 v[212:215], v[44:47], v[232:235], v[212:215]
    v_add_u32 v13, 40960, v13
    ds_read_b64_tr_b16 v[60:61], v13 offset:8192
    v_mfma_f32_16x16x32_bf16 v[220:223], v[44:47], v[236:239], v[220:223]
    ds_read_b64_tr_b16 v[62:63], v13 offset:8704
    s_waitcnt lgkmcnt(4)
    v_mfma_f32_16x16x32_bf16 v[192:195], v[48:51], v[240:243], v[192:195]
    ds_read_b64_tr_b16 v[40:41], v10 offset:12288
    v_mfma_f32_16x16x32_bf16 v[200:203], v[48:51], v[244:247], v[200:203]
    ds_read_b64_tr_b16 v[42:43], v10 offset:12800
    v_mfma_f32_16x16x32_bf16 v[196:199], v[52:55], v[240:243], v[196:199]
    ds_read_b64_tr_b16 v[44:45], v11 offset:12288
    v_mfma_f32_16x16x32_bf16 v[204:207], v[52:55], v[244:247], v[204:207]
    ds_read_b64_tr_b16 v[46:47], v11 offset:12800
    s_waitcnt lgkmcnt(4)
    v_mfma_f32_16x16x32_bf16 v[208:211], v[56:59], v[240:243], v[208:211]
    ds_read_b64_tr_b16 v[48:49], v12 offset:12288
    v_mfma_f32_16x16x32_bf16 v[216:219], v[56:59], v[244:247], v[216:219]
    ds_read_b64_tr_b16 v[50:51], v12 offset:12800
    v_mfma_f32_16x16x32_bf16 v[212:215], v[60:63], v[240:243], v[212:215]
    ds_read_b64_tr_b16 v[52:53], v13 offset:12288
    v_mfma_f32_16x16x32_bf16 v[220:223], v[60:63], v[244:247], v[220:223]
    ds_read_b64_tr_b16 v[54:55], v13 offset:12800
    s_waitcnt lgkmcnt(4)
    v_mfma_f32_16x16x32_bf16 v[192:195], v[40:43], v[248:251], v[192:195]
    v_mfma_f32_16x16x32_bf16 v[200:203], v[40:43], v[252:255], v[200:203]
    v_mfma_f32_16x16x32_bf16 v[196:199], v[44:47], v[248:251], v[196:199]
    v_mfma_f32_16x16x32_bf16 v[204:207], v[44:47], v[252:255], v[204:207]
    s_waitcnt lgkmcnt(0)
    v_mfma_f32_16x16x32_bf16 v[208:211], v[48:51], v[248:251], v[208:211]
    v_mfma_f32_16x16x32_bf16 v[216:219], v[48:51], v[252:255], v[216:219]
    v_mfma_f32_16x16x32_bf16 v[212:215], v[52:55], v[248:251], v[212:215]
    v_mfma_f32_16x16x32_bf16 v[220:223], v[52:55], v[252:255], v[220:223]
L_tail:
    s_barrier
    s_lshl_b32 s24, s20, 2
    s_add_u32 s24, s24, s17
    s_lshl_b32 s25, s24, 1
    s_add_u32 s24, s25, s30
    s_lshl_b32 s24, s24, 16
    v_sub_f32 v6, 1.0, v6
    v_sub_f32 v7, 1.0, v7
    v_pk_mul_f32 v[72:73], v[192:193], v[192:193]
    v_pk_mul_f32 v[74:75], v[194:195], v[194:195]
    v_pk_mul_f32 v[76:77], v[196:197], v[196:197]
    v_pk_mul_f32 v[78:79], v[198:199], v[198:199]
    v_pk_mul_f32 v[80:81], v[200:201], v[200:201]
    v_pk_mul_f32 v[82:83], v[202:203], v[202:203]
    v_pk_mul_f32 v[84:85], v[204:205], v[204:205]
    v_pk_mul_f32 v[86:87], v[206:207], v[206:207]
    v_pk_fma_f32 v[72:73], v[72:73], v[16:17], v[18:19]
    v_pk_fma_f32 v[74:75], v[74:75], v[16:17], v[18:19]
    v_pk_fma_f32 v[76:77], v[76:77], v[16:17], v[18:19]
    v_pk_fma_f32 v[78:79], v[78:79], v[16:17], v[18:19]
    v_pk_fma_f32 v[80:81], v[80:81], v[16:17], v[18:19]
    v_pk_fma_f32 v[82:83], v[82:83], v[16:17], v[18:19]
    v_pk_fma_f32 v[84:85], v[84:85], v[16:17], v[18:19]
    v_pk_fma_f32 v[86:87], v[86:87], v[16:17], v[18:19]
    v_pk_mul_f32 v[72:73], v[72:73], v[192:193]
    v_pk_mul_f32 v[74:75], v[74:75], v[194:195]
    v_pk_mul_f32 v[76:77], v[76:77], v[196:197]
    v_pk_mul_f32 v[78:79], v[78:79], v[198:199]
    v_pk_mul_f32 v[80:81], v[80:81], v[200:201]
    v_pk_mul_f32 v[82:83], v[82:83], v[202:203]
    v_pk_mul_f32 v[84:85], v[84:85], v[204:205]
    v_pk_mul_f32 v[86:87], v[86:87], v[206:207]
    v_exp_f32 v72, v72
    v_exp_f32 v73, v73
    v_exp_f32 v74, v74
    v_exp_f32 v75, v75
    v_exp_f32 v76, v76
    v_exp_f32 v77, v77
    v_exp_f32 v78, v78
    v_exp_f32 v79, v79
    v_exp_f32 v80, v80
    v_exp_f32 v81, v81
    v_exp_f32 v82, v82
    v_exp_f32 v83, v83
    v_exp_f32 v84, v84
    v_exp_f32 v85, v85
    v_exp_f32 v86, v86
    v_exp_f32 v87, v87
    v_pk_add_f32 v[72:73], v[72:73], 1.0 op_sel_hi:[1,0]
    v_pk_add_f32 v[74:75], v[74:75], 1.0 op_sel_hi:[1,0]
    v_pk_add_f32 v[76:77], v[76:77], 1.0 op_sel_hi:[1,0]
    v_pk_add_f32 v[78:79], v[78:79], 1.0 op_sel_hi:[1,0]
    v_pk_add_f32 v[80:81], v[80:81], 1.0 op_sel_hi:[1,0]
    v_pk_add_f32 v[82:83], v[82:83], 1.0 op_sel_hi:[1,0]
    v_pk_add_f32 v[84:85], v[84:85], 1.0 op_sel_hi:[1,0]
    v_pk_add_f32 v[86:87], v[86:87], 1.0 op_sel_hi:[1,0]
    v_rcp_f32 v72, v72
    v_rcp_f32 v73, v73
    v_rcp_f32 v74, v74
    v_rcp_f32 v75, v75
    v_rcp_f32 v76, v76
    v_rcp_f32 v77, v77
    v_rcp_f32 v78, v78
    v_rcp_f32 v79, v79
    v_rcp_f32 v80, v80
    v_rcp_f32 v81, v81
    v_rcp_f32 v82, v82
    v_rcp_f32 v83, v83
    v_rcp_f32 v84, v84
    v_rcp_f32 v85, v85
    v_rcp_f32 v86, v86
    v_rcp_f32 v87, v87
    v_pk_mul_f32 v[192:193], v[192:193], v[72:73]
    v_pk_mul_f32 v[194:195], v[194:195], v[74:75]
    v_pk_mul_f32 v[196:197], v[196:197], v[76:77]
    v_pk_mul_f32 v[198:199], v[198:199], v[78:79]
    v_pk_mul_f32 v[200:201], v[200:201], v[80:81]
    v_pk_mul_f32 v[202:203], v[202:203], v[82:83]
    v_pk_mul_f32 v[204:205], v[204:205], v[84:85]
    v_pk_mul_f32 v[206:207], v[206:207], v[86:87]
    v_pk_mul_f32 v[72:73], v[208:209], v[208:209]
    v_pk_mul_f32 v[74:75], v[210:211], v[210:211]
    v_pk_mul_f32 v[76:77], v[212:213], v[212:213]
    v_pk_mul_f32 v[78:79], v[214:215], v[214:215]
    v_pk_mul_f32 v[80:81], v[216:217], v[216:217]
    v_pk_mul_f32 v[82:83], v[218:219], v[218:219]
    v_pk_mul_f32 v[84:85], v[220:221], v[220:221]
    v_pk_mul_f32 v[86:87], v[222:223], v[222:223]
    v_pk_fma_f32 v[72:73], v[72:73], v[16:17], v[18:19]
    v_pk_fma_f32 v[74:75], v[74:75], v[16:17], v[18:19]
    v_pk_fma_f32 v[76:77], v[76:77], v[16:17], v[18:19]
    v_pk_fma_f32 v[78:79], v[78:79], v[16:17], v[18:19]
    v_pk_fma_f32 v[80:81], v[80:81], v[16:17], v[18:19]
    v_pk_fma_f32 v[82:83], v[82:83], v[16:17], v[18:19]
    v_pk_fma_f32 v[84:85], v[84:85], v[16:17], v[18:19]
    v_pk_fma_f32 v[86:87], v[86:87], v[16:17], v[18:19]
    s_barrier
    v_pk_mul_f32 v[72:73], v[72:73], v[208:209]
    s_add_u32 s21, s24, 0
    buffer_load_dwordx4 v[128:131], v2, s[12:15], s21 offen offset:0 sc1
    v_pk_mul_f32 v[74:75], v[74:75], v[210:211]
    v_pk_mul_f32 v[76:77], v[76:77], v[212:213]
    v_pk_mul_f32 v[78:79], v[78:79], v[214:215]
    v_pk_mul_f32 v[80:81], v[80:81], v[216:217]
    buffer_load_dwordx4 v[132:135], v2, s[12:15], s21 offen offset:1024 sc1
    v_pk_mul_f32 v[82:83], v[82:83], v[218:219]
    v_pk_mul_f32 v[84:85], v[84:85], v[220:221]
    v_pk_mul_f32 v[86:87], v[86:87], v[222:223]
    v_exp_f32 v72, v72
    v_exp_f32 v73, v73
    buffer_load_dwordx4 v[136:139], v2, s[12:15], s21 offen offset:2048 sc1
    v_exp_f32 v74, v74
    v_exp_f32 v75, v75
    v_exp_f32 v76, v76
    v_exp_f32 v77, v77
    v_exp_f32 v78, v78
    v_exp_f32 v79, v79
    v_exp_f32 v80, v80
    v_exp_f32 v81, v81
    buffer_load_dwordx4 v[140:143], v2, s[12:15], s21 offen offset:3072 sc1
    v_exp_f32 v82, v82
    v_exp_f32 v83, v83
    v_exp_f32 v84, v84
    v_exp_f32 v85, v85
    v_exp_f32 v86, v86
    v_exp_f32 v87, v87
    v_pk_add_f32 v[72:73], v[72:73], 1.0 op_sel_hi:[1,0]
    s_add_u32 s21, s24, 4096
    buffer_load_dwordx4 v[144:147], v2, s[12:15], s21 offen offset:0 sc1
    v_pk_add_f32 v[74:75], v[74:75], 1.0 op_sel_hi:[1,0]
    v_pk_add_f32 v[76:77], v[76:77], 1.0 op_sel_hi:[1,0]
    v_pk_add_f32 v[78:79], v[78:79], 1.0 op_sel_hi:[1,0]
    v_pk_add_f32 v[80:81], v[80:81], 1.0 op_sel_hi:[1,0]
    buffer_load_dwordx4 v[148:151], v2, s[12:15], s21 offen offset:1024 sc1
    v_pk_add_f32 v[82:83], v[82:83], 1.0 op_sel_hi:[1,0]
    v_pk_add_f32 v[84:85], v[84:85], 1.0 op_sel_hi:[1,0]
    v_pk_add_f32 v[86:87], v[86:87], 1.0 op_sel_hi:[1,0]
    v_rcp_f32 v72, v72
    v_rcp_f32 v73, v73
    buffer_load_dwordx4 v[152:155], v2, s[12:15], s21 offen offset:2048 sc1
    v_rcp_f32 v74, v74
    v_rcp_f32 v75, v75
    v_rcp_f32 v76, v76
    v_rcp_f32 v77, v77
    v_rcp_f32 v78, v78
    v_rcp_f32 v79, v79
    v_rcp_f32 v80, v80
    v_rcp_f32 v81, v81
    buffer_load_dwordx4 v[156:159], v2, s[12:15], s21 offen offset:3072 sc1
    v_rcp_f32 v82, v82
    v_rcp_f32 v83, v83
    v_rcp_f32 v84, v84
    v_rcp_f32 v85, v85
    v_rcp_f32 v86, v86
    v_rcp_f32 v87, v87
    v_pk_mul_f32 v[208:209], v[208:209], v[72:73]
    v_pk_mul_f32 v[210:211], v[210:211], v[74:75]
    v_pk_mul_f32 v[212:213], v[212:213], v[76:77]
    v_pk_mul_f32 v[214:215], v[214:215], v[78:79]
    v_pk_mul_f32 v[216:217], v[216:217], v[80:81]
    v_pk_mul_f32 v[218:219], v[218:219], v[82:83]
    v_pk_mul_f32 v[220:221], v[220:221], v[84:85]
    v_pk_mul_f32 v[222:223], v[222:223], v[86:87]
    v_pk_mul_f32 v[192:193], v[192:193], v[6:7] op_sel_hi:[1,0]
    v_pk_mul_f32 v[194:195], v[194:195], v[6:7] op_sel_hi:[1,0]
    v_pk_mul_f32 v[196:197], v[196:197], v[6:7] op_sel_hi:[1,0]
    v_pk_mul_f32 v[198:199], v[198:199], v[6:7] op_sel_hi:[1,0]
    v_pk_mul_f32 v[200:201], v[200:201], v[6:7] op_sel:[0,1] op_sel_hi:[1,1]
    v_pk_mul_f32 v[202:203], v[202:203], v[6:7] op_sel:[0,1] op_sel_hi:[1,1]
    v_pk_mul_f32 v[204:205], v[204:205], v[6:7] op_sel:[0,1] op_sel_hi:[1,1]
    v_pk_mul_f32 v[206:207], v[206:207], v[6:7] op_sel:[0,1] op_sel_hi:[1,1]
    v_pk_mul_f32 v[208:209], v[208:209], v[6:7] op_sel_hi:[1,0]
    v_pk_mul_f32 v[210:211], v[210:211], v[6:7] op_sel_hi:[1,0]
    v_pk_mul_f32 v[212:213], v[212:213], v[6:7] op_sel_hi:[1,0]
    v_pk_mul_f32 v[214:215], v[214:215], v[6:7] op_sel_hi:[1,0]
    v_pk_mul_f32 v[216:217], v[216:217], v[6:7] op_sel:[0,1] op_sel_hi:[1,1]
    v_pk_mul_f32 v[218:219], v[218:219], v[6:7] op_sel:[0,1] op_sel_hi:[1,1]
    v_pk_mul_f32 v[220:221], v[220:221], v[6:7] op_sel:[0,1] op_sel_hi:[1,1]
    v_pk_mul_f32 v[222:223], v[222:223], v[6:7] op_sel:[0,1] op_sel_hi:[1,1]
    v_cvt_pk_bf16_f32 v192, v192, v193
    v_cvt_pk_bf16_f32 v193, v194, v195
    v_cvt_pk_bf16_f32 v194, v196, v197
    v_cvt_pk_bf16_f32 v195, v198, v199
    v_cvt_pk_bf16_f32 v196, v200, v201
    v_cvt_pk_bf16_f32 v197, v202, v203
    v_cvt_pk_bf16_f32 v198, v204, v205
    v_cvt_pk_bf16_f32 v199, v206, v207
    v_cvt_pk_bf16_f32 v200, v208, v209
    v_cvt_pk_bf16_f32 v201, v210, v211
    v_cvt_pk_bf16_f32 v202, v212, v213
    v_cvt_pk_bf16_f32 v203, v214, v215
    v_cvt_pk_bf16_f32 v204, v216, v217
    v_cvt_pk_bf16_f32 v205, v218, v219
    v_cvt_pk_bf16_f32 v206, v220, v221
    v_cvt_pk_bf16_f32 v207, v222, v223
    s_lshl_b32 s23, s17, 13
    s_add_u32 s23, s23, 131072
    v_add_u32 v4, s23, v2
    ds_write_b128 v4, v[192:195] offset:0
    ds_write_b128 v4, v[196:199] offset:2048
    ds_write_b128 v4, v[200:203] offset:1024
    ds_write_b128 v4, v[204:207] offset:3072
    v_and_b32 v4, 15, v1
    v_lshrrev_b32 v5, 4, v1
    v_bfe_u32 v8, v1, 1, 3
    v_xor_b32 v8, v8, v5
    v_lshlrev_b32 v8, 4, v8
    v_lshl_add_u32 v8, v4, 7, v8
    v_xor_b32 v9, 64, v8
    v_lshlrev_b32 v10, 9, v5
    v_lshl_add_u32 v10, v4, 4, v10
    v_lshlrev_b32 v13, 1, v4
    v_add_u32 v13, 135168, v13
    v_mov_b32 v24, 0
    v_mov_b32 v25, 0
    v_mov_b32 v26, 0
    v_mov_b32 v27, 0
    v_mov_b32 v28, 0
    v_mov_b32 v29, 0
    v_mov_b32 v30, 0
    v_mov_b32 v31, 0
    s_mul_i32 s26, s19, 224
    s_add_u32 s26, s26, s25
    s_lshl_b32 s26, s26, 10
    s_lshr_b32 s29, s17, 1
    s_lshr_b32 s23, s31, 2
    s_xor_b32 s29, s29, s23
    s_and_b32 s23, s17, 1
    s_lshl_b32 s23, s23, 10
    s_add_u32 s23, s23, 131072
    v_add_u32 v12, s23, v2
L_sp_go:
    s_waitcnt lgkmcnt(0)
    s_barrier
    ds_read_b128 v[32:35], v8 offset:0
    ds_read_b128 v[36:39], v8 offset:2048
    ds_read_b128 v[40:43], v8 offset:4096
    ds_read_b128 v[44:47], v8 offset:6144
    ds_read_b128 v[48:51], v8 offset:8192
    ds_read_b128 v[52:55], v8 offset:10240
    ds_read_b128 v[56:59], v8 offset:12288
    ds_read_b128 v[60:63], v8 offset:14336
    s_add_u32 s23, s26, 0x400000
    v_mov_b32 v14, 0
    s_lshl_b32 s34, s19, 3
    s_add_u32 s34, s34, s20
    s_lshl_b32 s34, s34, 2
    s_add_u32 s34, s34, s17
    s_lshl_b32 s34, s34, 7
    s_add_u32 s34, s34, 0x16b0000
    s_waitcnt vmcnt(6) lgkmcnt(6)
    v_mfma_f32_16x16x32_bf16 v[64:67], v[128:131], v[32:35], 0
    ds_read_b128 v[224:227], v12 offset:0
    v_mfma_f32_16x16x32_bf16 v[68:71], v[132:135], v[32:35], 0
    ds_read_b128 v[32:35], v9 offset:0
    v_mfma_f32_16x16x32_bf16 v[72:75], v[128:131], v[36:39], 0
    ds_read_b128 v[228:231], v12 offset:2048
    s_add_u32 s21, s24, 8192
    buffer_load_dwordx4 v[160:163], v2, s[12:15], s21 offen offset:0 sc1
    v_mfma_f32_16x16x32_bf16 v[76:79], v[132:135], v[36:39], 0
    ds_read_b128 v[36:39], v9 offset:2048
    s_waitcnt lgkmcnt(6)
    v_mfma_f32_16x16x32_bf16 v[80:83], v[128:131], v[40:43], 0
    ds_read_b128 v[232:235], v12 offset:8192
    v_mfma_f32_16x16x32_bf16 v[84:87], v[132:135], v[40:43], 0
    ds_read_b128 v[40:43], v9 offset:4096
    v_mfma_f32_16x16x32_bf16 v[88:91], v[128:131], v[44:47], 0
    ds_read_b128 v[236:239], v12 offset:10240
    v_mfma_f32_16x16x32_bf16 v[92:95], v[132:135], v[44:47], 0
    ds_read_b128 v[44:47], v9 offset:6144
    s_waitcnt lgkmcnt(6)
    v_mfma_f32_16x16x32_bf16 v[96:99], v[128:131], v[48:51], 0
    ds_read_b128 v[240:243], v12 offset:16384
    v_mfma_f32_16x16x32_bf16 v[100:103], v[132:135], v[48:51], 0
    ds_read_b128 v[48:51], v9 offset:8192
    v_mfma_f32_16x16x32_bf16 v[104:107], v[128:131], v[52:55], 0
    ds_read_b128 v[244:247], v12 offset:18432
    buffer_load_dwordx4 v[164:167], v2, s[12:15], s21 offen offset:1024 sc1
    v_mfma_f32_16x16x32_bf16 v[108:111], v[132:135], v[52:55], 0
    ds_read_b128 v[52:55], v9 offset:10240
    s_waitcnt lgkmcnt(6)
    v_mfma_f32_16x16x32_bf16 v[112:115], v[128:131], v[56:59], 0
    ds_read_b128 v[248:251], v12 offset:24576
    v_mfma_f32_16x16x32_bf16 v[116:119], v[132:135], v[56:59], 0
    ds_read_b128 v[56:59], v9 offset:12288
    v_mfma_f32_16x16x32_bf16 v[120:123], v[128:131], v[60:63], 0
    ds_read_b128 v[252:255], v12 offset:26624
    v_mfma_f32_16x16x32_bf16 v[124:127], v[132:135], v[60:63], 0
    ds_read_b128 v[60:63], v9 offset:14336
    s_waitcnt vmcnt(6) lgkmcnt(6)
    v_mfma_f32_16x16x32_bf16 v[64:67], v[136:139], v[32:35], v[64:67]
    v_add_u32 v8, 16384, v8
    ds_read_u16_d16_hi v24, v13 offset:0
    v_mfma_f32_16x16x32_bf16 v[68:71], v[140:143], v[32:35], v[68:71]
    ds_read_b128 v[32:35], v8 offset:0
    v_mfma_f32_16x16x32_bf16 v[72:75], v[136:139], v[36:39], v[72:75]
    ds_read_u16_d16_hi v25, v13 offset:32
    buffer_load_dwordx4 v[168:171], v2, s[12:15], s21 offen offset:2048 sc1
    v_mfma_f32_16x16x32_bf16 v[76:79], v[140:143], v[36:39], v[76:79]
    ds_read_b128 v[36:39], v8 offset:2048
    s_waitcnt lgkmcnt(6)
    v_mfma_f32_16x16x32_bf16 v[80:83], v[136:139], v[40:43], v[80:83]
    ds_read_u16_d16_hi v26, v13 offset:64
    v_mfma_f32_16x16x32_bf16 v[84:87], v[140:143], v[40:43], v[84:87]
    ds_read_b128 v[40:43], v8 offset:4096
    v_mfma_f32_16x16x32_bf16 v[88:91], v[136:139], v[44:47], v[88:91]
    ds_read_u16_d16_hi v27, v13 offset:96
    v_mfma_f32_16x16x32_bf16 v[92:95], v[140:143], v[44:47], v[92:95]
    ds_read_b128 v[44:47], v8 offset:6144
    s_waitcnt lgkmcnt(6)
    v_mfma_f32_16x16x32_bf16 v[96:99], v[136:139], v[48:51], v[96:99]
    ds_read_u16_d16_hi v28, v13 offset:128
    v_mfma_f32_16x16x32_bf16 v[100:103], v[140:143], v[48:51], v[100:103]
    ds_read_b128 v[48:51], v8 offset:8192
    v_mfma_f32_16x16x32_bf16 v[104:107], v[136:139], v[52:55], v[104:107]
    ds_read_u16_d16_hi v29, v13 offset:160
    buffer_load_dwordx4 v[172:175], v2, s[12:15], s21 offen offset:3072 sc1
    v_mfma_f32_16x16x32_bf16 v[108:111], v[140:143], v[52:55], v[108:111]
    ds_read_b128 v[52:55], v8 offset:10240
    s_waitcnt lgkmcnt(6)
    v_mfma_f32_16x16x32_bf16 v[112:115], v[136:139], v[56:59], v[112:115]
    ds_read_u16_d16_hi v30, v13 offset:192
    v_mfma_f32_16x16x32_bf16 v[116:119], v[140:143], v[56:59], v[116:119]
    ds_read_b128 v[56:59], v8 offset:12288
    v_mfma_f32_16x16x32_bf16 v[120:123], v[136:139], v[60:63], v[120:123]
    ds_read_u16_d16_hi v31, v13 offset:224
    v_mfma_f32_16x16x32_bf16 v[124:127], v[140:143], v[60:63], v[124:127]
    ds_read_b128 v[60:63], v8 offset:14336
    s_waitcnt vmcnt(6) lgkmcnt(6)
    v_mfma_f32_16x16x32_bf16 v[64:67], v[144:147], v[32:35], v[64:67]
    v_add_u32 v9, 16384, v9
    v_mfma_f32_16x16x32_bf16 v[68:71], v[148:151], v[32:35], v[68:71]
    ds_read_b128 v[32:35], v9 offset:0
    v_mfma_f32_16x16x32_bf16 v[72:75], v[144:147], v[36:39], v[72:75]
    s_add_u32 s21, s24, 12288
    buffer_load_dwordx4 v[176:179], v2, s[12:15], s21 offen offset:0 sc1
    v_mfma_f32_16x16x32_bf16 v[76:79], v[148:151], v[36:39], v[76:79]
    ds_read_b128 v[36:39], v9 offset:2048
    s_waitcnt lgkmcnt(6)
    v_mfma_f32_16x16x32_bf16 v[80:83], v[144:147], v[40:43], v[80:83]
    v_mfma_f32_16x16x32_bf16 v[84:87], v[148:151], v[40:43], v[84:87]
    ds_read_b128 v[40:43], v9 offset:4096
    v_mfma_f32_16x16x32_bf16 v[88:91], v[144:147], v[44:47], v[88:91]
    v_mfma_f32_16x16x32_bf16 v[92:95], v[148:151], v[44:47], v[92:95]
    ds_read_b128 v[44:47], v9 offset:6144
    s_waitcnt lgkmcnt(6)
    v_mfma_f32_16x16x32_bf16 v[96:99], v[144:147], v[48:51], v[96:99]
    v_mfma_f32_16x16x32_bf16 v[100:103], v[148:151], v[48:51], v[100:103]
    ds_read_b128 v[48:51], v9 offset:8192
    v_mfma_f32_16x16x32_bf16 v[104:107], v[144:147], v[52:55], v[104:107]
    buffer_load_dwordx4 v[180:183], v2, s[12:15], s21 offen offset:1024 sc1
    v_mfma_f32_16x16x32_bf16 v[108:111], v[148:151], v[52:55], v[108:111]
    ds_read_b128 v[52:55], v9 offset:10240
    s_waitcnt lgkmcnt(6)
    v_mfma_f32_16x16x32_bf16 v[112:115], v[144:147], v[56:59], v[112:115]
    v_mfma_f32_16x16x32_bf16 v[116:119], v[148:151], v[56:59], v[116:119]
    ds_read_b128 v[56:59], v9 offset:12288
    v_mfma_f32_16x16x32_bf16 v[120:123], v[144:147], v[60:63], v[120:123]
    v_mfma_f32_16x16x32_bf16 v[124:127], v[148:151], v[60:63], v[124:127]
    ds_read_b128 v[60:63], v9 offset:14336
    s_waitcnt vmcnt(6) lgkmcnt(6)
    v_mfma_f32_16x16x32_bf16 v[64:67], v[152:155], v[32:35], v[64:67]
    s_barrier
    v_add_u32 v8, 16384, v8
    v_mfma_f32_16x16x32_bf16 v[68:71], v[156:159], v[32:35], v[68:71]
    ds_read_b128 v[32:35], v8 offset:0
    v_mfma_f32_16x16x32_bf16 v[72:75], v[152:155], v[36:39], v[72:75]
    buffer_load_dwordx4 v[184:187], v2, s[12:15], s21 offen offset:2048 sc1
    v_mfma_f32_16x16x32_bf16 v[76:79], v[156:159], v[36:39], v[76:79]
    ds_read_b128 v[36:39], v8 offset:2048
    s_waitcnt lgkmcnt(6)
    v_mfma_f32_16x16x32_bf16 v[80:83], v[152:155], v[40:43], v[80:83]
    v_mfma_f32_16x16x32_bf16 v[84:87], v[156:159], v[40:43], v[84:87]
    ds_read_b128 v[40:43], v8 offset:4096
    v_mfma_f32_16x16x32_bf16 v[88:91], v[152:155], v[44:47], v[88:91]
    v_mfma_f32_16x16x32_bf16 v[92:95], v[156:159], v[44:47], v[92:95]
    ds_read_b128 v[44:47], v8 offset:6144
    s_waitcnt lgkmcnt(6)
    v_mfma_f32_16x16x32_bf16 v[96:99], v[152:155], v[48:51], v[96:99]
    v_mfma_f32_16x16x32_bf16 v[100:103], v[156:159], v[48:51], v[100:103]
    ds_read_b128 v[48:51], v8 offset:8192
    v_mfma_f32_16x16x32_bf16 v[104:107], v[152:155], v[52:55], v[104:107]
    buffer_load_dwordx4 v[188:191], v2, s[12:15], s21 offen offset:3072 sc1
    v_mfma_f32_16x16x32_bf16 v[108:111], v[156:159], v[52:55], v[108:111]
    ds_read_b128 v[52:55], v8 offset:10240
    s_waitcnt lgkmcnt(6)
    v_mfma_f32_16x16x32_bf16 v[112:115], v[152:155], v[56:59], v[112:115]
    v_mfma_f32_16x16x32_bf16 v[116:119], v[156:159], v[56:59], v[116:119]
    ds_read_b128 v[56:59], v8 offset:12288
    v_mfma_f32_16x16x32_bf16 v[120:123], v[152:155], v[60:63], v[120:123]
    v_mfma_f32_16x16x32_bf16 v[124:127], v[156:159], v[60:63], v[124:127]
    ds_read_b128 v[60:63], v8 offset:14336
    s_waitcnt vmcnt(6) lgkmcnt(6)
    v_mfma_f32_16x16x32_bf16 v[64:67], v[160:163], v[32:35], v[64:67]
    v_add_u32 v9, 16384, v9
    v_mfma_f32_16x16x32_bf16 v[68:71], v[164:167], v[32:35], v[68:71]
    ds_read_b128 v[32:35], v9 offset:0
    v_mfma_f32_16x16x32_bf16 v[72:75], v[160:163], v[36:39], v[72:75]
    s_add_u32 s21, s24, 16384
    buffer_load_dwordx4 v[192:195], v2, s[12:15], s21 offen offset:0 sc1
    v_mfma_f32_16x16x32_bf16 v[76:79], v[164:167], v[36:39], v[76:79]
    ds_read_b128 v[36:39], v9 offset:2048
    s_waitcnt lgkmcnt(6)
    v_mfma_f32_16x16x32_bf16 v[80:83], v[160:163], v[40:43], v[80:83]
    v_mfma_f32_16x16x32_bf16 v[84:87], v[164:167], v[40:43], v[84:87]
    ds_read_b128 v[40:43], v9 offset:4096
    v_mfma_f32_16x16x32_bf16 v[88:91], v[160:163], v[44:47], v[88:91]
    v_mfma_f32_16x16x32_bf16 v[92:95], v[164:167], v[44:47], v[92:95]
    ds_read_b128 v[44:47], v9 offset:6144
    s_waitcnt lgkmcnt(6)
    v_mfma_f32_16x16x32_bf16 v[96:99], v[160:163], v[48:51], v[96:99]
    v_mfma_f32_16x16x32_bf16 v[100:103], v[164:167], v[48:51], v[100:103]
    ds_read_b128 v[48:51], v9 offset:8192
    v_mfma_f32_16x16x32_bf16 v[104:107], v[160:163], v[52:55], v[104:107]
    buffer_load_dwordx4 v[196:199], v2, s[12:15], s21 offen offset:1024 sc1
    v_mfma_f32_16x16x32_bf16 v[108:111], v[164:167], v[52:55], v[108:111]
    ds_read_b128 v[52:55], v9 offset:10240
    s_waitcnt lgkmcnt(6)
    v_mfma_f32_16x16x32_bf16 v[112:115], v[160:163], v[56:59], v[112:115]
    v_mfma_f32_16x16x32_bf16 v[116:119], v[164:167], v[56:59], v[116:119]
    ds_read_b128 v[56:59], v9 offset:12288
    v_mfma_f32_16x16x32_bf16 v[120:123], v[160:163], v[60:63], v[120:123]
    v_mfma_f32_16x16x32_bf16 v[124:127], v[164:167], v[60:63], v[124:127]
    ds_read_b128 v[60:63], v9 offset:14336
    s_waitcnt vmcnt(6) lgkmcnt(6)
    v_mfma_f32_16x16x32_bf16 v[64:67], v[168:171], v[32:35], v[64:67]
    v_add_u32 v8, 16384, v8
    v_mfma_f32_16x16x32_bf16 v[68:71], v[172:175], v[32:35], v[68:71]
    ds_read_b128 v[32:35], v8 offset:0
    v_mfma_f32_16x16x32_bf16 v[72:75], v[168:171], v[36:39], v[72:75]
    buffer_load_dwordx4 v[200:203], v2, s[12:15], s21 offen offset:2048 sc1
    v_mfma_f32_16x16x32_bf16 v[76:79], v[172:175], v[36:39], v[76:79]
    ds_read_b128 v[36:39], v8 offset:2048
    s_waitcnt lgkmcnt(6)
    v_mfma_f32_16x16x32_bf16 v[80:83], v[168:171], v[40:43], v[80:83]
    v_mfma_f32_16x16x32_bf16 v[84:87], v[172:175], v[40:43], v[84:87]
    ds_read_b128 v[40:43], v8 offset:4096
    v_mfma_f32_16x16x32_bf16 v[88:91], v[168:171], v[44:47], v[88:91]
    v_mfma_f32_16x16x32_bf16 v[92:95], v[172:175], v[44:47], v[92:95]
    ds_read_b128 v[44:47], v8 offset:6144
    s_waitcnt lgkmcnt(6)
    v_mfma_f32_16x16x32_bf16 v[96:99], v[168:171], v[48:51], v[96:99]
    v_mfma_f32_16x16x32_bf16 v[100:103], v[172:175], v[48:51], v[100:103]
    ds_read_b128 v[48:51], v8 offset:8192
    v_mfma_f32_16x16x32_bf16 v[104:107], v[168:171], v[52:55], v[104:107]
    buffer_load_dwordx4 v[204:207], v2, s[12:15], s21 offen offset:3072 sc1
    v_mfma_f32_16x16x32_bf16 v[108:111], v[172:175], v[52:55], v[108:111]
    ds_read_b128 v[52:55], v8 offset:10240
    s_waitcnt lgkmcnt(6)
    v_mfma_f32_16x16x32_bf16 v[112:115], v[168:171], v[56:59], v[112:115]
    v_mfma_f32_16x16x32_bf16 v[116:119], v[172:175], v[56:59], v[116:119]
    ds_read_b128 v[56:59], v8 offset:12288
    v_mfma_f32_16x16x32_bf16 v[120:123], v[168:171], v[60:63], v[120:123]
    v_mfma_f32_16x16x32_bf16 v[124:127], v[172:175], v[60:63], v[124:127]
    ds_read_b128 v[60:63], v8 offset:14336
    s_waitcnt vmcnt(6) lgkmcnt(6)
    v_mfma_f32_16x16x32_bf16 v[64:67], v[176:179], v[32:35], v[64:67]
    v_add_u32 v9, 16384, v9
    v_mfma_f32_16x16x32_bf16 v[68:71], v[180:183], v[32:35], v[68:71]
    ds_read_b128 v[32:35], v9 offset:0
    v_mfma_f32_16x16x32_bf16 v[72:75], v[176:179], v[36:39], v[72:75]
    s_add_u32 s21, s24, 20480
    buffer_load_dwordx4 v[208:211], v2, s[12:15], s21 offen offset:0 sc1
    v_mfma_f32_16x16x32_bf16 v[76:79], v[180:183], v[36:39], v[76:79]
    ds_read_b128 v[36:39], v9 offset:2048
    s_waitcnt lgkmcnt(6)
    v_mfma_f32_16x16x32_bf16 v[80:83], v[176:179], v[40:43], v[80:83]
    v_mfma_f32_16x16x32_bf16 v[84:87], v[180:183], v[40:43], v[84:87]
    ds_read_b128 v[40:43], v9 offset:4096
    v_mfma_f32_16x16x32_bf16 v[88:91], v[176:179], v[44:47], v[88:91]
    v_mfma_f32_16x16x32_bf16 v[92:95], v[180:183], v[44:47], v[92:95]
    ds_read_b128 v[44:47], v9 offset:6144
    s_waitcnt lgkmcnt(6)
    v_mfma_f32_16x16x32_bf16 v[96:99], v[176:179], v[48:51], v[96:99]
    v_mfma_f32_16x16x32_bf16 v[100:103], v[180:183], v[48:51], v[100:103]
    ds_read_b128 v[48:51], v9 offset:8192
    v_mfma_f32_16x16x32_bf16 v[104:107], v[176:179], v[52:55], v[104:107]
    buffer_load_dwordx4 v[212:215], v2, s[12:15], s21 offen offset:1024 sc1
    v_mfma_f32_16x16x32_bf16 v[108:111], v[180:183], v[52:55], v[108:111]
    ds_read_b128 v[52:55], v9 offset:10240
    s_waitcnt lgkmcnt(6)
    v_mfma_f32_16x16x32_bf16 v[112:115], v[176:179], v[56:59], v[112:115]
    v_mfma_f32_16x16x32_bf16 v[116:119], v[180:183], v[56:59], v[116:119]
    ds_read_b128 v[56:59], v9 offset:12288
    v_mfma_f32_16x16x32_bf16 v[120:123], v[176:179], v[60:63], v[120:123]
    v_mfma_f32_16x16x32_bf16 v[124:127], v[180:183], v[60:63], v[124:127]
    ds_read_b128 v[60:63], v9 offset:14336
    s_waitcnt vmcnt(6) lgkmcnt(6)
    v_mfma_f32_16x16x32_bf16 v[64:67], v[184:187], v[32:35], v[64:67]
    s_barrier
    v_add_u32 v8, 16384, v8
    v_mfma_f32_16x16x32_bf16 v[68:71], v[188:191], v[32:35], v[68:71]
    ds_read_b128 v[32:35], v8 offset:0
    v_mfma_f32_16x16x32_bf16 v[72:75], v[184:187], v[36:39], v[72:75]
    buffer_load_dwordx4 v[216:219], v2, s[12:15], s21 offen offset:2048 sc1
    v_mfma_f32_16x16x32_bf16 v[76:79], v[188:191], v[36:39], v[76:79]
    ds_read_b128 v[36:39], v8 offset:2048
    s_waitcnt lgkmcnt(6)
    v_mfma_f32_16x16x32_bf16 v[80:83], v[184:187], v[40:43], v[80:83]
    v_mfma_f32_16x16x32_bf16 v[84:87], v[188:191], v[40:43], v[84:87]
    ds_read_b128 v[40:43], v8 offset:4096
    v_mfma_f32_16x16x32_bf16 v[88:91], v[184:187], v[44:47], v[88:91]
    v_mfma_f32_16x16x32_bf16 v[92:95], v[188:191], v[44:47], v[92:95]
    ds_read_b128 v[44:47], v8 offset:6144
    s_waitcnt lgkmcnt(6)
    v_mfma_f32_16x16x32_bf16 v[96:99], v[184:187], v[48:51], v[96:99]
    v_mfma_f32_16x16x32_bf16 v[100:103], v[188:191], v[48:51], v[100:103]
    ds_read_b128 v[48:51], v8 offset:8192
    v_mfma_f32_16x16x32_bf16 v[104:107], v[184:187], v[52:55], v[104:107]
    buffer_load_dwordx4 v[220:223], v2, s[12:15], s21 offen offset:3072 sc1
    v_mfma_f32_16x16x32_bf16 v[108:111], v[188:191], v[52:55], v[108:111]
    ds_read_b128 v[52:55], v8 offset:10240
    s_waitcnt lgkmcnt(6)
    v_mfma_f32_16x16x32_bf16 v[112:115], v[184:187], v[56:59], v[112:115]
    v_mfma_f32_16x16x32_bf16 v[116:119], v[188:191], v[56:59], v[116:119]
    ds_read_b128 v[56:59], v8 offset:12288
    v_mfma_f32_16x16x32_bf16 v[120:123], v[184:187], v[60:63], v[120:123]
    v_mfma_f32_16x16x32_bf16 v[124:127], v[188:191], v[60:63], v[124:127]
    ds_read_b128 v[60:63], v8 offset:14336
    s_waitcnt vmcnt(6) lgkmcnt(6)
    v_mfma_f32_16x16x32_bf16 v[64:67], v[192:195], v[32:35], v[64:67]
    v_add_u32 v9, 16384, v9
    v_mfma_f32_16x16x32_bf16 v[68:71], v[196:199], v[32:35], v[68:71]
    ds_read_b128 v[32:35], v9 offset:0
    v_mfma_f32_16x16x32_bf16 v[72:75], v[192:195], v[36:39], v[72:75]
    s_add_u32 s21, s24, 24576
    buffer_load_dwordx4 v[128:131], v2, s[12:15], s21 offen offset:0 sc1
    v_mfma_f32_16x16x32_bf16 v[76:79], v[196:199], v[36:39], v[76:79]
    ds_read_b128 v[36:39], v9 offset:2048
    s_waitcnt lgkmcnt(6)
    v_mfma_f32_16x16x32_bf16 v[80:83], v[192:195], v[40:43], v[80:83]
    v_mfma_f32_16x16x32_bf16 v[84:87], v[196:199], v[40:43], v[84:87]
    ds_read_b128 v[40:43], v9 offset:4096
    v_mfma_f32_16x16x32_bf16 v[88:91], v[192:195], v[44:47], v[88:91]
    v_mfma_f32_16x16x32_bf16 v[92:95], v[196:199], v[44:47], v[92:95]
    ds_read_b128 v[44:47], v9 offset:6144
    s_waitcnt lgkmcnt(6)
    v_mfma_f32_16x16x32_bf16 v[96:99], v[192:195], v[48:51], v[96:99]
    v_mfma_f32_16x16x32_bf16 v[100:103], v[196:199], v[48:51], v[100:103]
    ds_read_b128 v[48:51], v9 offset:8192
    v_mfma_f32_16x16x32_bf16 v[104:107], v[192:195], v[52:55], v[104:107]
    buffer_load_dwordx4 v[132:135], v2, s[12:15], s21 offen offset:1024 sc1
    v_mfma_f32_16x16x32_bf16 v[108:111], v[196:199], v[52:55], v[108:111]
    ds_read_b128 v[52:55], v9 offset:10240
    s_waitcnt lgkmcnt(6)
    v_mfma_f32_16x16x32_bf16 v[112:115], v[192:195], v[56:59], v[112:115]
    v_mfma_f32_16x16x32_bf16 v[116:119], v[196:199], v[56:59], v[116:119]
    ds_read_b128 v[56:59], v9 offset:12288
    v_mfma_f32_16x16x32_bf16 v[120:123], v[192:195], v[60:63], v[120:123]
    v_mfma_f32_16x16x32_bf16 v[124:127], v[196:199], v[60:63], v[124:127]
    ds_read_b128 v[60:63], v9 offset:14336
    s_waitcnt vmcnt(6) lgkmcnt(6)
    v_mfma_f32_16x16x32_bf16 v[64:67], v[200:203], v[32:35], v[64:67]
    v_add_u32 v8, 16384, v8
    v_mfma_f32_16x16x32_bf16 v[68:71], v[204:207], v[32:35], v[68:71]
    ds_read_b128 v[32:35], v8 offset:0
    v_mfma_f32_16x16x32_bf16 v[72:75], v[200:203], v[36:39], v[72:75]
    buffer_load_dwordx4 v[136:139], v2, s[12:15], s21 offen offset:2048 sc1
    v_mfma_f32_16x16x32_bf16 v[76:79], v[204:207], v[36:39], v[76:79]
    ds_read_b128 v[36:39], v8 offset:2048
    s_waitcnt lgkmcnt(6)
    v_mfma_f32_16x16x32_bf16 v[80:83], v[200:203], v[40:43], v[80:83]
    v_mfma_f32_16x16x32_bf16 v[84:87], v[204:207], v[40:43], v[84:87]
    ds_read_b128 v[40:43], v8 offset:4096
    v_mfma_f32_16x16x32_bf16 v[88:91], v[200:203], v[44:47], v[88:91]
    v_mfma_f32_16x16x32_bf16 v[92:95], v[204:207], v[44:47], v[92:95]
    ds_read_b128 v[44:47], v8 offset:6144
    s_waitcnt lgkmcnt(6)
    v_mfma_f32_16x16x32_bf16 v[96:99], v[200:203], v[48:51], v[96:99]
    v_mfma_f32_16x16x32_bf16 v[100:103], v[204:207], v[48:51], v[100:103]
    ds_read_b128 v[48:51], v8 offset:8192
    v_mfma_f32_16x16x32_bf16 v[104:107], v[200:203], v[52:55], v[104:107]
    buffer_load_dwordx4 v[140:143], v2, s[12:15], s21 offen offset:3072 sc1
    v_mfma_f32_16x16x32_bf16 v[108:111], v[204:207], v[52:55], v[108:111]
    ds_read_b128 v[52:55], v8 offset:10240
    s_waitcnt lgkmcnt(6)
    v_mfma_f32_16x16x32_bf16 v[112:115], v[200:203], v[56:59], v[112:115]
    v_mfma_f32_16x16x32_bf16 v[116:119], v[204:207], v[56:59], v[116:119]
    ds_read_b128 v[56:59], v8 offset:12288
    v_mfma_f32_16x16x32_bf16 v[120:123], v[200:203], v[60:63], v[120:123]
    v_mfma_f32_16x16x32_bf16 v[124:127], v[204:207], v[60:63], v[124:127]
    ds_read_b128 v[60:63], v8 offset:14336
    s_waitcnt vmcnt(6) lgkmcnt(6)
    v_mfma_f32_16x16x32_bf16 v[64:67], v[208:211], v[32:35], v[64:67]
    v_add_u32 v9, 16384, v9
    v_mfma_f32_16x16x32_bf16 v[68:71], v[212:215], v[32:35], v[68:71]
    ds_read_b128 v[32:35], v9 offset:0
    v_mfma_f32_16x16x32_bf16 v[72:75], v[208:211], v[36:39], v[72:75]
    s_add_u32 s21, s24, 28672
    buffer_load_dwordx4 v[144:147], v2, s[12:15], s21 offen offset:0 sc1
    v_mfma_f32_16x16x32_bf16 v[76:79], v[212:215], v[36:39], v[76:79]
    ds_read_b128 v[36:39], v9 offset:2048
    s_waitcnt lgkmcnt(6)
    v_mfma_f32_16x16x32_bf16 v[80:83], v[208:211], v[40:43], v[80:83]
    v_mfma_f32_16x16x32_bf16 v[84:87], v[212:215], v[40:43], v[84:87]
    ds_read_b128 v[40:43], v9 offset:4096
    v_mfma_f32_16x16x32_bf16 v[88:91], v[208:211], v[44:47], v[88:91]
    v_mfma_f32_16x16x32_bf16 v[92:95], v[212:215], v[44:47], v[92:95]
    ds_read_b128 v[44:47], v9 offset:6144
    s_waitcnt lgkmcnt(6)
    v_mfma_f32_16x16x32_bf16 v[96:99], v[208:211], v[48:51], v[96:99]
    v_mfma_f32_16x16x32_bf16 v[100:103], v[212:215], v[48:51], v[100:103]
    ds_read_b128 v[48:51], v9 offset:8192
    v_mfma_f32_16x16x32_bf16 v[104:107], v[208:211], v[52:55], v[104:107]
    buffer_load_dwordx4 v[148:151], v2, s[12:15], s21 offen offset:1024 sc1
    v_mfma_f32_16x16x32_bf16 v[108:111], v[212:215], v[52:55], v[108:111]
    ds_read_b128 v[52:55], v9 offset:10240
    s_waitcnt lgkmcnt(6)
    v_mfma_f32_16x16x32_bf16 v[112:115], v[208:211], v[56:59], v[112:115]
    v_mfma_f32_16x16x32_bf16 v[116:119], v[212:215], v[56:59], v[116:119]
    ds_read_b128 v[56:59], v9 offset:12288
    v_mfma_f32_16x16x32_bf16 v[120:123], v[208:211], v[60:63], v[120:123]
    v_mfma_f32_16x16x32_bf16 v[124:127], v[212:215], v[60:63], v[124:127]
    ds_read_b128 v[60:63], v9 offset:14336
    s_waitcnt vmcnt(6) lgkmcnt(6)
    v_mfma_f32_16x16x32_bf16 v[64:67], v[216:219], v[32:35], v[64:67]
    s_barrier
    v_add_u32 v8, 16384, v8
    v_mfma_f32_16x16x32_bf16 v[68:71], v[220:223], v[32:35], v[68:71]
    ds_read_b128 v[32:35], v8 offset:0
    v_mfma_f32_16x16x32_bf16 v[72:75], v[216:219], v[36:39], v[72:75]
    buffer_load_dwordx4 v[152:155], v2, s[12:15], s21 offen offset:2048 sc1
    v_mfma_f32_16x16x32_bf16 v[76:79], v[220:223], v[36:39], v[76:79]
    ds_read_b128 v[36:39], v8 offset:2048
    s_waitcnt lgkmcnt(6)
    v_mfma_f32_16x16x32_bf16 v[80:83], v[216:219], v[40:43], v[80:83]
    v_mfma_f32_16x16x32_bf16 v[84:87], v[220:223], v[40:43], v[84:87]
    ds_read_b128 v[40:43], v8 offset:4096
    v_mfma_f32_16x16x32_bf16 v[88:91], v[216:219], v[44:47], v[88:91]
    v_mfma_f32_16x16x32_bf16 v[92:95], v[220:223], v[44:47], v[92:95]
    ds_read_b128 v[44:47], v8 offset:6144
    s_waitcnt lgkmcnt(6)
    v_mfma_f32_16x16x32_bf16 v[96:99], v[216:219], v[48:51], v[96:99]
    v_mfma_f32_16x16x32_bf16 v[100:103], v[220:223], v[48:51], v[100:103]
    ds_read_b128 v[48:51], v8 offset:8192
    v_mfma_f32_16x16x32_bf16 v[104:107], v[216:219], v[52:55], v[104:107]
    buffer_load_dwordx4 v[156:159], v2, s[12:15], s21 offen offset:3072 sc1
    v_mfma_f32_16x16x32_bf16 v[108:111], v[220:223], v[52:55], v[108:111]
    ds_read_b128 v[52:55], v8 offset:10240
    s_waitcnt lgkmcnt(6)
    v_mfma_f32_16x16x32_bf16 v[112:115], v[216:219], v[56:59], v[112:115]
    v_mfma_f32_16x16x32_bf16 v[116:119], v[220:223], v[56:59], v[116:119]
    ds_read_b128 v[56:59], v8 offset:12288
    v_mfma_f32_16x16x32_bf16 v[120:123], v[216:219], v[60:63], v[120:123]
    v_mfma_f32_16x16x32_bf16 v[124:127], v[220:223], v[60:63], v[124:127]
    ds_read_b128 v[60:63], v8 offset:14336
    s_waitcnt vmcnt(6) lgkmcnt(6)
    v_mfma_f32_16x16x32_bf16 v[64:67], v[128:131], v[32:35], v[64:67]
    v_add_u32 v9, 16384, v9
    v_mfma_f32_16x16x32_bf16 v[68:71], v[132:135], v[32:35], v[68:71]
    ds_read_b128 v[32:35], v9 offset:0
    v_mfma_f32_16x16x32_bf16 v[72:75], v[128:131], v[36:39], v[72:75]
    s_add_u32 s21, s24, 32768
    buffer_load_dwordx4 v[160:163], v2, s[12:15], s21 offen offset:0 sc1
    v_mfma_f32_16x16x32_bf16 v[76:79], v[132:135], v[36:39], v[76:79]
    ds_read_b128 v[36:39], v9 offset:2048
    s_waitcnt lgkmcnt(6)
    v_mfma_f32_16x16x32_bf16 v[80:83], v[128:131], v[40:43], v[80:83]
    buffer_load_dwordx4 v[164:167], v2, s[12:15], s21 offen offset:1024 sc1
    v_mfma_f32_16x16x32_bf16 v[84:87], v[132:135], v[40:43], v[84:87]
    ds_read_b128 v[40:43], v9 offset:4096
    v_mfma_f32_16x16x32_bf16 v[88:91], v[128:131], v[44:47], v[88:91]
    v_mfma_f32_16x16x32_bf16 v[92:95], v[132:135], v[44:47], v[92:95]
    ds_read_b128 v[44:47], v9 offset:6144
    s_waitcnt lgkmcnt(6)
    v_mfma_f32_16x16x32_bf16 v[96:99], v[128:131], v[48:51], v[96:99]
    v_mfma_f32_16x16x32_bf16 v[100:103], v[132:135], v[48:51], v[100:103]
    ds_read_b128 v[48:51], v9 offset:8192
    v_mfma_f32_16x16x32_bf16 v[104:107], v[128:131], v[52:55], v[104:107]
    buffer_load_dwordx4 v[168:171], v2, s[12:15], s21 offen offset:2048 sc1
    v_mfma_f32_16x16x32_bf16 v[108:111], v[132:135], v[52:55], v[108:111]
    ds_read_b128 v[52:55], v9 offset:10240
    s_waitcnt lgkmcnt(6)
    v_mfma_f32_16x16x32_bf16 v[112:115], v[128:131], v[56:59], v[112:115]
    buffer_load_dwordx4 v[172:175], v2, s[12:15], s21 offen offset:3072 sc1
    v_mfma_f32_16x16x32_bf16 v[116:119], v[132:135], v[56:59], v[116:119]
    ds_read_b128 v[56:59], v9 offset:12288
    v_mfma_f32_16x16x32_bf16 v[120:123], v[128:131], v[60:63], v[120:123]
    v_mfma_f32_16x16x32_bf16 v[124:127], v[132:135], v[60:63], v[124:127]
    ds_read_b128 v[60:63], v9 offset:14336
    s_waitcnt vmcnt(8) lgkmcnt(6)
    v_mfma_f32_16x16x32_bf16 v[64:67], v[136:139], v[32:35], v[64:67]
    v_add_u32 v8, 16384, v8
    v_mfma_f32_16x16x32_bf16 v[68:71], v[140:143], v[32:35], v[68:71]
    ds_read_b128 v[32:35], v8 offset:0
    v_mfma_f32_16x16x32_bf16 v[72:75], v[136:139], v[36:39], v[72:75]
    s_add_u32 s21, s24, 36864
    buffer_load_dwordx4 v[176:179], v2, s[12:15], s21 offen offset:0 sc1
    v_mfma_f32_16x16x32_bf16 v[76:79], v[140:143], v[36:39], v[76:79]
    ds_read_b128 v[36:39], v8 offset:2048
    s_waitcnt lgkmcnt(6)
    v_mfma_f32_16x16x32_bf16 v[80:83], v[136:139], v[40:43], v[80:83]
    buffer_load_dwordx4 v[180:183], v2, s[12:15], s21 offen offset:1024 sc1
    v_mfma_f32_16x16x32_bf16 v[84:87], v[140:143], v[40:43], v[84:87]
    ds_read_b128 v[40:43], v8 offset:4096
    v_mfma_f32_16x16x32_bf16 v[88:91], v[136:139], v[44:47], v[88:91]
    v_mfma_f32_16x16x32_bf16 v[92:95], v[140:143], v[44:47], v[92:95]
    ds_read_b128 v[44:47], v8 offset:6144
    s_waitcnt lgkmcnt(6)
    v_mfma_f32_16x16x32_bf16 v[96:99], v[136:139], v[48:51], v[96:99]
    v_mfma_f32_16x16x32_bf16 v[100:103], v[140:143], v[48:51], v[100:103]
    ds_read_b128 v[48:51], v8 offset:8192
    v_mfma_f32_16x16x32_bf16 v[104:107], v[136:139], v[52:55], v[104:107]
    buffer_load_dwordx4 v[184:187], v2, s[12:15], s21 offen offset:2048 sc1
    v_mfma_f32_16x16x32_bf16 v[108:111], v[140:143], v[52:55], v[108:111]
    ds_read_b128 v[52:55], v8 offset:10240
    s_waitcnt lgkmcnt(6)
    v_mfma_f32_16x16x32_bf16 v[112:115], v[136:139], v[56:59], v[112:115]
    buffer_load_dwordx4 v[188:191], v2, s[12:15], s21 offen offset:3072 sc1
    v_mfma_f32_16x16x32_bf16 v[116:119], v[140:143], v[56:59], v[116:119]
    ds_read_b128 v[56:59], v8 offset:12288
    v_mfma_f32_16x16x32_bf16 v[120:123], v[136:139], v[60:63], v[120:123]
    v_mfma_f32_16x16x32_bf16 v[124:127], v[140:143], v[60:63], v[124:127]
    ds_read_b128 v[60:63], v8 offset:14336
    s_waitcnt vmcnt(10) lgkmcnt(6)
    v_mfma_f32_16x16x32_bf16 v[64:67], v[144:147], v[32:35], v[64:67]
    v_add_u32 v9, 16384, v9
    v_mfma_f32_16x16x32_bf16 v[68:71], v[148:151], v[32:35], v[68:71]
    ds_read_b128 v[32:35], v9 offset:0
    v_mfma_f32_16x16x32_bf16 v[72:75], v[144:147], v[36:39], v[72:75]
    s_add_u32 s21, s24, 40960
    buffer_load_dwordx4 v[192:195], v2, s[12:15], s21 offen offset:0 sc1
    v_mfma_f32_16x16x32_bf16 v[76:79], v[148:151], v[36:39], v[76:79]
    ds_read_b128 v[36:39], v9 offset:2048
    s_waitcnt lgkmcnt(6)
    v_mfma_f32_16x16x32_bf16 v[80:83], v[144:147], v[40:43], v[80:83]
    buffer_load_dwordx4 v[196:199], v2, s[12:15], s21 offen offset:1024 sc1
    v_mfma_f32_16x16x32_bf16 v[84:87], v[148:151], v[40:43], v[84:87]
    ds_read_b128 v[40:43], v9 offset:4096
    v_mfma_f32_16x16x32_bf16 v[88:91], v[144:147], v[44:47], v[88:91]
    v_mfma_f32_16x16x32_bf16 v[92:95], v[148:151], v[44:47], v[92:95]
    ds_read_b128 v[44:47], v9 offset:6144
    s_waitcnt lgkmcnt(6)
    v_mfma_f32_16x16x32_bf16 v[96:99], v[144:147], v[48:51], v[96:99]
    v_mfma_f32_16x16x32_bf16 v[100:103], v[148:151], v[48:51], v[100:103]
    ds_read_b128 v[48:51], v9 offset:8192
    v_mfma_f32_16x16x32_bf16 v[104:107], v[144:147], v[52:55], v[104:107]
    buffer_load_dwordx4 v[200:203], v2, s[12:15], s21 offen offset:2048 sc1
    v_mfma_f32_16x16x32_bf16 v[108:111], v[148:151], v[52:55], v[108:111]
    ds_read_b128 v[52:55], v9 offset:10240
    s_waitcnt lgkmcnt(6)
    v_mfma_f32_16x16x32_bf16 v[112:115], v[144:147], v[56:59], v[112:115]
    buffer_load_dwordx4 v[204:207], v2, s[12:15], s21 offen offset:3072 sc1
    v_mfma_f32_16x16x32_bf16 v[116:119], v[148:151], v[56:59], v[116:119]
    ds_read_b128 v[56:59], v9 offset:12288
    v_mfma_f32_16x16x32_bf16 v[120:123], v[144:147], v[60:63], v[120:123]
    v_mfma_f32_16x16x32_bf16 v[124:127], v[148:151], v[60:63], v[124:127]
    ds_read_b128 v[60:63], v9 offset:14336
    s_waitcnt vmcnt(12) lgkmcnt(6)
    v_mfma_f32_16x16x32_bf16 v[64:67], v[152:155], v[32:35], v[64:67]
    s_barrier
    v_add_u32 v8, 16384, v8
    v_mfma_f32_16x16x32_bf16 v[68:71], v[156:159], v[32:35], v[68:71]
    ds_read_b128 v[32:35], v8 offset:0
    v_mfma_f32_16x16x32_bf16 v[72:75], v[152:155], v[36:39], v[72:75]
    s_add_u32 s21, s24, 45056
    buffer_load_dwordx4 v[208:211], v2, s[12:15], s21 offen offset:0 sc1
    v_mfma_f32_16x16x32_bf16 v[76:79], v[156:159], v[36:39], v[76:79]
    ds_read_b128 v[36:39], v8 offset:2048
    s_waitcnt lgkmcnt(6)
    v_mfma_f32_16x16x32_bf16 v[80:83], v[152:155], v[40:43], v[80:83]
    buffer_load_dwordx4 v[212:215], v2, s[12:15], s21 offen offset:1024 sc1
    v_mfma_f32_16x16x32_bf16 v[84:87], v[156:159], v[40:43], v[84:87]
    ds_read_b128 v[40:43], v8 offset:4096
    v_mfma_f32_16x16x32_bf16 v[88:91], v[152:155], v[44:47], v[88:91]
    v_mfma_f32_16x16x32_bf16 v[92:95], v[156:159], v[44:47], v[92:95]
    ds_read_b128 v[44:47], v8 offset:6144
    s_waitcnt lgkmcnt(6)
    v_mfma_f32_16x16x32_bf16 v[96:99], v[152:155], v[48:51], v[96:99]
    v_mfma_f32_16x16x32_bf16 v[100:103], v[156:159], v[48:51], v[100:103]
    ds_read_b128 v[48:51], v8 offset:8192
    v_mfma_f32_16x16x32_bf16 v[104:107], v[152:155], v[52:55], v[104:107]
    buffer_load_dwordx4 v[216:219], v2, s[12:15], s21 offen offset:2048 sc1
    v_mfma_f32_16x16x32_bf16 v[108:111], v[156:159], v[52:55], v[108:111]
    ds_read_b128 v[52:55], v8 offset:10240
    s_waitcnt lgkmcnt(6)
    v_mfma_f32_16x16x32_bf16 v[112:115], v[152:155], v[56:59], v[112:115]
    buffer_load_dwordx4 v[220:223], v2, s[12:15], s21 offen offset:3072 sc1
    v_mfma_f32_16x16x32_bf16 v[116:119], v[156:159], v[56:59], v[116:119]
    ds_read_b128 v[56:59], v8 offset:12288
    v_mfma_f32_16x16x32_bf16 v[120:123], v[152:155], v[60:63], v[120:123]
    v_mfma_f32_16x16x32_bf16 v[124:127], v[156:159], v[60:63], v[124:127]
    ds_read_b128 v[60:63], v8 offset:14336
    s_waitcnt vmcnt(14) lgkmcnt(6)
    v_mfma_f32_16x16x32_bf16 v[64:67], v[160:163], v[32:35], v[64:67]
    v_add_u32 v9, 16384, v9
    v_mfma_f32_16x16x32_bf16 v[68:71], v[164:167], v[32:35], v[68:71]
    ds_read_b128 v[32:35], v9 offset:0
    v_mfma_f32_16x16x32_bf16 v[72:75], v[160:163], v[36:39], v[72:75]
    s_add_u32 s21, s24, 49152
    buffer_load_dwordx4 v[128:131], v2, s[12:15], s21 offen offset:0 sc1
    v_mfma_f32_16x16x32_bf16 v[76:79], v[164:167], v[36:39], v[76:79]
    ds_read_b128 v[36:39], v9 offset:2048
    s_waitcnt lgkmcnt(6)
    v_mfma_f32_16x16x32_bf16 v[80:83], v[160:163], v[40:43], v[80:83]
    buffer_load_dwordx4 v[132:135], v2, s[12:15], s21 offen offset:1024 sc1
    v_mfma_f32_16x16x32_bf16 v[84:87], v[164:167], v[40:43], v[84:87]
    ds_read_b128 v[40:43], v9 offset:4096
    v_mfma_f32_16x16x32_bf16 v[88:91], v[160:163], v[44:47], v[88:91]
    v_mfma_f32_16x16x32_bf16 v[92:95], v[164:167], v[44:47], v[92:95]
    ds_read_b128 v[44:47], v9 offset:6144
    s_waitcnt lgkmcnt(6)
    v_mfma_f32_16x16x32_bf16 v[96:99], v[160:163], v[48:51], v[96:99]
    v_mfma_f32_16x16x32_bf16 v[100:103], v[164:167], v[48:51], v[100:103]
    ds_read_b128 v[48:51], v9 offset:8192
    v_mfma_f32_16x16x32_bf16 v[104:107], v[160:163], v[52:55], v[104:107]
    buffer_load_dwordx4 v[136:139], v2, s[12:15], s21 offen offset:2048 sc1
    v_mfma_f32_16x16x32_bf16 v[108:111], v[164:167], v[52:55], v[108:111]
    ds_read_b128 v[52:55], v9 offset:10240
    s_waitcnt lgkmcnt(6)
    v_mfma_f32_16x16x32_bf16 v[112:115], v[160:163], v[56:59], v[112:115]
    buffer_load_dwordx4 v[140:143], v2, s[12:15], s21 offen offset:3072 sc1
    v_mfma_f32_16x16x32_bf16 v[116:119], v[164:167], v[56:59], v[116:119]
    ds_read_b128 v[56:59], v9 offset:12288
    v_mfma_f32_16x16x32_bf16 v[120:123], v[160:163], v[60:63], v[120:123]
    v_mfma_f32_16x16x32_bf16 v[124:127], v[164:167], v[60:63], v[124:127]
    ds_read_b128 v[60:63], v9 offset:14336
    s_waitcnt vmcnt(16) lgkmcnt(6)
    v_mfma_f32_16x16x32_bf16 v[64:67], v[168:171], v[32:35], v[64:67]
    v_add_u32 v8, 16384, v8
    v_mfma_f32_16x16x32_bf16 v[68:71], v[172:175], v[32:35], v[68:71]
    ds_read_b128 v[32:35], v8 offset:0
    v_mfma_f32_16x16x32_bf16 v[72:75], v[168:171], v[36:39], v[72:75]
    s_add_u32 s21, s24, 53248
    buffer_load_dwordx4 v[144:147], v2, s[12:15], s21 offen offset:0 sc1
    v_mfma_f32_16x16x32_bf16 v[76:79], v[172:175], v[36:39], v[76:79]
    ds_read_b128 v[36:39], v8 offset:2048
    s_waitcnt lgkmcnt(6)
    v_mfma_f32_16x16x32_bf16 v[80:83], v[168:171], v[40:43], v[80:83]
    buffer_load_dwordx4 v[148:151], v2, s[12:15], s21 offen offset:1024 sc1
    v_mfma_f32_16x16x32_bf16 v[84:87], v[172:175], v[40:43], v[84:87]
    ds_read_b128 v[40:43], v8 offset:4096
    v_mfma_f32_16x16x32_bf16 v[88:91], v[168:171], v[44:47], v[88:91]
    v_mfma_f32_16x16x32_bf16 v[92:95], v[172:175], v[44:47], v[92:95]
    ds_read_b128 v[44:47], v8 offset:6144
    s_waitcnt lgkmcnt(6)
    v_mfma_f32_16x16x32_bf16 v[96:99], v[168:171], v[48:51], v[96:99]
    v_mfma_f32_16x16x32_bf16 v[100:103], v[172:175], v[48:51], v[100:103]
    ds_read_b128 v[48:51], v8 offset:8192
    v_mfma_f32_16x16x32_bf16 v[104:107], v[168:171], v[52:55], v[104:107]
    buffer_load_dwordx4 v[152:155], v2, s[12:15], s21 offen offset:2048 sc1
    v_mfma_f32_16x16x32_bf16 v[108:111], v[172:175], v[52:55], v[108:111]
    ds_read_b128 v[52:55], v8 offset:10240
    s_waitcnt lgkmcnt(6)
    v_mfma_f32_16x16x32_bf16 v[112:115], v[168:171], v[56:59], v[112:115]
    v_mfma_f32_16x16x32_bf16 v[116:119], v[172:175], v[56:59], v[116:119]
    ds_read_b128 v[56:59], v8 offset:12288
    v_mfma_f32_16x16x32_bf16 v[120:123], v[168:171], v[60:63], v[120:123]
    v_mfma_f32_16x16x32_bf16 v[124:127], v[172:175], v[60:63], v[124:127]
    ds_read_b128 v[60:63], v8 offset:14336
    s_waitcnt vmcnt(17) lgkmcnt(6)
    v_mfma_f32_16x16x32_bf16 v[64:67], v[176:179], v[32:35], v[64:67]
    v_add_u32 v9, 16384, v9
    v_mfma_f32_16x16x32_bf16 v[68:71], v[180:183], v[32:35], v[68:71]
    ds_read_b128 v[32:35], v9 offset:0
    v_mfma_f32_16x16x32_bf16 v[72:75], v[176:179], v[36:39], v[72:75]
    buffer_load_dwordx4 v[156:159], v2, s[12:15], s21 offen offset:3072 sc1
    v_mfma_f32_16x16x32_bf16 v[76:79], v[180:183], v[36:39], v[76:79]
    ds_read_b128 v[36:39], v9 offset:2048
    s_waitcnt lgkmcnt(6)
    v_mfma_f32_16x16x32_bf16 v[80:83], v[176:179], v[40:43], v[80:83]
    v_mfma_f32_16x16x32_bf16 v[84:87], v[180:183], v[40:43], v[84:87]
    ds_read_b128 v[40:43], v9 offset:4096
    v_mfma_f32_16x16x32_bf16 v[88:91], v[176:179], v[44:47], v[88:91]
    v_mfma_f32_16x16x32_bf16 v[92:95], v[180:183], v[44:47], v[92:95]
    ds_read_b128 v[44:47], v9 offset:6144
    s_waitcnt lgkmcnt(6)
    v_mfma_f32_16x16x32_bf16 v[96:99], v[176:179], v[48:51], v[96:99]
    v_mfma_f32_16x16x32_bf16 v[100:103], v[180:183], v[48:51], v[100:103]
    ds_read_b128 v[48:51], v9 offset:8192
    v_mfma_f32_16x16x32_bf16 v[104:107], v[176:179], v[52:55], v[104:107]
    s_lshl_b32 s21, s29, 28
    s_add_u32 s24, s24, s21
    s_add_u32 s21, s24, 57344
    buffer_load_dwordx4 v[160:163], v2, s[12:15], s21 offen offset:0 sc1
    v_mfma_f32_16x16x32_bf16 v[108:111], v[180:183], v[52:55], v[108:111]
    ds_read_b128 v[52:55], v9 offset:10240
    s_waitcnt lgkmcnt(6)
    v_mfma_f32_16x16x32_bf16 v[112:115], v[176:179], v[56:59], v[112:115]
    v_mfma_f32_16x16x32_bf16 v[116:119], v[180:183], v[56:59], v[116:119]
    ds_read_b128 v[56:59], v9 offset:12288
    v_mfma_f32_16x16x32_bf16 v[120:123], v[176:179], v[60:63], v[120:123]
    v_mfma_f32_16x16x32_bf16 v[124:127], v[180:183], v[60:63], v[124:127]
    ds_read_b128 v[60:63], v9 offset:14336
    s_waitcnt vmcnt(17) lgkmcnt(6)
    v_mfma_f32_16x16x32_bf16 v[64:67], v[184:187], v[32:35], v[64:67]
    s_barrier
    v_add_u32 v8, -147456, v8
    v_mfma_f32_16x16x32_bf16 v[68:71], v[188:191], v[32:35], v[68:71]
    ds_read_b128 v[32:35], v8 offset:0
    v_mfma_f32_16x16x32_bf16 v[72:75], v[184:187], v[36:39], v[72:75]
    buffer_load_dwordx4 v[164:167], v2, s[12:15], s21 offen offset:1024 sc1
    v_mfma_f32_16x16x32_bf16 v[76:79], v[188:191], v[36:39], v[76:79]
    ds_read_b128 v[36:39], v8 offset:2048
    s_waitcnt lgkmcnt(6)
    v_mfma_f32_16x16x32_bf16 v[80:83], v[184:187], v[40:43], v[80:83]
    v_mfma_f32_16x16x32_bf16 v[84:87], v[188:191], v[40:43], v[84:87]
    ds_read_b128 v[40:43], v8 offset:4096
    v_mfma_f32_16x16x32_bf16 v[88:91], v[184:187], v[44:47], v[88:91]
    v_mfma_f32_16x16x32_bf16 v[92:95], v[188:191], v[44:47], v[92:95]
    ds_read_b128 v[44:47], v8 offset:6144
    s_waitcnt lgkmcnt(6)
    v_mfma_f32_16x16x32_bf16 v[96:99], v[184:187], v[48:51], v[96:99]
    v_mfma_f32_16x16x32_bf16 v[100:103], v[188:191], v[48:51], v[100:103]
    ds_read_b128 v[48:51], v8 offset:8192
    v_mfma_f32_16x16x32_bf16 v[104:107], v[184:187], v[52:55], v[104:107]
    buffer_load_dwordx4 v[168:171], v2, s[12:15], s21 offen offset:2048 sc1
    v_mfma_f32_16x16x32_bf16 v[108:111], v[188:191], v[52:55], v[108:111]
    ds_read_b128 v[52:55], v8 offset:10240
    s_waitcnt lgkmcnt(6)
    v_mfma_f32_16x16x32_bf16 v[112:115], v[184:187], v[56:59], v[112:115]
    v_mfma_f32_16x16x32_bf16 v[116:119], v[188:191], v[56:59], v[116:119]
    ds_read_b128 v[56:59], v8 offset:12288
    v_mfma_f32_16x16x32_bf16 v[120:123], v[184:187], v[60:63], v[120:123]
    v_mfma_f32_16x16x32_bf16 v[124:127], v[188:191], v[60:63], v[124:127]
    ds_read_b128 v[60:63], v8 offset:14336
    s_waitcnt vmcnt(17) lgkmcnt(6)
    v_mfma_f32_16x16x32_bf16 v[64:67], v[192:195], v[32:35], v[64:67]
    v_add_u32 v9, -147456, v9
    v_mfma_f32_16x16x32_bf16 v[68:71], v[196:199], v[32:35], v[68:71]
    ds_read_b128 v[32:35], v9 offset:0
    v_mfma_f32_16x16x32_bf16 v[72:75], v[192:195], v[36:39], v[72:75]
    buffer_load_dwordx4 v[172:175], v2, s[12:15], s21 offen offset:3072 sc1
    v_mfma_f32_16x16x32_bf16 v[76:79], v[196:199], v[36:39], v[76:79]
    ds_read_b128 v[36:39], v9 offset:2048
    s_waitcnt lgkmcnt(6)
    v_mfma_f32_16x16x32_bf16 v[80:83], v[192:195], v[40:43], v[80:83]
    v_mfma_f32_16x16x32_bf16 v[84:87], v[196:199], v[40:43], v[84:87]
    ds_read_b128 v[40:43], v9 offset:4096
    v_mfma_f32_16x16x32_bf16 v[88:91], v[192:195], v[44:47], v[88:91]
    v_mfma_f32_16x16x32_bf16 v[92:95], v[196:199], v[44:47], v[92:95]
    ds_read_b128 v[44:47], v9 offset:6144
    s_waitcnt lgkmcnt(6)
    v_mfma_f32_16x16x32_bf16 v[96:99], v[192:195], v[48:51], v[96:99]
    v_mfma_f32_16x16x32_bf16 v[100:103], v[196:199], v[48:51], v[100:103]
    ds_read_b128 v[48:51], v9 offset:8192
    v_mfma_f32_16x16x32_bf16 v[104:107], v[192:195], v[52:55], v[104:107]
    s_add_u32 s21, s24, 61440
    buffer_load_dwordx4 v[176:179], v2, s[12:15], s21 offen offset:0 sc1
    v_mfma_f32_16x16x32_bf16 v[108:111], v[196:199], v[52:55], v[108:111]
    ds_read_b128 v[52:55], v9 offset:10240
    s_waitcnt lgkmcnt(6)
    v_mfma_f32_16x16x32_bf16 v[112:115], v[192:195], v[56:59], v[112:115]
    v_mfma_f32_16x16x32_bf16 v[116:119], v[196:199], v[56:59], v[116:119]
    ds_read_b128 v[56:59], v9 offset:12288
    v_mfma_f32_16x16x32_bf16 v[120:123], v[192:195], v[60:63], v[120:123]
    v_mfma_f32_16x16x32_bf16 v[124:127], v[196:199], v[60:63], v[124:127]
    ds_read_b128 v[60:63], v9 offset:14336
    s_waitcnt vmcnt(17) lgkmcnt(6)
    v_mfma_f32_16x16x32_bf16 v[64:67], v[200:203], v[32:35], v[64:67]
    v_add_u32 v8, 16384, v8
    v_mfma_f32_16x16x32_bf16 v[68:71], v[204:207], v[32:35], v[68:71]
    ds_read_b128 v[32:35], v8 offset:0
    v_mfma_f32_16x16x32_bf16 v[72:75], v[200:203], v[36:39], v[72:75]
    buffer_load_dwordx4 v[180:183], v2, s[12:15], s21 offen offset:1024 sc1
    v_mfma_f32_16x16x32_bf16 v[76:79], v[204:207], v[36:39], v[76:79]
    ds_read_b128 v[36:39], v8 offset:2048
    s_waitcnt lgkmcnt(6)
    v_mfma_f32_16x16x32_bf16 v[80:83], v[200:203], v[40:43], v[80:83]
    v_mfma_f32_16x16x32_bf16 v[84:87], v[204:207], v[40:43], v[84:87]
    ds_read_b128 v[40:43], v8 offset:4096
    v_mfma_f32_16x16x32_bf16 v[88:91], v[200:203], v[44:47], v[88:91]
    v_mfma_f32_16x16x32_bf16 v[92:95], v[204:207], v[44:47], v[92:95]
    ds_read_b128 v[44:47], v8 offset:6144
    s_waitcnt lgkmcnt(6)
    v_mfma_f32_16x16x32_bf16 v[96:99], v[200:203], v[48:51], v[96:99]
    v_mfma_f32_16x16x32_bf16 v[100:103], v[204:207], v[48:51], v[100:103]
    ds_read_b128 v[48:51], v8 offset:8192
    v_mfma_f32_16x16x32_bf16 v[104:107], v[200:203], v[52:55], v[104:107]
    buffer_load_dwordx4 v[184:187], v2, s[12:15], s21 offen offset:2048 sc1
    v_mfma_f32_16x16x32_bf16 v[108:111], v[204:207], v[52:55], v[108:111]
    ds_read_b128 v[52:55], v8 offset:10240
    s_waitcnt lgkmcnt(6)
    v_mfma_f32_16x16x32_bf16 v[112:115], v[200:203], v[56:59], v[112:115]
    v_mfma_f32_16x16x32_bf16 v[116:119], v[204:207], v[56:59], v[116:119]
    ds_read_b128 v[56:59], v8 offset:12288
    v_mfma_f32_16x16x32_bf16 v[120:123], v[200:203], v[60:63], v[120:123]
    v_mfma_f32_16x16x32_bf16 v[124:127], v[204:207], v[60:63], v[124:127]
    ds_read_b128 v[60:63], v8 offset:14336
    s_waitcnt vmcnt(17) lgkmcnt(6)
    v_mfma_f32_16x16x32_bf16 v[64:67], v[208:211], v[32:35], v[64:67]
    v_add_u32 v9, 16384, v9
    v_mfma_f32_16x16x32_bf16 v[68:71], v[212:215], v[32:35], v[68:71]
    ds_read_b128 v[32:35], v9 offset:0
    v_mfma_f32_16x16x32_bf16 v[72:75], v[208:211], v[36:39], v[72:75]
    buffer_load_dwordx4 v[188:191], v2, s[12:15], s21 offen offset:3072 sc1
    v_mfma_f32_16x16x32_bf16 v[76:79], v[212:215], v[36:39], v[76:79]
    ds_read_b128 v[36:39], v9 offset:2048
    s_waitcnt lgkmcnt(6)
    v_mfma_f32_16x16x32_bf16 v[80:83], v[208:211], v[40:43], v[80:83]
    v_mfma_f32_16x16x32_bf16 v[84:87], v[212:215], v[40:43], v[84:87]
    ds_read_b128 v[40:43], v9 offset:4096
    v_mfma_f32_16x16x32_bf16 v[88:91], v[208:211], v[44:47], v[88:91]
    v_mfma_f32_16x16x32_bf16 v[92:95], v[212:215], v[44:47], v[92:95]
    ds_read_b128 v[44:47], v9 offset:6144
    s_waitcnt lgkmcnt(6)
    v_mfma_f32_16x16x32_bf16 v[96:99], v[208:211], v[48:51], v[96:99]
    v_mfma_f32_16x16x32_bf16 v[100:103], v[212:215], v[48:51], v[100:103]
    ds_read_b128 v[48:51], v9 offset:8192
    v_mfma_f32_16x16x32_bf16 v[104:107], v[208:211], v[52:55], v[104:107]
    s_xor_b32 s24, s24, 65536
    s_add_u32 s21, s24, 57344
    buffer_load_dwordx4 v[192:195], v2, s[12:15], s21 offen offset:0 sc1
    v_mfma_f32_16x16x32_bf16 v[108:111], v[212:215], v[52:55], v[108:111]
    ds_read_b128 v[52:55], v9 offset:10240
    s_waitcnt lgkmcnt(6)
    v_mfma_f32_16x16x32_bf16 v[112:115], v[208:211], v[56:59], v[112:115]
    v_mfma_f32_16x16x32_bf16 v[116:119], v[212:215], v[56:59], v[116:119]
    ds_read_b128 v[56:59], v9 offset:12288
    v_mfma_f32_16x16x32_bf16 v[120:123], v[208:211], v[60:63], v[120:123]
    v_mfma_f32_16x16x32_bf16 v[124:127], v[212:215], v[60:63], v[124:127]
    ds_read_b128 v[60:63], v9 offset:14336
    s_waitcnt vmcnt(17) lgkmcnt(6)
    v_mfma_f32_16x16x32_bf16 v[64:67], v[216:219], v[32:35], v[64:67]
    s_barrier
    v_add_u32 v8, 16384, v8
    v_mfma_f32_16x16x32_bf16 v[68:71], v[220:223], v[32:35], v[68:71]
    ds_read_b128 v[32:35], v8 offset:0
    v_mfma_f32_16x16x32_bf16 v[72:75], v[216:219], v[36:39], v[72:75]
    buffer_load_dwordx4 v[196:199], v2, s[12:15], s21 offen offset:1024 sc1
    v_mfma_f32_16x16x32_bf16 v[76:79], v[220:223], v[36:39], v[76:79]
    ds_read_b128 v[36:39], v8 offset:2048
    s_waitcnt lgkmcnt(6)
    v_mfma_f32_16x16x32_bf16 v[80:83], v[216:219], v[40:43], v[80:83]
    v_mfma_f32_16x16x32_bf16 v[84:87], v[220:223], v[40:43], v[84:87]
    ds_read_b128 v[40:43], v8 offset:4096
    v_mfma_f32_16x16x32_bf16 v[88:91], v[216:219], v[44:47], v[88:91]
    v_mfma_f32_16x16x32_bf16 v[92:95], v[220:223], v[44:47], v[92:95]
    ds_read_b128 v[44:47], v8 offset:6144
    s_waitcnt lgkmcnt(6)
    v_mfma_f32_16x16x32_bf16 v[96:99], v[216:219], v[48:51], v[96:99]
    v_mfma_f32_16x16x32_bf16 v[100:103], v[220:223], v[48:51], v[100:103]
    ds_read_b128 v[48:51], v8 offset:8192
    v_mfma_f32_16x16x32_bf16 v[104:107], v[216:219], v[52:55], v[104:107]
    buffer_load_dwordx4 v[200:203], v2, s[12:15], s21 offen offset:2048 sc1
    v_mfma_f32_16x16x32_bf16 v[108:111], v[220:223], v[52:55], v[108:111]
    ds_read_b128 v[52:55], v8 offset:10240
    s_waitcnt lgkmcnt(6)
    v_mfma_f32_16x16x32_bf16 v[112:115], v[216:219], v[56:59], v[112:115]
    v_mfma_f32_16x16x32_bf16 v[116:119], v[220:223], v[56:59], v[116:119]
    ds_read_b128 v[56:59], v8 offset:12288
    v_mfma_f32_16x16x32_bf16 v[120:123], v[216:219], v[60:63], v[120:123]
    v_mfma_f32_16x16x32_bf16 v[124:127], v[220:223], v[60:63], v[124:127]
    ds_read_b128 v[60:63], v8 offset:14336
    s_waitcnt vmcnt(17) lgkmcnt(6)
    v_mfma_f32_16x16x32_bf16 v[64:67], v[128:131], v[32:35], v[64:67]
    v_add_u32 v9, 16384, v9
    v_mfma_f32_16x16x32_bf16 v[68:71], v[132:135], v[32:35], v[68:71]
    ds_read_b128 v[32:35], v9 offset:0
    v_mfma_f32_16x16x32_bf16 v[72:75], v[128:131], v[36:39], v[72:75]
    buffer_load_dwordx4 v[204:207], v2, s[12:15], s21 offen offset:3072 sc1
    v_mfma_f32_16x16x32_bf16 v[76:79], v[132:135], v[36:39], v[76:79]
    ds_read_b128 v[36:39], v9 offset:2048
    s_waitcnt lgkmcnt(6)
    v_mfma_f32_16x16x32_bf16 v[80:83], v[128:131], v[40:43], v[80:83]
    v_mfma_f32_16x16x32_bf16 v[84:87], v[132:135], v[40:43], v[84:87]
    ds_read_b128 v[40:43], v9 offset:4096
    v_mfma_f32_16x16x32_bf16 v[88:91], v[128:131], v[44:47], v[88:91]
    v_mfma_f32_16x16x32_bf16 v[92:95], v[132:135], v[44:47], v[92:95]
    ds_read_b128 v[44:47], v9 offset:6144
    s_waitcnt lgkmcnt(6)
    v_mfma_f32_16x16x32_bf16 v[96:99], v[128:131], v[48:51], v[96:99]
    v_mfma_f32_16x16x32_bf16 v[100:103], v[132:135], v[48:51], v[100:103]
    ds_read_b128 v[48:51], v9 offset:8192
    v_mfma_f32_16x16x32_bf16 v[104:107], v[128:131], v[52:55], v[104:107]
    s_add_u32 s21, s24, 61440
    buffer_load_dwordx4 v[208:211], v2, s[12:15], s21 offen offset:0 sc1
    v_mfma_f32_16x16x32_bf16 v[108:111], v[132:135], v[52:55], v[108:111]
    ds_read_b128 v[52:55], v9 offset:10240
    s_waitcnt lgkmcnt(6)
    v_mfma_f32_16x16x32_bf16 v[112:115], v[128:131], v[56:59], v[112:115]
    v_mfma_f32_16x16x32_bf16 v[116:119], v[132:135], v[56:59], v[116:119]
    ds_read_b128 v[56:59], v9 offset:12288
    v_mfma_f32_16x16x32_bf16 v[120:123], v[128:131], v[60:63], v[120:123]
    v_mfma_f32_16x16x32_bf16 v[124:127], v[132:135], v[60:63], v[124:127]
    ds_read_b128 v[60:63], v9 offset:14336
    s_waitcnt vmcnt(17) lgkmcnt(6)
    v_mfma_f32_16x16x32_bf16 v[64:67], v[136:139], v[32:35], v[64:67]
    v_add_u32 v8, 16384, v8
    v_mfma_f32_16x16x32_bf16 v[68:71], v[140:143], v[32:35], v[68:71]
    ds_read_b128 v[32:35], v8 offset:0
    v_mfma_f32_16x16x32_bf16 v[72:75], v[136:139], v[36:39], v[72:75]
    buffer_load_dwordx4 v[212:215], v2, s[12:15], s21 offen offset:1024 sc1
    v_mfma_f32_16x16x32_bf16 v[76:79], v[140:143], v[36:39], v[76:79]
    ds_read_b128 v[36:39], v8 offset:2048
    s_waitcnt lgkmcnt(6)
    v_mfma_f32_16x16x32_bf16 v[80:83], v[136:139], v[40:43], v[80:83]
    v_mfma_f32_16x16x32_bf16 v[84:87], v[140:143], v[40:43], v[84:87]
    ds_read_b128 v[40:43], v8 offset:4096
    v_mfma_f32_16x16x32_bf16 v[88:91], v[136:139], v[44:47], v[88:91]
    v_mfma_f32_16x16x32_bf16 v[92:95], v[140:143], v[44:47], v[92:95]
    ds_read_b128 v[44:47], v8 offset:6144
    s_waitcnt lgkmcnt(6)
    v_mfma_f32_16x16x32_bf16 v[96:99], v[136:139], v[48:51], v[96:99]
    v_mfma_f32_16x16x32_bf16 v[100:103], v[140:143], v[48:51], v[100:103]
    ds_read_b128 v[48:51], v8 offset:8192
    v_mfma_f32_16x16x32_bf16 v[104:107], v[136:139], v[52:55], v[104:107]
    buffer_load_dwordx4 v[216:219], v2, s[12:15], s21 offen offset:2048 sc1
    v_mfma_f32_16x16x32_bf16 v[108:111], v[140:143], v[52:55], v[108:111]
    ds_read_b128 v[52:55], v8 offset:10240
    s_waitcnt lgkmcnt(6)
    v_mfma_f32_16x16x32_bf16 v[112:115], v[136:139], v[56:59], v[112:115]
    v_mfma_f32_16x16x32_bf16 v[116:119], v[140:143], v[56:59], v[116:119]
    ds_read_b128 v[56:59], v8 offset:12288
    v_mfma_f32_16x16x32_bf16 v[120:123], v[136:139], v[60:63], v[120:123]
    v_mfma_f32_16x16x32_bf16 v[124:127], v[140:143], v[60:63], v[124:127]
    ds_read_b128 v[60:63], v8 offset:14336
    s_waitcnt vmcnt(17) lgkmcnt(6)
    v_mfma_f32_16x16x32_bf16 v[64:67], v[144:147], v[32:35], v[64:67]
    v_add_u32 v9, 16384, v9
    v_mfma_f32_16x16x32_bf16 v[68:71], v[148:151], v[32:35], v[68:71]
    ds_read_b128 v[32:35], v9 offset:0
    v_mfma_f32_16x16x32_bf16 v[72:75], v[144:147], v[36:39], v[72:75]
    buffer_load_dwordx4 v[220:223], v2, s[12:15], s21 offen offset:3072 sc1
    v_mfma_f32_16x16x32_bf16 v[76:79], v[148:151], v[36:39], v[76:79]
    ds_read_b128 v[36:39], v9 offset:2048
    s_waitcnt lgkmcnt(6)
    v_mfma_f32_16x16x32_bf16 v[80:83], v[144:147], v[40:43], v[80:83]
    v_mfma_f32_16x16x32_bf16 v[84:87], v[148:151], v[40:43], v[84:87]
    ds_read_b128 v[40:43], v9 offset:4096
    v_mfma_f32_16x16x32_bf16 v[88:91], v[144:147], v[44:47], v[88:91]
    v_mfma_f32_16x16x32_bf16 v[92:95], v[148:151], v[44:47], v[92:95]
    ds_read_b128 v[44:47], v9 offset:6144
    s_waitcnt lgkmcnt(6)
    v_mfma_f32_16x16x32_bf16 v[96:99], v[144:147], v[48:51], v[96:99]
    v_mfma_f32_16x16x32_bf16 v[100:103], v[148:151], v[48:51], v[100:103]
    ds_read_b128 v[48:51], v9 offset:8192
    v_mfma_f32_16x16x32_bf16 v[104:107], v[144:147], v[52:55], v[104:107]
    v_mfma_f32_16x16x32_bf16 v[108:111], v[148:151], v[52:55], v[108:111]
    ds_read_b128 v[52:55], v9 offset:10240
    s_waitcnt lgkmcnt(6)
    v_mfma_f32_16x16x32_bf16 v[112:115], v[144:147], v[56:59], v[112:115]
    v_mfma_f32_16x16x32_bf16 v[116:119], v[148:151], v[56:59], v[116:119]
    ds_read_b128 v[56:59], v9 offset:12288
    v_mfma_f32_16x16x32_bf16 v[120:123], v[144:147], v[60:63], v[120:123]
    v_mfma_f32_16x16x32_bf16 v[124:127], v[148:151], v[60:63], v[124:127]
    ds_read_b128 v[60:63], v9 offset:14336
    s_waitcnt vmcnt(16) lgkmcnt(6)
    v_mfma_f32_16x16x32_bf16 v[64:67], v[152:155], v[32:35], v[64:67]
    s_barrier
    v_add_u32 v8, 16384, v8
    v_mfma_f32_16x16x32_bf16 v[68:71], v[156:159], v[32:35], v[68:71]
    ds_read_b128 v[32:35], v8 offset:0
    v_mfma_f32_16x16x32_bf16 v[72:75], v[152:155], v[36:39], v[72:75]
    v_mfma_f32_16x16x32_bf16 v[76:79], v[156:159], v[36:39], v[76:79]
    ds_read_b128 v[36:39], v8 offset:2048
    s_waitcnt lgkmcnt(6)
    v_mfma_f32_16x16x32_bf16 v[80:83], v[152:155], v[40:43], v[80:83]
    v_mfma_f32_16x16x32_bf16 v[84:87], v[156:159], v[40:43], v[84:87]
    ds_read_b128 v[40:43], v8 offset:4096
    v_mfma_f32_16x16x32_bf16 v[88:91], v[152:155], v[44:47], v[88:91]
    v_mfma_f32_16x16x32_bf16 v[92:95], v[156:159], v[44:47], v[92:95]
    ds_read_b128 v[44:47], v8 offset:6144
    s_waitcnt lgkmcnt(6)
    v_mfma_f32_16x16x32_bf16 v[96:99], v[152:155], v[48:51], v[96:99]
    v_mfma_f32_16x16x32_bf16 v[100:103], v[156:159], v[48:51], v[100:103]
    ds_read_b128 v[48:51], v8 offset:8192
    v_mfma_f32_16x16x32_bf16 v[104:107], v[152:155], v[52:55], v[104:107]
    v_mfma_f32_16x16x32_bf16 v[108:111], v[156:159], v[52:55], v[108:111]
    ds_read_b128 v[52:55], v8 offset:10240
    s_waitcnt lgkmcnt(6)
    v_mfma_f32_16x16x32_bf16 v[112:115], v[152:155], v[56:59], v[112:115]
    v_mfma_f32_16x16x32_bf16 v[116:119], v[156:159], v[56:59], v[116:119]
    ds_read_b128 v[56:59], v8 offset:12288
    v_mfma_f32_16x16x32_bf16 v[120:123], v[152:155], v[60:63], v[120:123]
    v_mfma_f32_16x16x32_bf16 v[124:127], v[156:159], v[60:63], v[124:127]
    ds_read_b128 v[60:63], v8 offset:14336
    s_cmp_lg_u32 s29, 0
    s_cbranch_scc1 L_send
    s_waitcnt vmcnt(14) lgkmcnt(6)
    v_mfma_f32_16x16x32_bf16 v[64:67], v[160:163], v[32:35], v[64:67]
    v_add_u32 v9, 16384, v9
    v_lshlrev_b32 v128, 16, v224
    v_and_b32 v129, 0xffff0000, v224
    v_mfma_f32_16x16x32_bf16 v[68:71], v[164:167], v[32:35], v[68:71]
    ds_read_b128 v[32:35], v9 offset:0
    v_mfma_f32_16x16x32_bf16 v[72:75], v[160:163], v[36:39], v[72:75]
    v_lshlrev_b32 v130, 16, v225
    v_and_b32 v131, 0xffff0000, v225
    v_mfma_f32_16x16x32_bf16 v[76:79], v[164:167], v[36:39], v[76:79]
    ds_read_b128 v[36:39], v9 offset:2048
    s_waitcnt lgkmcnt(6)
    v_mfma_f32_16x16x32_bf16 v[80:83], v[160:163], v[40:43], v[80:83]
    v_lshlrev_b32 v132, 16, v226
    v_and_b32 v133, 0xffff0000, v226
    v_mfma_f32_16x16x32_bf16 v[84:87], v[164:167], v[40:43], v[84:87]
    ds_read_b128 v[40:43], v9 offset:4096
    v_mfma_f32_16x16x32_bf16 v[88:91], v[160:163], v[44:47], v[88:91]
    v_lshlrev_b32 v134, 16, v227
    v_and_b32 v135, 0xffff0000, v227
    v_mfma_f32_16x16x32_bf16 v[92:95], v[164:167], v[44:47], v[92:95]
    ds_read_b128 v[44:47], v9 offset:6144
    s_waitcnt lgkmcnt(6)
    v_mfma_f32_16x16x32_bf16 v[96:99], v[160:163], v[48:51], v[96:99]
    v_lshlrev_b32 v136, 16, v228
    v_and_b32 v137, 0xffff0000, v228
    v_mfma_f32_16x16x32_bf16 v[100:103], v[164:167], v[48:51], v[100:103]
    ds_read_b128 v[48:51], v9 offset:8192
    v_mfma_f32_16x16x32_bf16 v[104:107], v[160:163], v[52:55], v[104:107]
    v_lshlrev_b32 v138, 16, v229
    v_and_b32 v139, 0xffff0000, v229
    v_mfma_f32_16x16x32_bf16 v[108:111], v[164:167], v[52:55], v[108:111]
    ds_read_b128 v[52:55], v9 offset:10240
    s_waitcnt lgkmcnt(6)
    v_mfma_f32_16x16x32_bf16 v[112:115], v[160:163], v[56:59], v[112:115]
    v_lshlrev_b32 v140, 16, v230
    v_and_b32 v141, 0xffff0000, v230
    v_mfma_f32_16x16x32_bf16 v[116:119], v[164:167], v[56:59], v[116:119]
    ds_read_b128 v[56:59], v9 offset:12288
    v_mfma_f32_16x16x32_bf16 v[120:123], v[160:163], v[60:63], v[120:123]
    v_lshlrev_b32 v142, 16, v231
    v_and_b32 v143, 0xffff0000, v231
    v_mfma_f32_16x16x32_bf16 v[124:127], v[164:167], v[60:63], v[124:127]
    ds_read_b128 v[60:63], v9 offset:14336
    s_waitcnt vmcnt(12) lgkmcnt(6)
    v_mfma_f32_16x16x32_bf16 v[64:67], v[168:171], v[32:35], v[64:67]
    v_add_u32 v8, 16384, v8
    v_lshlrev_b32 v144, 16, v232
    v_and_b32 v145, 0xffff0000, v232
    v_mfma_f32_16x16x32_bf16 v[68:71], v[172:175], v[32:35], v[68:71]
    ds_read_b128 v[32:35], v8 offset:0
    v_mfma_f32_16x16x32_bf16 v[72:75], v[168:171], v[36:39], v[72:75]
    v_lshlrev_b32 v146, 16, v233
    v_and_b32 v147, 0xffff0000, v233
    v_mfma_f32_16x16x32_bf16 v[76:79], v[172:175], v[36:39], v[76:79]
    ds_read_b128 v[36:39], v8 offset:2048
    s_waitcnt lgkmcnt(6)
    v_mfma_f32_16x16x32_bf16 v[80:83], v[168:171], v[40:43], v[80:83]
    v_lshlrev_b32 v148, 16, v234
    v_and_b32 v149, 0xffff0000, v234
    v_mfma_f32_16x16x32_bf16 v[84:87], v[172:175], v[40:43], v[84:87]
    ds_read_b128 v[40:43], v8 offset:4096
    v_mfma_f32_16x16x32_bf16 v[88:91], v[168:171], v[44:47], v[88:91]
    v_lshlrev_b32 v150, 16, v235
    v_and_b32 v151, 0xffff0000, v235
    v_mfma_f32_16x16x32_bf16 v[92:95], v[172:175], v[44:47], v[92:95]
    ds_read_b128 v[44:47], v8 offset:6144
    s_waitcnt lgkmcnt(6)
    v_mfma_f32_16x16x32_bf16 v[96:99], v[168:171], v[48:51], v[96:99]
    v_lshlrev_b32 v152, 16, v236
    v_and_b32 v153, 0xffff0000, v236
    v_mfma_f32_16x16x32_bf16 v[100:103], v[172:175], v[48:51], v[100:103]
    ds_read_b128 v[48:51], v8 offset:8192
    v_mfma_f32_16x16x32_bf16 v[104:107], v[168:171], v[52:55], v[104:107]
    v_lshlrev_b32 v154, 16, v237
    v_and_b32 v155, 0xffff0000, v237
    v_mfma_f32_16x16x32_bf16 v[108:111], v[172:175], v[52:55], v[108:111]
    ds_read_b128 v[52:55], v8 offset:10240
    s_waitcnt lgkmcnt(6)
    v_mfma_f32_16x16x32_bf16 v[112:115], v[168:171], v[56:59], v[112:115]
    v_lshlrev_b32 v156, 16, v238
    v_and_b32 v157, 0xffff0000, v238
    v_mfma_f32_16x16x32_bf16 v[116:119], v[172:175], v[56:59], v[116:119]
    ds_read_b128 v[56:59], v8 offset:12288
    v_mfma_f32_16x16x32_bf16 v[120:123], v[168:171], v[60:63], v[120:123]
    v_lshlrev_b32 v158, 16, v239
    v_and_b32 v159, 0xffff0000, v239
    v_mfma_f32_16x16x32_bf16 v[124:127], v[172:175], v[60:63], v[124:127]
    ds_read_b128 v[60:63], v8 offset:14336
    s_waitcnt vmcnt(10) lgkmcnt(6)
    v_mfma_f32_16x16x32_bf16 v[64:67], v[176:179], v[32:35], v[64:67]
    v_add_u32 v9, 16384, v9
    v_mfma_f32_16x16x32_bf16 v[68:71], v[180:183], v[32:35], v[68:71]
    ds_read_b128 v[32:35], v9 offset:0
    v_mfma_f32_16x16x32_bf16 v[72:75], v[176:179], v[36:39], v[72:75]
    v_mfma_f32_16x16x32_bf16 v[76:79], v[180:183], v[36:39], v[76:79]
    ds_read_b128 v[36:39], v9 offset:2048
    s_waitcnt lgkmcnt(6)
    v_mfma_f32_16x16x32_bf16 v[80:83], v[176:179], v[40:43], v[80:83]
    v_mfma_f32_16x16x32_bf16 v[84:87], v[180:183], v[40:43], v[84:87]
    ds_read_b128 v[40:43], v9 offset:4096
    v_mfma_f32_16x16x32_bf16 v[88:91], v[176:179], v[44:47], v[88:91]
    v_mfma_f32_16x16x32_bf16 v[92:95], v[180:183], v[44:47], v[92:95]
    ds_read_b128 v[44:47], v9 offset:6144
    s_waitcnt lgkmcnt(6)
    v_mfma_f32_16x16x32_bf16 v[96:99], v[176:179], v[48:51], v[96:99]
    v_mfma_f32_16x16x32_bf16 v[100:103], v[180:183], v[48:51], v[100:103]
    ds_read_b128 v[48:51], v9 offset:8192
    v_mfma_f32_16x16x32_bf16 v[104:107], v[176:179], v[52:55], v[104:107]
    v_mfma_f32_16x16x32_bf16 v[108:111], v[180:183], v[52:55], v[108:111]
    ds_read_b128 v[52:55], v9 offset:10240
    s_waitcnt lgkmcnt(6)
    v_mfma_f32_16x16x32_bf16 v[112:115], v[176:179], v[56:59], v[112:115]
    v_mfma_f32_16x16x32_bf16 v[116:119], v[180:183], v[56:59], v[116:119]
    ds_read_b128 v[56:59], v9 offset:12288
    v_mfma_f32_16x16x32_bf16 v[120:123], v[176:179], v[60:63], v[120:123]
    v_mfma_f32_16x16x32_bf16 v[124:127], v[180:183], v[60:63], v[124:127]
    ds_read_b128 v[60:63], v9 offset:14336
    s_waitcnt vmcnt(8) lgkmcnt(6)
    v_mfma_f32_16x16x32_bf16 v[64:67], v[184:187], v[32:35], v[64:67]
    s_barrier
    v_add_u32 v8, 16384, v8
    v_mfma_f32_16x16x32_bf16 v[68:71], v[188:191], v[32:35], v[68:71]
    ds_read_b128 v[32:35], v8 offset:0
    v_mfma_f32_16x16x32_bf16 v[72:75], v[184:187], v[36:39], v[72:75]
    v_mfma_f32_16x16x32_bf16 v[76:79], v[188:191], v[36:39], v[76:79]
    ds_read_b128 v[36:39], v8 offset:2048
    s_waitcnt lgkmcnt(6)
    v_mfma_f32_16x16x32_bf16 v[80:83], v[184:187], v[40:43], v[80:83]
    v_mfma_f32_16x16x32_bf16 v[84:87], v[188:191], v[40:43], v[84:87]
    ds_read_b128 v[40:43], v8 offset:4096
    v_mfma_f32_16x16x32_bf16 v[88:91], v[184:187], v[44:47], v[88:91]
    v_mfma_f32_16x16x32_bf16 v[92:95], v[188:191], v[44:47], v[92:95]
    ds_read_b128 v[44:47], v8 offset:6144
    s_waitcnt lgkmcnt(6)
    v_mfma_f32_16x16x32_bf16 v[96:99], v[184:187], v[48:51], v[96:99]
    v_mfma_f32_16x16x32_bf16 v[100:103], v[188:191], v[48:51], v[100:103]
    ds_read_b128 v[48:51], v8 offset:8192
    v_mfma_f32_16x16x32_bf16 v[104:107], v[184:187], v[52:55], v[104:107]
    v_mfma_f32_16x16x32_bf16 v[108:111], v[188:191], v[52:55], v[108:111]
    ds_read_b128 v[52:55], v8 offset:10240
    s_waitcnt lgkmcnt(6)
    v_mfma_f32_16x16x32_bf16 v[112:115], v[184:187], v[56:59], v[112:115]
    v_mfma_f32_16x16x32_bf16 v[116:119], v[188:191], v[56:59], v[116:119]
    ds_read_b128 v[56:59], v8 offset:12288
    v_mfma_f32_16x16x32_bf16 v[120:123], v[184:187], v[60:63], v[120:123]
    v_mfma_f32_16x16x32_bf16 v[124:127], v[188:191], v[60:63], v[124:127]
    ds_read_b128 v[60:63], v8 offset:14336
    s_waitcnt vmcnt(6) lgkmcnt(6)
    v_mfma_f32_16x16x32_bf16 v[64:67], v[192:195], v[32:35], v[64:67]
    v_add_u32 v9, 16384, v9
    v_lshlrev_b32 v160, 16, v240
    v_and_b32 v161, 0xffff0000, v240
    v_mfma_f32_16x16x32_bf16 v[68:71], v[196:199], v[32:35], v[68:71]
    ds_read_b128 v[32:35], v9 offset:0
    v_mfma_f32_16x16x32_bf16 v[72:75], v[192:195], v[36:39], v[72:75]
    v_lshlrev_b32 v162, 16, v241
    v_and_b32 v163, 0xffff0000, v241
    v_mfma_f32_16x16x32_bf16 v[76:79], v[196:199], v[36:39], v[76:79]
    ds_read_b128 v[36:39], v9 offset:2048
    s_waitcnt lgkmcnt(6)
    v_mfma_f32_16x16x32_bf16 v[80:83], v[192:195], v[40:43], v[80:83]
    v_lshlrev_b32 v164, 16, v242
    v_and_b32 v165, 0xffff0000, v242
    v_mfma_f32_16x16x32_bf16 v[84:87], v[196:199], v[40:43], v[84:87]
    ds_read_b128 v[40:43], v9 offset:4096
    v_mfma_f32_16x16x32_bf16 v[88:91], v[192:195], v[44:47], v[88:91]
    v_lshlrev_b32 v166, 16, v243
    v_and_b32 v167, 0xffff0000, v243
    v_mfma_f32_16x16x32_bf16 v[92:95], v[196:199], v[44:47], v[92:95]
    ds_read_b128 v[44:47], v9 offset:6144
    s_waitcnt lgkmcnt(6)
    v_mfma_f32_16x16x32_bf16 v[96:99], v[192:195], v[48:51], v[96:99]
    v_lshlrev_b32 v168, 16, v244
    v_and_b32 v169, 0xffff0000, v244
    v_mfma_f32_16x16x32_bf16 v[100:103], v[196:199], v[48:51], v[100:103]
    ds_read_b128 v[48:51], v9 offset:8192
    v_mfma_f32_16x16x32_bf16 v[104:107], v[192:195], v[52:55], v[104:107]
    v_lshlrev_b32 v170, 16, v245
    v_and_b32 v171, 0xffff0000, v245
    v_mfma_f32_16x16x32_bf16 v[108:111], v[196:199], v[52:55], v[108:111]
    ds_read_b128 v[52:55], v9 offset:10240
    s_waitcnt lgkmcnt(6)
    v_mfma_f32_16x16x32_bf16 v[112:115], v[192:195], v[56:59], v[112:115]
    v_lshlrev_b32 v172, 16, v246
    v_and_b32 v173, 0xffff0000, v246
    v_mfma_f32_16x16x32_bf16 v[116:119], v[196:199], v[56:59], v[116:119]
    ds_read_b128 v[56:59], v9 offset:12288
    v_mfma_f32_16x16x32_bf16 v[120:123], v[192:195], v[60:63], v[120:123]
    v_lshlrev_b32 v174, 16, v247
    v_and_b32 v175, 0xffff0000, v247
    v_mfma_f32_16x16x32_bf16 v[124:127], v[196:199], v[60:63], v[124:127]
    ds_read_b128 v[60:63], v9 offset:14336
    s_waitcnt vmcnt(4) lgkmcnt(6)
    v_mfma_f32_16x16x32_bf16 v[64:67], v[200:203], v[32:35], v[64:67]
    v_add_u32 v8, 16384, v8
    v_lshlrev_b32 v176, 16, v248
    v_and_b32 v177, 0xffff0000, v248
    v_mfma_f32_16x16x32_bf16 v[68:71], v[204:207], v[32:35], v[68:71]
    ds_read_b128 v[32:35], v8 offset:0
    v_mfma_f32_16x16x32_bf16 v[72:75], v[200:203], v[36:39], v[72:75]
    v_lshlrev_b32 v178, 16, v249
    v_and_b32 v179, 0xffff0000, v249
    v_mfma_f32_16x16x32_bf16 v[76:79], v[204:207], v[36:39], v[76:79]
    ds_read_b128 v[36:39], v8 offset:2048
    s_waitcnt lgkmcnt(6)
    v_mfma_f32_16x16x32_bf16 v[80:83], v[200:203], v[40:43], v[80:83]
    v_lshlrev_b32 v180, 16, v250
    v_and_b32 v181, 0xffff0000, v250
    buffer_load_dword v15, v14, s[12:15], s34 offen sc1
    v_mfma_f32_16x16x32_bf16 v[84:87], v[204:207], v[40:43], v[84:87]
    ds_read_b128 v[40:43], v8 offset:4096
    v_mfma_f32_16x16x32_bf16 v[88:91], v[200:203], v[44:47], v[88:91]
    v_lshlrev_b32 v182, 16, v251
    v_and_b32 v183, 0xffff0000, v251
    v_mfma_f32_16x16x32_bf16 v[92:95], v[204:207], v[44:47], v[92:95]
    ds_read_b128 v[44:47], v8 offset:6144
    s_waitcnt lgkmcnt(6)
    v_mfma_f32_16x16x32_bf16 v[96:99], v[200:203], v[48:51], v[96:99]
    v_lshlrev_b32 v184, 16, v252
    v_and_b32 v185, 0xffff0000, v252
    v_mfma_f32_16x16x32_bf16 v[100:103], v[204:207], v[48:51], v[100:103]
    ds_read_b128 v[48:51], v8 offset:8192
    v_mfma_f32_16x16x32_bf16 v[104:107], v[200:203], v[52:55], v[104:107]
    v_lshlrev_b32 v186, 16, v253
    v_and_b32 v187, 0xffff0000, v253
    v_mfma_f32_16x16x32_bf16 v[108:111], v[204:207], v[52:55], v[108:111]
    ds_read_b128 v[52:55], v8 offset:10240
    s_waitcnt lgkmcnt(6)
    v_mfma_f32_16x16x32_bf16 v[112:115], v[200:203], v[56:59], v[112:115]
    v_lshlrev_b32 v188, 16, v254
    v_and_b32 v189, 0xffff0000, v254
    v_mfma_f32_16x16x32_bf16 v[116:119], v[204:207], v[56:59], v[116:119]
    ds_read_b128 v[56:59], v8 offset:12288
    v_mfma_f32_16x16x32_bf16 v[120:123], v[200:203], v[60:63], v[120:123]
    v_lshlrev_b32 v190, 16, v255
    v_and_b32 v191, 0xffff0000, v255
    v_mfma_f32_16x16x32_bf16 v[124:127], v[204:207], v[60:63], v[124:127]
    ds_read_b128 v[60:63], v8 offset:14336
    s_waitcnt vmcnt(3) lgkmcnt(6)
    v_mfma_f32_16x16x32_bf16 v[64:67], v[208:211], v[32:35], v[64:67]
    v_add_u32 v9, 16384, v9
    v_mfma_f32_16x16x32_bf16 v[68:71], v[212:215], v[32:35], v[68:71]
    ds_read_b128 v[32:35], v9 offset:0
    v_mfma_f32_16x16x32_bf16 v[72:75], v[208:211], v[36:39], v[72:75]
    v_mfma_f32_16x16x32_bf16 v[76:79], v[212:215], v[36:39], v[76:79]
    ds_read_b128 v[36:39], v9 offset:2048
    s_waitcnt lgkmcnt(6)
    v_mfma_f32_16x16x32_bf16 v[80:83], v[208:211], v[40:43], v[80:83]
    v_mfma_f32_16x16x32_bf16 v[84:87], v[212:215], v[40:43], v[84:87]
    ds_read_b128 v[40:43], v9 offset:4096
    v_mfma_f32_16x16x32_bf16 v[88:91], v[208:211], v[44:47], v[88:91]
    v_mfma_f32_16x16x32_bf16 v[92:95], v[212:215], v[44:47], v[92:95]
    ds_read_b128 v[44:47], v9 offset:6144
    s_waitcnt lgkmcnt(6)
    v_mfma_f32_16x16x32_bf16 v[96:99], v[208:211], v[48:51], v[96:99]
    v_mfma_f32_16x16x32_bf16 v[100:103], v[212:215], v[48:51], v[100:103]
    ds_read_b128 v[48:51], v9 offset:8192
    v_mfma_f32_16x16x32_bf16 v[104:107], v[208:211], v[52:55], v[104:107]
    v_mfma_f32_16x16x32_bf16 v[108:111], v[212:215], v[52:55], v[108:111]
    ds_read_b128 v[52:55], v9 offset:10240
    s_waitcnt lgkmcnt(6)
    v_mfma_f32_16x16x32_bf16 v[112:115], v[208:211], v[56:59], v[112:115]
    v_mfma_f32_16x16x32_bf16 v[116:119], v[212:215], v[56:59], v[116:119]
    ds_read_b128 v[56:59], v9 offset:12288
    v_mfma_f32_16x16x32_bf16 v[120:123], v[208:211], v[60:63], v[120:123]
    v_mfma_f32_16x16x32_bf16 v[124:127], v[212:215], v[60:63], v[124:127]
    ds_read_b128 v[60:63], v9 offset:14336
    s_waitcnt vmcnt(1) lgkmcnt(6)
    v_mfma_f32_16x16x32_bf16 v[64:67], v[216:219], v[32:35], v[64:67]
    v_mfma_f32_16x16x32_bf16 v[68:71], v[220:223], v[32:35], v[68:71]
    v_mfma_f32_16x16x32_bf16 v[72:75], v[216:219], v[36:39], v[72:75]
    v_mfma_f32_16x16x32_bf16 v[76:79], v[220:223], v[36:39], v[76:79]
    s_waitcnt lgkmcnt(4)
    v_mfma_f32_16x16x32_bf16 v[80:83], v[216:219], v[40:43], v[80:83]
    v_mfma_f32_16x16x32_bf16 v[84:87], v[220:223], v[40:43], v[84:87]
    v_mfma_f32_16x16x32_bf16 v[88:91], v[216:219], v[44:47], v[88:91]
    v_mfma_f32_16x16x32_bf16 v[92:95], v[220:223], v[44:47], v[92:95]
    s_waitcnt lgkmcnt(2)
    v_mfma_f32_16x16x32_bf16 v[96:99], v[216:219], v[48:51], v[96:99]
    v_mfma_f32_16x16x32_bf16 v[100:103], v[220:223], v[48:51], v[100:103]
    v_mfma_f32_16x16x32_bf16 v[104:107], v[216:219], v[52:55], v[104:107]
    v_mfma_f32_16x16x32_bf16 v[108:111], v[220:223], v[52:55], v[108:111]
    s_waitcnt lgkmcnt(0)
    v_mfma_f32_16x16x32_bf16 v[112:115], v[216:219], v[56:59], v[112:115]
    s_waitcnt vmcnt(0)
    s_mov_b32 s3, 0
    v_cmp_ne_u32 vcc, s28, v15
    s_nop 0
    s_cbranch_vccnz L_k_no
    buffer_load_dwordx4 v[224:227], v10, s[12:15], s23 offen offset:0 sc1
    buffer_load_dwordx4 v[228:231], v10, s[12:15], s23 offen offset:256 sc1
    s_add_u32 s23, s23, 57344
    buffer_load_dwordx4 v[232:235], v10, s[12:15], s23 offen offset:0 sc1
    buffer_load_dwordx4 v[236:239], v10, s[12:15], s23 offen offset:256 sc1
    s_add_u32 s23, s23, 57344
    buffer_load_dwordx4 v[240:243], v10, s[12:15], s23 offen offset:0 sc1
    buffer_load_dwordx4 v[244:247], v10, s[12:15], s23 offen offset:256 sc1
    s_add_u32 s23, s23, 57344
    buffer_load_dwordx4 v[248:251], v10, s[12:15], s23 offen offset:0 sc1
    buffer_load_dwordx4 v[252:255], v10, s[12:15], s23 offen offset:256 sc1
    s_add_u32 s23, s23, 57344
    s_mov_b32 s3, 1
L_k_no:
    v_mfma_f32_16x16x32_bf16 v[116:119], v[220:223], v[56:59], v[116:119]
    v_mfma_f32_16x16x32_bf16 v[120:123], v[216:219], v[60:63], v[120:123]
    v_mfma_f32_16x16x32_bf16 v[124:127], v[220:223], v[60:63], v[124:127]
    v_pk_mul_f32 v[64:65], v[64:65], v[128:129]
    v_pk_mul_f32 v[66:67], v[66:67], v[130:131]
    v_pk_mul_f32 v[68:69], v[68:69], v[132:133]
    v_pk_mul_f32 v[70:71], v[70:71], v[134:135]
    v_pk_mul_f32 v[72:73], v[72:73], v[136:137]
    v_pk_mul_f32 v[74:75], v[74:75], v[138:139]
    v_pk_mul_f32 v[76:77], v[76:77], v[140:141]
    v_pk_mul_f32 v[78:79], v[78:79], v[142:143]
    v_pk_mul_f32 v[80:81], v[80:81], v[144:145]
    v_pk_mul_f32 v[82:83], v[82:83], v[146:147]
    v_pk_mul_f32 v[84:85], v[84:85], v[148:149]
    v_pk_mul_f32 v[86:87], v[86:87], v[150:151]
    v_pk_mul_f32 v[88:89], v[88:89], v[152:153]
    v_pk_mul_f32 v[90:91], v[90:91], v[154:155]
    v_pk_mul_f32 v[92:93], v[92:93], v[156:157]
    v_pk_mul_f32 v[94:95], v[94:95], v[158:159]
    v_pk_mul_f32 v[96:97], v[96:97], v[160:161]
    v_pk_mul_f32 v[98:99], v[98:99], v[162:163]
    v_pk_mul_f32 v[100:101], v[100:101], v[164:165]
    v_pk_mul_f32 v[102:103], v[102:103], v[166:167]
    v_pk_mul_f32 v[104:105], v[104:105], v[168:169]
    v_pk_mul_f32 v[106:107], v[106:107], v[170:171]
    v_pk_mul_f32 v[108:109], v[108:109], v[172:173]
    v_pk_mul_f32 v[110:111], v[110:111], v[174:175]
    v_pk_mul_f32 v[112:113], v[112:113], v[176:177]
    v_pk_mul_f32 v[114:115], v[114:115], v[178:179]
    v_pk_mul_f32 v[116:117], v[116:117], v[180:181]
    v_pk_mul_f32 v[118:119], v[118:119], v[182:183]
    v_pk_mul_f32 v[120:121], v[120:121], v[184:185]
    v_pk_mul_f32 v[122:123], v[122:123], v[186:187]
    v_pk_mul_f32 v[124:125], v[124:125], v[188:189]
    v_pk_mul_f32 v[126:127], v[126:127], v[190:191]
    s_cmp_eq_u32 s3, 1
    s_cbranch_scc1 L_k_go
L_poll9:
    buffer_load_dword v15, v14, s[12:15], s34 offen sc1
    s_add_u32 s33, s33, 1
    s_waitcnt vmcnt(0)
    v_cmp_ne_u32 vcc, s28, v15
    s_cmp_gt_u32 s33, 262144
    s_cbranch_scc1 L_poll9_d
    s_cbranch_vccz L_poll9_d
    s_sleep 1
    s_branch L_poll9
L_poll9_d:
    buffer_load_dwordx4 v[224:227], v10, s[12:15], s23 offen offset:0 sc1
    buffer_load_dwordx4 v[228:231], v10, s[12:15], s23 offen offset:256 sc1
    s_add_u32 s23, s23, 57344
    buffer_load_dwordx4 v[232:235], v10, s[12:15], s23 offen offset:0 sc1
    buffer_load_dwordx4 v[236:239], v10, s[12:15], s23 offen offset:256 sc1
    s_add_u32 s23, s23, 57344
    buffer_load_dwordx4 v[240:243], v10, s[12:15], s23 offen offset:0 sc1
    buffer_load_dwordx4 v[244:247], v10, s[12:15], s23 offen offset:256 sc1
    s_add_u32 s23, s23, 57344
    buffer_load_dwordx4 v[248:251], v10, s[12:15], s23 offen offset:0 sc1
    buffer_load_dwordx4 v[252:255], v10, s[12:15], s23 offen offset:256 sc1
    s_add_u32 s23, s23, 57344
L_k_go:
    s_add_u32 s23, s26, 0xa00000
    s_waitcnt vmcnt(7)
    v_lshlrev_b32 v16, 16, v224
    v_and_b32 v17, 0xffff0000, v224
    v_lshlrev_b32 v18, 16, v225
    v_and_b32 v19, 0xffff0000, v225
    v_lshlrev_b32 v20, 16, v226
    v_and_b32 v21, 0xffff0000, v226
    v_lshlrev_b32 v22, 16, v227
    v_and_b32 v23, 0xffff0000, v227
    v_pk_fma_f32 v[64:65], v[16:17], v[128:129], v[64:65]
    v_pk_fma_f32 v[66:67], v[18:19], v[130:131], v[66:67]
    v_pk_fma_f32 v[68:69], v[20:21], v[132:133], v[68:69]
    v_pk_fma_f32 v[70:71], v[22:23], v[134:135], v[70:71]
    v_cvt_pk_bf16_f32 v224, v64, v65
    v_cvt_pk_bf16_f32 v225, v66, v67
    v_cvt_pk_bf16_f32 v226, v68, v69
    v_cvt_pk_bf16_f32 v227, v70, v71
    buffer_store_dwordx4 v[224:227], v10, s[12:15], s23 offen offset:0 sc1
    s_waitcnt vmcnt(7)
    v_lshlrev_b32 v16, 16, v228
    v_and_b32 v17, 0xffff0000, v228
    v_lshlrev_b32 v18, 16, v229
    v_and_b32 v19, 0xffff0000, v229
    v_lshlrev_b32 v20, 16, v230
    v_and_b32 v21, 0xffff0000, v230
    v_lshlrev_b32 v22, 16, v231
    v_and_b32 v23, 0xffff0000, v231
    v_pk_fma_f32 v[72:73], v[16:17], v[136:137], v[72:73]
    v_pk_fma_f32 v[74:75], v[18:19], v[138:139], v[74:75]
    v_pk_fma_f32 v[76:77], v[20:21], v[140:141], v[76:77]
    v_pk_fma_f32 v[78:79], v[22:23], v[142:143], v[78:79]
    v_cvt_pk_bf16_f32 v228, v72, v73
    v_cvt_pk_bf16_f32 v229, v74, v75
    v_cvt_pk_bf16_f32 v230, v76, v77
    v_cvt_pk_bf16_f32 v231, v78, v79
    buffer_store_dwordx4 v[228:231], v10, s[12:15], s23 offen offset:256 sc1
    s_add_u32 s23, s23, 57344
    s_waitcnt vmcnt(7)
    v_lshlrev_b32 v16, 16, v232
    v_and_b32 v17, 0xffff0000, v232
    v_lshlrev_b32 v18, 16, v233
    v_and_b32 v19, 0xffff0000, v233
    v_lshlrev_b32 v20, 16, v234
    v_and_b32 v21, 0xffff0000, v234
    v_lshlrev_b32 v22, 16, v235
    v_and_b32 v23, 0xffff0000, v235
    v_pk_fma_f32 v[80:81], v[16:17], v[144:145], v[80:81]
    v_pk_fma_f32 v[82:83], v[18:19], v[146:147], v[82:83]
    v_pk_fma_f32 v[84:85], v[20:21], v[148:149], v[84:85]
    v_pk_fma_f32 v[86:87], v[22:23], v[150:151], v[86:87]
    v_cvt_pk_bf16_f32 v232, v80, v81
    v_cvt_pk_bf16_f32 v233, v82, v83
    v_cvt_pk_bf16_f32 v234, v84, v85
    v_cvt_pk_bf16_f32 v235, v86, v87
    buffer_store_dwordx4 v[232:235], v10, s[12:15], s23 offen offset:0 sc1
    s_waitcnt vmcnt(7)
    v_lshlrev_b32 v16, 16, v236
    v_and_b32 v17, 0xffff0000, v236
    v_lshlrev_b32 v18, 16, v237
    v_and_b32 v19, 0xffff0000, v237
    v_lshlrev_b32 v20, 16, v238
    v_and_b32 v21, 0xffff0000, v238
    v_lshlrev_b32 v22, 16, v239
    v_and_b32 v23, 0xffff0000, v239
    v_pk_fma_f32 v[88:89], v[16:17], v[152:153], v[88:89]
    v_pk_fma_f32 v[90:91], v[18:19], v[154:155], v[90:91]
    v_pk_fma_f32 v[92:93], v[20:21], v[156:157], v[92:93]
    v_pk_fma_f32 v[94:95], v[22:23], v[158:159], v[94:95]
    v_cvt_pk_bf16_f32 v236, v88, v89
    v_cvt_pk_bf16_f32 v237, v90, v91
    v_cvt_pk_bf16_f32 v238, v92, v93
    v_cvt_pk_bf16_f32 v239, v94, v95
    buffer_store_dwordx4 v[236:239], v10, s[12:15], s23 offen offset:256 sc1
    s_add_u32 s23, s23, 57344
    s_waitcnt vmcnt(7)
    v_lshlrev_b32 v16, 16, v240
    v_and_b32 v17, 0xffff0000, v240
    v_lshlrev_b32 v18, 16, v241
    v_and_b32 v19, 0xffff0000, v241
    v_lshlrev_b32 v20, 16, v242
    v_and_b32 v21, 0xffff0000, v242
    v_lshlrev_b32 v22, 16, v243
    v_and_b32 v23, 0xffff0000, v243
    v_pk_fma_f32 v[96:97], v[16:17], v[160:161], v[96:97]
    v_pk_fma_f32 v[98:99], v[18:19], v[162:163], v[98:99]
    v_pk_fma_f32 v[100:101], v[20:21], v[164:165], v[100:101]
    v_pk_fma_f32 v[102:103], v[22:23], v[166:167], v[102:103]
    v_cvt_pk_bf16_f32 v240, v96, v97
    v_cvt_pk_bf16_f32 v241, v98, v99
    v_cvt_pk_bf16_f32 v242, v100, v101
    v_cvt_pk_bf16_f32 v243, v102, v103
    buffer_store_dwordx4 v[240:243], v10, s[12:15], s23 offen offset:0 sc1
    s_waitcnt vmcnt(7)
    v_lshlrev_b32 v16, 16, v244
    v_and_b32 v17, 0xffff0000, v244
    v_lshlrev_b32 v18, 16, v245
    v_and_b32 v19, 0xffff0000, v245
    v_lshlrev_b32 v20, 16, v246
    v_and_b32 v21, 0xffff0000, v246
    v_lshlrev_b32 v22, 16, v247
    v_and_b32 v23, 0xffff0000, v247
    v_pk_fma_f32 v[104:105], v[16:17], v[168:169], v[104:105]
    v_pk_fma_f32 v[106:107], v[18:19], v[170:171], v[106:107]
    v_pk_fma_f32 v[108:109], v[20:21], v[172:173], v[108:109]
    v_pk_fma_f32 v[110:111], v[22:23], v[174:175], v[110:111]
    v_cvt_pk_bf16_f32 v244, v104, v105
    v_cvt_pk_bf16_f32 v245, v106, v107
    v_cvt_pk_bf16_f32 v246, v108, v109
    v_cvt_pk_bf16_f32 v247, v110, v111
    buffer_store_dwordx4 v[244:247], v10, s[12:15], s23 offen offset:256 sc1
    s_add_u32 s23, s23, 57344
    s_waitcnt vmcnt(7)
    v_lshlrev_b32 v16, 16, v248
    v_and_b32 v17, 0xffff0000, v248
    v_lshlrev_b32 v18, 16, v249
    v_and_b32 v19, 0xffff0000, v249
    v_lshlrev_b32 v20, 16, v250
    v_and_b32 v21, 0xffff0000, v250
    v_lshlrev_b32 v22, 16, v251
    v_and_b32 v23, 0xffff0000, v251
    v_pk_fma_f32 v[112:113], v[16:17], v[176:177], v[112:113]
    v_pk_fma_f32 v[114:115], v[18:19], v[178:179], v[114:115]
    v_pk_fma_f32 v[116:117], v[20:21], v[180:181], v[116:117]
    v_pk_fma_f32 v[118:119], v[22:23], v[182:183], v[118:119]
    v_cvt_pk_bf16_f32 v248, v112, v113
    v_cvt_pk_bf16_f32 v249, v114, v115
    v_cvt_pk_bf16_f32 v250, v116, v117
    v_cvt_pk_bf16_f32 v251, v118, v119
    buffer_store_dwordx4 v[248:251], v10, s[12:15], s23 offen offset:0 sc1
    s_waitcnt vmcnt(7)
    v_lshlrev_b32 v16, 16, v252
    v_and_b32 v17, 0xffff0000, v252
    v_lshlrev_b32 v18, 16, v253
    v_and_b32 v19, 0xffff0000, v253
    v_lshlrev_b32 v20, 16, v254
    v_and_b32 v21, 0xffff0000, v254
    v_lshlrev_b32 v22, 16, v255
    v_and_b32 v23, 0xffff0000, v255
    v_pk_fma_f32 v[120:121], v[16:17], v[184:185], v[120:121]
    v_pk_fma_f32 v[122:123], v[18:19], v[186:187], v[122:123]
    v_pk_fma_f32 v[124:125], v[20:21], v[188:189], v[124:125]
    v_pk_fma_f32 v[126:127], v[22:23], v[190:191], v[126:127]
    v_cvt_pk_bf16_f32 v252, v120, v121
    v_cvt_pk_bf16_f32 v253, v122, v123
    v_cvt_pk_bf16_f32 v254, v124, v125
    v_cvt_pk_bf16_f32 v255, v126, v127
    buffer_store_dwordx4 v[252:255], v10, s[12:15], s23 offen offset:256 sc1
    s_add_u32 s23, s23, 57344
    s_branch L_kjoin
L_send:
    s_nop 7
    v_pk_add_f32 v[64:65], v[64:65], v[24:25] op_sel_hi:[1,0]
    v_pk_add_f32 v[66:67], v[66:67], v[24:25] op_sel_hi:[1,0]
    v_pk_add_f32 v[68:69], v[68:69], v[24:25] op_sel_hi:[1,0]
    v_pk_add_f32 v[70:71], v[70:71], v[24:25] op_sel_hi:[1,0]
    v_cvt_pk_bf16_f32 v224, v64, v65
    v_cvt_pk_bf16_f32 v225, v66, v67
    v_cvt_pk_bf16_f32 v226, v68, v69
    v_cvt_pk_bf16_f32 v227, v70, v71
    buffer_store_dwordx4 v[224:227], v10, s[12:15], s23 offen offset:0 sc1
    v_pk_add_f32 v[72:73], v[72:73], v[24:25] op_sel:[0,1] op_sel_hi:[1,1]
    v_pk_add_f32 v[74:75], v[74:75], v[24:25] op_sel:[0,1] op_sel_hi:[1,1]
    v_pk_add_f32 v[76:77], v[76:77], v[24:25] op_sel:[0,1] op_sel_hi:[1,1]
    v_pk_add_f32 v[78:79], v[78:79], v[24:25] op_sel:[0,1] op_sel_hi:[1,1]
    v_cvt_pk_bf16_f32 v228, v72, v73
    v_cvt_pk_bf16_f32 v229, v74, v75
    v_cvt_pk_bf16_f32 v230, v76, v77
    v_cvt_pk_bf16_f32 v231, v78, v79
    buffer_store_dwordx4 v[228:231], v10, s[12:15], s23 offen offset:256 sc1
    s_add_u32 s23, s23, 57344
    v_pk_add_f32 v[80:81], v[80:81], v[26:27] op_sel_hi:[1,0]
    v_pk_add_f32 v[82:83], v[82:83], v[26:27] op_sel_hi:[1,0]
    v_pk_add_f32 v[84:85], v[84:85], v[26:27] op_sel_hi:[1,0]
    v_pk_add_f32 v[86:87], v[86:87], v[26:27] op_sel_hi:[1,0]
    v_cvt_pk_bf16_f32 v232, v80, v81
    v_cvt_pk_bf16_f32 v233, v82, v83
    v_cvt_pk_bf16_f32 v234, v84, v85
    v_cvt_pk_bf16_f32 v235, v86, v87
    buffer_store_dwordx4 v[232:235], v10, s[12:15], s23 offen offset:0 sc1
    v_pk_add_f32 v[88:89], v[88:89], v[26:27] op_sel:[0,1] op_sel_hi:[1,1]
    v_pk_add_f32 v[90:91], v[90:91], v[26:27] op_sel:[0,1] op_sel_hi:[1,1]
    v_pk_add_f32 v[92:93], v[92:93], v[26:27] op_sel:[0,1] op_sel_hi:[1,1]
    v_pk_add_f32 v[94:95], v[94:95], v[26:27] op_sel:[0,1] op_sel_hi:[1,1]
    v_cvt_pk_bf16_f32 v236, v88, v89
    v_cvt_pk_bf16_f32 v237, v90, v91
    v_cvt_pk_bf16_f32 v238, v92, v93
    v_cvt_pk_bf16_f32 v239, v94, v95
    buffer_store_dwordx4 v[236:239], v10, s[12:15], s23 offen offset:256 sc1
    s_add_u32 s23, s23, 57344
    v_pk_add_f32 v[96:97], v[96:97], v[28:29] op_sel_hi:[1,0]
    v_pk_add_f32 v[98:99], v[98:99], v[28:29] op_sel_hi:[1,0]
    v_pk_add_f32 v[100:101], v[100:101], v[28:29] op_sel_hi:[1,0]
    v_pk_add_f32 v[102:103], v[102:103], v[28:29] op_sel_hi:[1,0]
    v_cvt_pk_bf16_f32 v240, v96, v97
    v_cvt_pk_bf16_f32 v241, v98, v99
    v_cvt_pk_bf16_f32 v242, v100, v101
    v_cvt_pk_bf16_f32 v243, v102, v103
    buffer_store_dwordx4 v[240:243], v10, s[12:15], s23 offen offset:0 sc1
    v_pk_add_f32 v[104:105], v[104:105], v[28:29] op_sel:[0,1] op_sel_hi:[1,1]
    v_pk_add_f32 v[106:107], v[106:107], v[28:29] op_sel:[0,1] op_sel_hi:[1,1]
    v_pk_add_f32 v[108:109], v[108:109], v[28:29] op_sel:[0,1] op_sel_hi:[1,1]
    v_pk_add_f32 v[110:111], v[110:111], v[28:29] op_sel:[0,1] op_sel_hi:[1,1]
    v_cvt_pk_bf16_f32 v244, v104, v105
    v_cvt_pk_bf16_f32 v245, v106, v107
    v_cvt_pk_bf16_f32 v246, v108, v109
    v_cvt_pk_bf16_f32 v247, v110, v111
    buffer_store_dwordx4 v[244:247], v10, s[12:15], s23 offen offset:256 sc1
    s_add_u32 s23, s23, 57344
    v_pk_add_f32 v[112:113], v[112:113], v[30:31] op_sel_hi:[1,0]
    v_pk_add_f32 v[114:115], v[114:115], v[30:31] op_sel_hi:[1,0]
    v_pk_add_f32 v[116:117], v[116:117], v[30:31] op_sel_hi:[1,0]
    v_pk_add_f32 v[118:119], v[118:119], v[30:31] op_sel_hi:[1,0]
    v_cvt_pk_bf16_f32 v248, v112, v113
    v_cvt_pk_bf16_f32 v249, v114, v115
    v_cvt_pk_bf16_f32 v250, v116, v117
    v_cvt_pk_bf16_f32 v251, v118, v119
    buffer_store_dwordx4 v[248:251], v10, s[12:15], s23 offen offset:0 sc1
    v_pk_add_f32 v[120:121], v[120:121], v[30:31] op_sel:[0,1] op_sel_hi:[1,1]
    v_pk_add_f32 v[122:123], v[122:123], v[30:31] op_sel:[0,1] op_sel_hi:[1,1]
    v_pk_add_f32 v[124:125], v[124:125], v[30:31] op_sel:[0,1] op_sel_hi:[1,1]
    v_pk_add_f32 v[126:127], v[126:127], v[30:31] op_sel:[0,1] op_sel_hi:[1,1]
    v_cvt_pk_bf16_f32 v252, v120, v121
    v_cvt_pk_bf16_f32 v253, v122, v123
    v_cvt_pk_bf16_f32 v254, v124, v125
    v_cvt_pk_bf16_f32 v255, v126, v127
    buffer_store_dwordx4 v[252:255], v10, s[12:15], s23 offen offset:256 sc1
    s_add_u32 s23, s23, 57344
    s_barrier
    s_waitcnt vmcnt(0)
    v_mov_b32 v4, s28
    v_mov_b32 v5, 0
    s_mov_b64 exec, 1
    buffer_store_dword v4, v5, s[12:15], s34 offen sc1
    s_mov_b64 exec, -1
L_kjoin:
    s_mul_i32 s23, s19, 16
    s_add_u32 s23, s23, s62
    s_lshl_b32 s23, s23, 7
    s_add_u32 s23, s23, 0x16a0000
    s_waitcnt vmcnt(0)
    s_barrier
    s_cmp_lg_u32 s16, 0
    s_cbranch_scc1 L_of10
    v_mov_b32 v4, s28
    v_mov_b32 v5, 0
    s_mov_b64 exec, 1
    buffer_store_dword v4, v5, s[12:15], s23 offen sc1
    s_mov_b64 exec, -1
L_of10:
L_upoll:
    s_cmp_lg_u32 s16, 0
    s_cbranch_scc1 L_up_w
    s_lshl_b32 s26, s19, 11
    s_add_u32 s26, s26, 0x16a0000
    v_and_b32 v6, 15, v1
    v_and_b32 v7, 7, v1
    v_add_u32 v8, -1, v6
    v_cmp_eq_u32 vcc, 7, v7
    s_nop 1
    v_cndmask_b32 v6, v6, v8, vcc
    v_lshlrev_b32 v6, 7, v6
    s_cmp_lg_u32 s20, 7
    s_cbranch_scc1 L_p3_pn
L_poll11:
    buffer_load_dword v7, v6, s[12:15], s26 offen sc1
    s_add_u32 s33, s33, 1
    s_waitcnt vmcnt(0)
    v_cmp_eq_u32 vcc, s28, v7
    s_cmp_gt_u32 s33, 262144
    s_cbranch_scc1 L_poll11_d
    s_cbranch_vccnz L_poll11_d
    s_sleep 16
    s_branch L_poll11
L_poll11_d:
L_p3_pn:
    s_sleep 8
L_poll12:
    buffer_load_dword v7, v6, s[12:15], s26 offen sc1
    s_add_u32 s33, s33, 1
    s_waitcnt vmcnt(0)
    v_cmp_ne_u32 vcc, s28, v7
    s_cmp_gt_u32 s33, 262144
    s_cbranch_scc1 L_poll12_d
    s_cbranch_vccz L_poll12_d
    s_sleep 1
    s_branch L_poll12
L_poll12_d:
L_up_w:
    s_barrier
    s_barrier
    s_endpgm
L_misc:
    s_waitcnt lgkmcnt(0)
    s_mov_b32 s12, s58
    s_mov_b32 s13, s59
    s_mov_b32 s14, 0x1800000
    s_mov_b32 s15, 0x20000
    s_add_u32 s60, s58, 0x16f0000
    s_addc_u32 s61, s59, 0
    s_load_dword s28, s[60:61], 0
    s_mov_b32 s4, s36
    s_mov_b32 s5, s37
    s_mov_b32 s6, 0x200000
    s_mov_b32 s8, s52
    s_mov_b32 s9, s53
    s_mov_b32 s10, 0x400
    v_lshlrev_b32 v2, 4, v1
    buffer_load_dwordx4 v[12:15], v2, s[8:11], 0 offen
    s_lshl_b32 s23, s19, 17
    s_lshl_b32 s34, s16, 14
    s_add_u32 s23, s23, s34
    buffer_load_dwordx4 v[16:19], v2, s[4:7], s23 offen offset:0
    buffer_load_dwordx4 v[20:23], v2, s[4:7], s23 offen offset:1024
    buffer_load_dwordx4 v[24:27], v2, s[4:7], s23 offen offset:2048
    buffer_load_dwordx4 v[28:31], v2, s[4:7], s23 offen offset:3072
    s_add_u32 s23, s23, 4096
    buffer_load_dwordx4 v[32:35], v2, s[4:7], s23 offen offset:0
    buffer_load_dwordx4 v[36:39], v2, s[4:7], s23 offen offset:1024
    buffer_load_dwordx4 v[40:43], v2, s[4:7], s23 offen offset:2048
    buffer_load_dwordx4 v[44:47], v2, s[4:7], s23 offen offset:3072
    s_add_u32 s23, s23, 4096
    buffer_load_dwordx4 v[48:51], v2, s[4:7], s23 offen offset:0
    buffer_load_dwordx4 v[52:55], v2, s[4:7], s23 offen offset:1024
    buffer_load_dwordx4 v[56:59], v2, s[4:7], s23 offen offset:2048
    buffer_load_dwordx4 v[60:63], v2, s[4:7], s23 offen offset:3072
    s_add_u32 s23, s23, 4096
    buffer_load_dwordx4 v[64:67], v2, s[4:7], s23 offen offset:0
    buffer_load_dwordx4 v[68:71], v2, s[4:7], s23 offen offset:1024
    buffer_load_dwordx4 v[72:75], v2, s[4:7], s23 offen offset:2048
    buffer_load_dwordx4 v[76:79], v2, s[4:7], s23 offen offset:3072
    s_waitcnt lgkmcnt(0)
    s_add_u32 s28, s28, 0x9e3779b9
    s_waitcnt vmcnt(0)
    v_dot2_f32_bf16 v96, v16, v12, 0
    v_dot2_f32_bf16 v97, v20, v12, 0
    v_dot2_f32_bf16 v98, v24, v12, 0
    v_dot2_f32_bf16 v99, v28, v12, 0
    v_dot2_f32_bf16 v100, v32, v12, 0
    v_dot2_f32_bf16 v101, v36, v12, 0
    v_dot2_f32_bf16 v102, v40, v12, 0
    v_dot2_f32_bf16 v103, v44, v12, 0
    v_dot2_f32_bf16 v104, v48, v12, 0
    v_dot2_f32_bf16 v105, v52, v12, 0
    v_dot2_f32_bf16 v106, v56, v12, 0
    v_dot2_f32_bf16 v107, v60, v12, 0
    v_dot2_f32_bf16 v108, v64, v12, 0
    v_dot2_f32_bf16 v109, v68, v12, 0
    v_dot2_f32_bf16 v110, v72, v12, 0
    v_dot2_f32_bf16 v111, v76, v12, 0
    v_dot2_f32_bf16 v96, v17, v13, v96
    v_dot2_f32_bf16 v97, v21, v13, v97
    v_dot2_f32_bf16 v98, v25, v13, v98
    v_dot2_f32_bf16 v99, v29, v13, v99
    v_dot2_f32_bf16 v100, v33, v13, v100
    v_dot2_f32_bf16 v101, v37, v13, v101
    v_dot2_f32_bf16 v102, v41, v13, v102
    v_dot2_f32_bf16 v103, v45, v13, v103
    v_dot2_f32_bf16 v104, v49, v13, v104
    v_dot2_f32_bf16 v105, v53, v13, v105
    v_dot2_f32_bf16 v106, v57, v13, v106
    v_dot2_f32_bf16 v107, v61, v13, v107
    v_dot2_f32_bf16 v108, v65, v13, v108
    v_dot2_f32_bf16 v109, v69, v13, v109
    v_dot2_f32_bf16 v110, v73, v13, v110
    v_dot2_f32_bf16 v111, v77, v13, v111
    v_dot2_f32_bf16 v96, v18, v14, v96
    v_dot2_f32_bf16 v97, v22, v14, v97
    v_dot2_f32_bf16 v98, v26, v14, v98
    v_dot2_f32_bf16 v99, v30, v14, v99
    v_dot2_f32_bf16 v100, v34, v14, v100
    v_dot2_f32_bf16 v101, v38, v14, v101
    v_dot2_f32_bf16 v102, v42, v14, v102
    v_dot2_f32_bf16 v103, v46, v14, v103
    v_dot2_f32_bf16 v104, v50, v14, v104
    v_dot2_f32_bf16 v105, v54, v14, v105
    v_dot2_f32_bf16 v106, v58, v14, v106
    v_dot2_f32_bf16 v107, v62, v14, v107
    v_dot2_f32_bf16 v108, v66, v14, v108
    v_dot2_f32_bf16 v109, v70, v14, v109
    v_dot2_f32_bf16 v110, v74, v14, v110
    v_dot2_f32_bf16 v111, v78, v14, v111
    v_dot2_f32_bf16 v96, v19, v15, v96
    v_dot2_f32_bf16 v97, v23, v15, v97
    v_dot2_f32_bf16 v98, v27, v15, v98
    v_dot2_f32_bf16 v99, v31, v15, v99
    v_dot2_f32_bf16 v100, v35, v15, v100
    v_dot2_f32_bf16 v101, v39, v15, v101
    v_dot2_f32_bf16 v102, v43, v15, v102
    v_dot2_f32_bf16 v103, v47, v15, v103
    v_dot2_f32_bf16 v104, v51, v15, v104
    v_dot2_f32_bf16 v105, v55, v15, v105
    v_dot2_f32_bf16 v106, v59, v15, v106
    v_dot2_f32_bf16 v107, v63, v15, v107
    v_dot2_f32_bf16 v108, v67, v15, v108
    v_dot2_f32_bf16 v109, v71, v15, v109
    v_dot2_f32_bf16 v110, v75, v15, v110
    v_dot2_f32_bf16 v111, v79, v15, v111
    s_nop 2
    v_add_f32_dpp v96, v96, v96 row_shr:1 row_mask:0xf bank_mask:0xf
    v_add_f32_dpp v97, v97, v97 row_shr:1 row_mask:0xf bank_mask:0xf
    v_add_f32_dpp v98, v98, v98 row_shr:1 row_mask:0xf bank_mask:0xf
    v_add_f32_dpp v99, v99, v99 row_shr:1 row_mask:0xf bank_mask:0xf
    v_add_f32_dpp v100, v100, v100 row_shr:1 row_mask:0xf bank_mask:0xf
    v_add_f32_dpp v101, v101, v101 row_shr:1 row_mask:0xf bank_mask:0xf
    v_add_f32_dpp v102, v102, v102 row_shr:1 row_mask:0xf bank_mask:0xf
    v_add_f32_dpp v103, v103, v103 row_shr:1 row_mask:0xf bank_mask:0xf
    v_add_f32_dpp v104, v104, v104 row_shr:1 row_mask:0xf bank_mask:0xf
    v_add_f32_dpp v105, v105, v105 row_shr:1 row_mask:0xf bank_mask:0xf
    v_add_f32_dpp v106, v106, v106 row_shr:1 row_mask:0xf bank_mask:0xf
    v_add_f32_dpp v107, v107, v107 row_shr:1 row_mask:0xf bank_mask:0xf
    v_add_f32_dpp v108, v108, v108 row_shr:1 row_mask:0xf bank_mask:0xf
    v_add_f32_dpp v109, v109, v109 row_shr:1 row_mask:0xf bank_mask:0xf
    v_add_f32_dpp v110, v110, v110 row_shr:1 row_mask:0xf bank_mask:0xf
    v_add_f32_dpp v111, v111, v111 row_shr:1 row_mask:0xf bank_mask:0xf
    v_add_f32_dpp v96, v96, v96 row_shr:2 row_mask:0xf bank_mask:0xf
    v_add_f32_dpp v97, v97, v97 row_shr:2 row_mask:0xf bank_mask:0xf
    v_add_f32_dpp v98, v98, v98 row_shr:2 row_mask:0xf bank_mask:0xf
    v_add_f32_dpp v99, v99, v99 row_shr:2 row_mask:0xf bank_mask:0xf
    v_add_f32_dpp v100, v100, v100 row_shr:2 row_mask:0xf bank_mask:0xf
    v_add_f32_dpp v101, v101, v101 row_shr:2 row_mask:0xf bank_mask:0xf
    v_add_f32_dpp v102, v102, v102 row_shr:2 row_mask:0xf bank_mask:0xf
    v_add_f32_dpp v103, v103, v103 row_shr:2 row_mask:0xf bank_mask:0xf
    v_add_f32_dpp v104, v104, v104 row_shr:2 row_mask:0xf bank_mask:0xf
    v_add_f32_dpp v105, v105, v105 row_shr:2 row_mask:0xf bank_mask:0xf
    v_add_f32_dpp v106, v106, v106 row_shr:2 row_mask:0xf bank_mask:0xf
    v_add_f32_dpp v107, v107, v107 row_shr:2 row_mask:0xf bank_mask:0xf
    v_add_f32_dpp v108, v108, v108 row_shr:2 row_mask:0xf bank_mask:0xf
    v_add_f32_dpp v109, v109, v109 row_shr:2 row_mask:0xf bank_mask:0xf
    v_add_f32_dpp v110, v110, v110 row_shr:2 row_mask:0xf bank_mask:0xf
    v_add_f32_dpp v111, v111, v111 row_shr:2 row_mask:0xf bank_mask:0xf
    v_add_f32_dpp v96, v96, v96 row_shr:4 row_mask:0xf bank_mask:0xf
    v_add_f32_dpp v97, v97, v97 row_shr:4 row_mask:0xf bank_mask:0xf
    v_add_f32_dpp v98, v98, v98 row_shr:4 row_mask:0xf bank_mask:0xf
    v_add_f32_dpp v99, v99, v99 row_shr:4 row_mask:0xf bank_mask:0xf
    v_add_f32_dpp v100, v100, v100 row_shr:4 row_mask:0xf bank_mask:0xf
    v_add_f32_dpp v101, v101, v101 row_shr:4 row_mask:0xf bank_mask:0xf
    v_add_f32_dpp v102, v102, v102 row_shr:4 row_mask:0xf bank_mask:0xf
    v_add_f32_dpp v103, v103, v103 row_shr:4 row_mask:0xf bank_mask:0xf
    v_add_f32_dpp v104, v104, v104 row_shr:4 row_mask:0xf bank_mask:0xf
    v_add_f32_dpp v105, v105, v105 row_shr:4 row_mask:0xf bank_mask:0xf
    v_add_f32_dpp v106, v106, v106 row_shr:4 row_mask:0xf bank_mask:0xf
    v_add_f32_dpp v107, v107, v107 row_shr:4 row_mask:0xf bank_mask:0xf
    v_add_f32_dpp v108, v108, v108 row_shr:4 row_mask:0xf bank_mask:0xf
    v_add_f32_dpp v109, v109, v109 row_shr:4 row_mask:0xf bank_mask:0xf
    v_add_f32_dpp v110, v110, v110 row_shr:4 row_mask:0xf bank_mask:0xf
    v_add_f32_dpp v111, v111, v111 row_shr:4 row_mask:0xf bank_mask:0xf
    v_add_f32_dpp v96, v96, v96 row_shr:8 row_mask:0xf bank_mask:0xf
    v_add_f32_dpp v97, v97, v97 row_shr:8 row_mask:0xf bank_mask:0xf
    v_add_f32_dpp v98, v98, v98 row_shr:8 row_mask:0xf bank_mask:0xf
    v_add_f32_dpp v99, v99, v99 row_shr:8 row_mask:0xf bank_mask:0xf
    v_add_f32_dpp v100, v100, v100 row_shr:8 row_mask:0xf bank_mask:0xf
    v_add_f32_dpp v101, v101, v101 row_shr:8 row_mask:0xf bank_mask:0xf
    v_add_f32_dpp v102, v102, v102 row_shr:8 row_mask:0xf bank_mask:0xf
    v_add_f32_dpp v103, v103, v103 row_shr:8 row_mask:0xf bank_mask:0xf
    v_add_f32_dpp v104, v104, v104 row_shr:8 row_mask:0xf bank_mask:0xf
    v_add_f32_dpp v105, v105, v105 row_shr:8 row_mask:0xf bank_mask:0xf
    v_add_f32_dpp v106, v106, v106 row_shr:8 row_mask:0xf bank_mask:0xf
    v_add_f32_dpp v107, v107, v107 row_shr:8 row_mask:0xf bank_mask:0xf
    v_add_f32_dpp v108, v108, v108 row_shr:8 row_mask:0xf bank_mask:0xf
    v_add_f32_dpp v109, v109, v109 row_shr:8 row_mask:0xf bank_mask:0xf
    v_add_f32_dpp v110, v110, v110 row_shr:8 row_mask:0xf bank_mask:0xf
    v_add_f32_dpp v111, v111, v111 row_shr:8 row_mask:0xf bank_mask:0xf
    v_add_f32_dpp v96, v96, v96 row_bcast:15 row_mask:0xa bank_mask:0xf
    v_add_f32_dpp v97, v97, v97 row_bcast:15 row_mask:0xa bank_mask:0xf
    v_add_f32_dpp v98, v98, v98 row_bcast:15 row_mask:0xa bank_mask:0xf
    v_add_f32_dpp v99, v99, v99 row_bcast:15 row_mask:0xa bank_mask:0xf
    v_add_f32_dpp v100, v100, v100 row_bcast:15 row_mask:0xa bank_mask:0xf
    v_add_f32_dpp v101, v101, v101 row_bcast:15 row_mask:0xa bank_mask:0xf
    v_add_f32_dpp v102, v102, v102 row_bcast:15 row_mask:0xa bank_mask:0xf
    v_add_f32_dpp v103, v103, v103 row_bcast:15 row_mask:0xa bank_mask:0xf
    v_add_f32_dpp v104, v104, v104 row_bcast:15 row_mask:0xa bank_mask:0xf
    v_add_f32_dpp v105, v105, v105 row_bcast:15 row_mask:0xa bank_mask:0xf
    v_add_f32_dpp v106, v106, v106 row_bcast:15 row_mask:0xa bank_mask:0xf
    v_add_f32_dpp v107, v107, v107 row_bcast:15 row_mask:0xa bank_mask:0xf
    v_add_f32_dpp v108, v108, v108 row_bcast:15 row_mask:0xa bank_mask:0xf
    v_add_f32_dpp v109, v109, v109 row_bcast:15 row_mask:0xa bank_mask:0xf
    v_add_f32_dpp v110, v110, v110 row_bcast:15 row_mask:0xa bank_mask:0xf
    v_add_f32_dpp v111, v111, v111 row_bcast:15 row_mask:0xa bank_mask:0xf
    v_add_f32_dpp v96, v96, v96 row_bcast:31 row_mask:0xc bank_mask:0xf
    v_add_f32_dpp v97, v97, v97 row_bcast:31 row_mask:0xc bank_mask:0xf
    v_add_f32_dpp v98, v98, v98 row_bcast:31 row_mask:0xc bank_mask:0xf
    v_add_f32_dpp v99, v99, v99 row_bcast:31 row_mask:0xc bank_mask:0xf
    v_add_f32_dpp v100, v100, v100 row_bcast:31 row_mask:0xc bank_mask:0xf
    v_add_f32_dpp v101, v101, v101 row_bcast:31 row_mask:0xc bank_mask:0xf
    v_add_f32_dpp v102, v102, v102 row_bcast:31 row_mask:0xc bank_mask:0xf
    v_add_f32_dpp v103, v103, v103 row_bcast:31 row_mask:0xc bank_mask:0xf
    v_add_f32_dpp v104, v104, v104 row_bcast:31 row_mask:0xc bank_mask:0xf
    v_add_f32_dpp v105, v105, v105 row_bcast:31 row_mask:0xc bank_mask:0xf
    v_add_f32_dpp v106, v106, v106 row_bcast:31 row_mask:0xc bank_mask:0xf
    v_add_f32_dpp v107, v107, v107 row_bcast:31 row_mask:0xc bank_mask:0xf
    v_add_f32_dpp v108, v108, v108 row_bcast:31 row_mask:0xc bank_mask:0xf
    v_add_f32_dpp v109, v109, v109 row_bcast:31 row_mask:0xc bank_mask:0xf
    v_add_f32_dpp v110, v110, v110 row_bcast:31 row_mask:0xc bank_mask:0xf
    v_add_f32_dpp v111, v111, v111 row_bcast:31 row_mask:0xc bank_mask:0xf
    v_mov_b32 v8, 0
    v_readlane_b32 s34, v96, 63
    s_nop 3
    v_writelane_b32 v8, s34, 0
    v_readlane_b32 s34, v97, 63
    s_nop 3
    v_writelane_b32 v8, s34, 1
    v_readlane_b32 s34, v98, 63
    s_nop 3
    v_writelane_b32 v8, s34, 2
    v_readlane_b32 s34, v99, 63
    s_nop 3
    v_writelane_b32 v8, s34, 3
    v_readlane_b32 s34, v100, 63
    s_nop 3
    v_writelane_b32 v8, s34, 4
    v_readlane_b32 s34, v101, 63
    s_nop 3
    v_writelane_b32 v8, s34, 5
    v_readlane_b32 s34, v102, 63
    s_nop 3
    v_writelane_b32 v8, s34, 6
    v_readlane_b32 s34, v103, 63
    s_nop 3
    v_writelane_b32 v8, s34, 7
    v_readlane_b32 s34, v104, 63
    s_nop 3
    v_writelane_b32 v8, s34, 8
    v_readlane_b32 s34, v105, 63
    s_nop 3
    v_writelane_b32 v8, s34, 9
    v_readlane_b32 s34, v106, 63
    s_nop 3
    v_writelane_b32 v8, s34, 10
    v_readlane_b32 s34, v107, 63
    s_nop 3
    v_writelane_b32 v8, s34, 11
    v_readlane_b32 s34, v108, 63
    s_nop 3
    v_writelane_b32 v8, s34, 12
    v_readlane_b32 s34, v109, 63
    s_nop 3
    v_writelane_b32 v8, s34, 13
    v_readlane_b32 s34, v110, 63
    s_nop 3
    v_writelane_b32 v8, s34, 14
    v_readlane_b32 s34, v111, 63
    s_nop 3
    v_writelane_b32 v8, s34, 15
    v_mul_f32 v8, 0xbfb8aa3b, v8
    v_exp_f32 v8, v8
    s_nop 0
    v_add_f32 v8, 1.0, v8
    v_rcp_f32 v8, v8
    s_lshl_b32 s23, s19, 9
    s_lshl_b32 s34, s16, 6
    s_add_u32 s23, s23, s34
    s_add_u32 s23, s23, 0x1610000
    v_lshlrev_b32 v2, 2, v1
    s_mov_b64 exec, 0xffff
    buffer_store_dword v8, v2, s[12:15], s23 offen sc1
    s_mov_b64 exec, -1
    s_waitcnt vmcnt(0)
    s_barrier
    s_cmp_lg_u32 s16, 0
    s_cbranch_scc1 L_m_f
    s_lshl_b32 s23, s19, 7
    s_add_u32 s23, s23, 0x1683800
    v_mov_b32 v4, s28
    v_mov_b32 v5, 0
    s_mov_b64 exec, 1
    buffer_store_dword v4, v5, s[12:15], s23 offen sc1
    s_mov_b64 exec, -1
L_m_f:
    v_lshrrev_b32 v4, 3, v6
    v_lshlrev_b32 v2, 12, v4
    v_lshrrev_b32 v4, 4, v6
    v_xor_b32 v4, v4, v6
    v_and_b32 v4, 7, v4
    v_lshl_add_u32 v2, v4, 4, v2
    s_lshl_b32 s24, s19, 19
    s_lshl_b32 s23, s30, 11
    s_add_u32 s24, s24, s23
    s_mov_b32 s4, s46
    s_mov_b32 s5, s47
    s_mov_b32 s6, 0x800000
    s_mov_b32 s96, s40
    s_mov_b32 s97, s41
    s_mov_b32 s98, 0x80000
    v_lshrrev_b32 v4, 3, v1
    v_lshlrev_b32 v7, 10, v4
    v_bfe_u32 v4, v1, 4, 1
    v_lshlrev_b32 v4, 2, v4
    v_and_b32 v5, 7, v1
    v_xor_b32 v4, v4, v5
    v_lshl_add_u32 v7, v4, 4, v7
    s_lshl_b32 s23, s17, 15
    v_add_u32 v7, s23, v7
    v_mov_b32 v3, v7
    s_mov_b32 s8, s50
    s_mov_b32 s9, s51
    s_mov_b32 s10, 0xe0000
    s_lshl_b32 s23, s19, 8
    v_lshlrev_b32 v22, 2, v1
    v_add_u32 v70, s23, v22
    global_load_dword v70, v70, s[48:49]
    v_lshlrev_b32 v17, 4, v1
    v_add_u32 v14, s27, v17
    v_add_u32 v15, 65536, v14
    v_add_u32 v16, 131072, v14
    s_cmp_lt_u32 s16, 4
    s_cbranch_scc1 L_m_red
    v_lshrrev_b32 v19, 3, v6
    v_lshlrev_b32 v19, 12, v19
    v_and_b32 v9, 7, v6
    v_lshl_add_u32 v19, v9, 7, v19
    s_lshl_b32 s23, s19, 2
    s_and_b32 s34, s31, 3
    s_add_u32 s23, s23, s34
    s_lshl_b32 s23, s23, 17
    s_lshl_b32 s34, s30, 11
    s_add_u32 s23, s23, s34
    v_add_u32 v19, s23, v19
    global_load_dword v10, v19, s[46:47] offset:0
    s_mul_i32 s23, s2, 3584
    s_mul_i32 s34, s17, 896
    s_add_u32 s23, s23, s34
    v_lshlrev_b32 v9, 7, v1
    v_add_u32 v9, s23, v9
    s_mov_b64 exec, 0x7f
    global_load_dword v13, v9, s[50:51]
    s_lshl_b32 s23, s2, 11
    s_lshl_b32 s34, s17, 9
    s_add_u32 s23, s23, s34
    v_lshlrev_b32 v9, 7, v1
    v_add_u32 v9, s23, v9
    s_mov_b64 exec, 15
    global_load_dword v12, v9, s[40:41]
    s_mov_b64 exec, -1
    s_mul_i32 s34, s17, 98304
    s_lshl_b32 s23, s31, 7
    s_add_u32 s34, s34, s23
    s_lshl_b32 s23, s17, 12
    buffer_load_dwordx4 v[144:147], v7, s[96:99], s34 offen
    s_add_u32 s34, s34, 8192
    buffer_load_dwordx4 v[148:151], v7, s[96:99], s34 offen
    s_add_u32 s34, s34, 8192
    buffer_load_dwordx4 v[152:155], v7, s[96:99], s34 offen
    s_add_u32 s34, s34, 8192
    buffer_load_dwordx4 v[156:159], v7, s[96:99], s34 offen
    s_mul_i32 s34, s17, 98304
    s_lshl_b32 s23, s31, 7
    s_add_u32 s34, s34, s23
    s_add_u32 s34, s34, 32768
    s_lshl_b32 s23, s17, 12
    buffer_load_dwordx4 v[160:163], v7, s[96:99], s34 offen
    s_add_u32 s34, s34, 8192
    buffer_load_dwordx4 v[164:167], v7, s[96:99], s34 offen
    s_add_u32 s34, s34, 8192
    buffer_load_dwordx4 v[168:171], v7, s[96:99], s34 offen
    s_add_u32 s34, s34, 8192
    buffer_load_dwordx4 v[172:175], v7, s[96:99], s34 offen
    s_mul_i32 s34, s17, 98304
    s_lshl_b32 s23, s31, 7
    s_add_u32 s34, s34, s23
    s_add_u32 s34, s34, 65536
    s_lshl_b32 s23, s17, 12
    buffer_load_dwordx4 v[176:179], v7, s[96:99], s34 offen
    s_add_u32 s34, s34, 8192
    buffer_load_dwordx4 v[180:183], v7, s[96:99], s34 offen
    s_add_u32 s34, s34, 8192
    buffer_load_dwordx4 v[184:187], v7, s[96:99], s34 offen
    s_add_u32 s34, s34, 8192
    buffer_load_dwordx4 v[188:191], v7, s[96:99], s34 offen
    s_mul_i32 s34, s17, 98304
    s_lshl_b32 s23, s31, 7
    s_add_u32 s34, s34, s23
    s_add_u32 s34, s34, 98304
    s_lshl_b32 s23, s17, 12
    buffer_load_dwordx4 v[192:195], v7, s[96:99], s34 offen
    s_add_u32 s34, s34, 8192
    buffer_load_dwordx4 v[196:199], v7, s[96:99], s34 offen
    s_add_u32 s34, s34, 8192
    buffer_load_dwordx4 v[200:203], v7, s[96:99], s34 offen
    s_add_u32 s34, s34, 8192
    buffer_load_dwordx4 v[204:207], v7, s[96:99], s34 offen
    s_add_u32 s23, s31, 1
    s_cmp_ge_u32 s23, 7
    s_cselect_b32 s34, 7, 0
    s_sub_u32 s23, s23, s34
    s_lshl_b32 s34, s23, 17
    s_lshl_b32 s23, s31, 7
    s_add_u32 s34, s34, s23
    s_lshl_b32 s23, s17, 12
    s_add_u32 m0, s23, 147456
    s_nop 0
    buffer_load_dwordx4 v3, s[8:11], s34 offen lds
    s_add_u32 s34, s34, 8192
    s_add_u32 m0, s23, 148480
    s_nop 0
    buffer_load_dwordx4 v3, s[8:11], s34 offen lds
    s_add_u32 s34, s34, 8192
    s_add_u32 m0, s23, 149504
    s_nop 0
    buffer_load_dwordx4 v3, s[8:11], s34 offen lds
    s_add_u32 s34, s34, 8192
    s_add_u32 m0, s23, 150528
    s_nop 0
    buffer_load_dwordx4 v3, s[8:11], s34 offen lds
    s_add_u32 s23, s31, 2
    s_cmp_ge_u32 s23, 7
    s_cselect_b32 s34, 7, 0
    s_sub_u32 s23, s23, s34
    s_lshl_b32 s34, s23, 17
    s_lshl_b32 s23, s31, 7
    s_add_u32 s34, s34, s23
    s_lshl_b32 s23, s17, 12
    s_add_u32 m0, s23, 0
    s_nop 0
    buffer_load_dwordx4 v3, s[8:11], s34 offen lds
    s_add_u32 s34, s34, 8192
    s_add_u32 m0, s23, 1024
    s_nop 0
    buffer_load_dwordx4 v3, s[8:11], s34 offen lds
    s_add_u32 s34, s34, 8192
    s_add_u32 m0, s23, 2048
    s_nop 0
    buffer_load_dwordx4 v3, s[8:11], s34 offen lds
    s_add_u32 s34, s34, 8192
    s_add_u32 m0, s23, 3072
    s_nop 0
    buffer_load_dwordx4 v3, s[8:11], s34 offen lds
    s_add_u32 s23, s31, 3
    s_cmp_ge_u32 s23, 7
    s_cselect_b32 s34, 7, 0
    s_sub_u32 s23, s23, s34
    s_lshl_b32 s34, s23, 17
    s_lshl_b32 s23, s31, 7
    s_add_u32 s34, s34, s23
    s_lshl_b32 s23, s17, 12
    s_add_u32 m0, s23, 16384
    s_nop 0
    buffer_load_dwordx4 v3, s[8:11], s34 offen lds
    s_add_u32 s34, s34, 8192
    s_add_u32 m0, s23, 17408
    s_nop 0
    buffer_load_dwordx4 v3, s[8:11], s34 offen lds
    s_add_u32 s34, s34, 8192
    s_add_u32 m0, s23, 18432
    s_nop 0
    buffer_load_dwordx4 v3, s[8:11], s34 offen lds
    s_add_u32 s34, s34, 8192
    s_add_u32 m0, s23, 19456
    s_nop 0
    buffer_load_dwordx4 v3, s[8:11], s34 offen lds
    s_add_u32 s23, s31, 4
    s_cmp_ge_u32 s23, 7
    s_cselect_b32 s34, 7, 0
    s_sub_u32 s23, s23, s34
    s_lshl_b32 s34, s23, 17
    s_lshl_b32 s23, s31, 7
    s_add_u32 s34, s34, s23
    s_lshl_b32 s23, s17, 12
    s_add_u32 m0, s23, 32768
    s_nop 0
    buffer_load_dwordx4 v3, s[8:11], s34 offen lds
    s_add_u32 s34, s34, 8192
    s_add_u32 m0, s23, 33792
    s_nop 0
    buffer_load_dwordx4 v3, s[8:11], s34 offen lds
    s_add_u32 s34, s34, 8192
    s_add_u32 m0, s23, 34816
    s_nop 0
    buffer_load_dwordx4 v3, s[8:11], s34 offen lds
    s_add_u32 s34, s34, 8192
    s_add_u32 m0, s23, 35840
    s_nop 0
    buffer_load_dwordx4 v3, s[8:11], s34 offen lds
    s_add_u32 s23, s31, 5
    s_cmp_ge_u32 s23, 7
    s_cselect_b32 s34, 7, 0
    s_sub_u32 s23, s23, s34
    s_lshl_b32 s34, s23, 17
    s_lshl_b32 s23, s31, 7
    s_add_u32 s34, s34, s23
    s_lshl_b32 s23, s17, 12
    s_add_u32 m0, s23, 49152
    s_nop 0
    buffer_load_dwordx4 v3, s[8:11], s34 offen lds
    s_add_u32 s34, s34, 8192
    s_add_u32 m0, s23, 50176
    s_nop 0
    buffer_load_dwordx4 v3, s[8:11], s34 offen lds
    s_add_u32 s34, s34, 8192
    s_add_u32 m0, s23, 51200
    s_nop 0
    buffer_load_dwordx4 v3, s[8:11], s34 offen lds
    s_add_u32 s34, s34, 8192
    s_add_u32 m0, s23, 52224
    s_nop 0
    buffer_load_dwordx4 v3, s[8:11], s34 offen lds
    s_waitcnt vmcnt(20)
    v_lshrrev_b32 v28, 5, v1
    v_bfe_u32 v29, v1, 2, 2
    v_lshl_add_u32 v24, v28, 2, v29
    v_lshlrev_b32 v24, 7, v24
    v_bfe_u32 v28, v1, 3, 1
    v_lshl_add_u32 v24, v28, 6, v24
    v_bfe_u32 v28, v1, 4, 1
    v_lshl_add_u32 v24, v28, 5, v24
    v_and_b32 v28, 1, v1
    v_lshl_add_u32 v24, v28, 4, v24
    v_bfe_u32 v28, v1, 1, 1
    v_lshl_add_u32 v24, v28, 3, v24
    s_lshl_b32 s23, s17, 12
    s_add_u32 s23, s23, 98304
    v_add_u32 v24, s23, v24
    v_xor_b32 v25, 64, v24
    v_add_u32 v26, s23, v17
    ds_write_b128 v26, v[144:147] offset:0
    ds_write_b128 v26, v[148:151] offset:1024
    ds_write_b128 v26, v[152:155] offset:2048
    ds_write_b128 v26, v[156:159] offset:3072
    ds_read_b64_tr_b16 v[144:145], v24 offset:0
    ds_read_b64_tr_b16 v[146:147], v24 offset:2048
    ds_read_b64_tr_b16 v[148:149], v25 offset:0
    ds_read_b64_tr_b16 v[150:151], v25 offset:2048
    ds_read_b64_tr_b16 v[152:153], v24 offset:1024
    ds_read_b64_tr_b16 v[154:155], v24 offset:3072
    ds_read_b64_tr_b16 v[156:157], v25 offset:1024
    ds_read_b64_tr_b16 v[158:159], v25 offset:3072
    ds_write_b128 v26, v[160:163] offset:0
    ds_write_b128 v26, v[164:167] offset:1024
    ds_write_b128 v26, v[168:171] offset:2048
    ds_write_b128 v26, v[172:175] offset:3072
    ds_read_b64_tr_b16 v[160:161], v24 offset:0
    ds_read_b64_tr_b16 v[162:163], v24 offset:2048
    ds_read_b64_tr_b16 v[164:165], v25 offset:0
    ds_read_b64_tr_b16 v[166:167], v25 offset:2048
    ds_read_b64_tr_b16 v[168:169], v24 offset:1024
    ds_read_b64_tr_b16 v[170:171], v24 offset:3072
    ds_read_b64_tr_b16 v[172:173], v25 offset:1024
    ds_read_b64_tr_b16 v[174:175], v25 offset:3072
    ds_write_b128 v26, v[176:179] offset:0
    ds_write_b128 v26, v[180:183] offset:1024
    ds_write_b128 v26, v[184:187] offset:2048
    ds_write_b128 v26, v[188:191] offset:3072
    ds_read_b64_tr_b16 v[176:177], v24 offset:0
    ds_read_b64_tr_b16 v[178:179], v24 offset:2048
    ds_read_b64_tr_b16 v[180:181], v25 offset:0
    ds_read_b64_tr_b16 v[182:183], v25 offset:2048
    ds_read_b64_tr_b16 v[184:185], v24 offset:1024
    ds_read_b64_tr_b16 v[186:187], v24 offset:3072
    ds_read_b64_tr_b16 v[188:189], v25 offset:1024
    ds_read_b64_tr_b16 v[190:191], v25 offset:3072
    ds_write_b128 v26, v[192:195] offset:0
    ds_write_b128 v26, v[196:199] offset:1024
    ds_write_b128 v26, v[200:203] offset:2048
    ds_write_b128 v26, v[204:207] offset:3072
    ds_read_b64_tr_b16 v[192:193], v24 offset:0
    ds_read_b64_tr_b16 v[194:195], v24 offset:2048
    ds_read_b64_tr_b16 v[196:197], v25 offset:0
    ds_read_b64_tr_b16 v[198:199], v25 offset:2048
    ds_read_b64_tr_b16 v[200:201], v24 offset:1024
    ds_read_b64_tr_b16 v[202:203], v24 offset:3072
    ds_read_b64_tr_b16 v[204:205], v25 offset:1024
    ds_read_b64_tr_b16 v[206:207], v25 offset:3072
    s_waitcnt lgkmcnt(0)
    s_add_u32 s23, s31, 0
    s_cmp_ge_u32 s23, 7
    s_cselect_b32 s34, 7, 0
    s_sub_u32 s23, s23, s34
    s_lshl_b32 s34, s23, 17
    s_lshl_b32 s23, s31, 7
    s_add_u32 s34, s34, s23
    s_lshl_b32 s23, s17, 12
    s_add_u32 m0, s23, 131072
    s_nop 0
    buffer_load_dwordx4 v3, s[8:11], s34 offen lds
    s_add_u32 s34, s34, 8192
    s_add_u32 m0, s23, 132096
    s_nop 0
    buffer_load_dwordx4 v3, s[8:11], s34 offen lds
    s_add_u32 s34, s34, 8192
    s_add_u32 m0, s23, 133120
    s_nop 0
    buffer_load_dwordx4 v3, s[8:11], s34 offen lds
    s_add_u32 s34, s34, 8192
    s_add_u32 m0, s23, 134144
    s_nop 0
    buffer_load_dwordx4 v3, s[8:11], s34 offen lds
L_m_red:
    s_lshr_b32 s29, s19, 1
    s_lshl_b32 s29, s29, 4
    s_lshl_b32 s34, s17, 2
    s_add_u32 s29, s29, s34
    s_mul_i32 s29, s29, 4352
    s_add_u32 s29, s29, 0x1500000
    s_lshl_b32 s22, s19, 1
    s_add_u32 s22, s22, s18
    s_and_b32 s21, s22, 3
    s_lshl_b32 s34, s21, 10
    v_add_u32 v19, s34, v17
    s_lshl_b32 s34, s21, 6
    s_add_u32 s34, s34, 4096
    v_and_b32 v20, 48, v1
    v_add_u32 v20, s34, v20
    v_lshlrev_b32 v21, 5, v1
    s_lshl_b32 s21, s16, 11
    s_add_u32 s21, s21, 81920
    v_add_u32 v21, s21, v21
    s_waitcnt vmcnt(0)
    s_barrier
    v_and_b32 v22, 15, v1
    v_lshlrev_b32 v22, 7, v22
    s_lshr_b32 s34, s19, 1
    s_lshl_b32 s34, s34, 11
    s_add_u32 s34, s34, 0x1684000
    s_cmp_lg_u32 s16, 0
    s_cbranch_scc1 L_m_w
L_poll13:
    buffer_load_dword v23, v22, s[12:15], s34 offen sc1
    s_add_u32 s33, s33, 1
    s_waitcnt vmcnt(0)
    v_cmp_ne_u32 vcc, s28, v23
    s_cmp_gt_u32 s33, 262144
    s_cbranch_scc1 L_poll13_d
    s_cbranch_vccz L_poll13_d
    s_sleep 2
    s_branch L_poll13
L_poll13_d:
L_m_w:
    s_barrier
    buffer_load_dwordx4 v[32:35], v19, s[12:15], s29 offen sc1
    buffer_load_dwordx4 v[36:39], v20, s[12:15], s29 offen sc1
    s_add_u32 s29, s29, 4352
    buffer_load_dwordx4 v[40:43], v19, s[12:15], s29 offen sc1
    buffer_load_dwordx4 v[44:47], v20, s[12:15], s29 offen sc1
    s_add_u32 s29, s29, 4352
    buffer_load_dwordx4 v[48:51], v19, s[12:15], s29 offen sc1
    buffer_load_dwordx4 v[52:55], v20, s[12:15], s29 offen sc1
    s_add_u32 s29, s29, 4352
    buffer_load_dwordx4 v[56:59], v19, s[12:15], s29 offen sc1
    buffer_load_dwordx4 v[60:63], v20, s[12:15], s29 offen sc1
    s_add_u32 s29, s29, 4352
    s_waitcnt vmcnt(0)
    v_add_f32 v32, v32, v40
    v_add_f32 v48, v48, v56
    v_add_f32 v24, v32, v48
    v_add_f32 v33, v33, v41
    v_add_f32 v49, v49, v57
    v_add_f32 v25, v33, v49
    v_add_f32 v34, v34, v42
    v_add_f32 v50, v50, v58
    v_add_f32 v26, v34, v50
    v_add_f32 v35, v35, v43
    v_add_f32 v51, v51, v59
    v_add_f32 v27, v35, v51
    v_add_f32 v36, v36, v44
    v_add_f32 v52, v52, v60
    v_add_f32 v28, v36, v52
    v_add_f32 v37, v37, v45
    v_add_f32 v53, v53, v61
    v_add_f32 v29, v37, v53
    v_add_f32 v38, v38, v46
    v_add_f32 v54, v54, v62
    v_add_f32 v30, v38, v54
    v_add_f32 v39, v39, v47
    v_add_f32 v55, v55, v63
    v_add_f32 v31, v39, v55
    ds_write_b128 v21, v[24:27]
    ds_write_b128 v21, v[28:31] offset:16
    s_waitcnt lgkmcnt(0)
    s_barrier
    s_cmp_lg_u32 s17, 0
    s_cbranch_scc1 L_m_r2
    ds_read_b128 v[32:35], v21 offset:2048
    ds_read_b128 v[36:39], v21 offset:2064
    ds_read_b128 v[40:43], v21 offset:4096
    ds_read_b128 v[44:47], v21 offset:4112
    ds_read_b128 v[48:51], v21 offset:6144
    ds_read_b128 v[52:55], v21 offset:6160
    s_lshl_b32 s21, s22, 10
    s_add_u32 s21, s21, 0x15f0000
    s_waitcnt lgkmcnt(0)
    v_add_f32 v24, v24, v32
    v_add_f32 v40, v40, v48
    v_add_f32 v24, v24, v40
    v_add_f32 v25, v25, v33
    v_add_f32 v41, v41, v49
    v_add_f32 v25, v25, v41
    v_add_f32 v26, v26, v34
    v_add_f32 v42, v42, v50
    v_add_f32 v26, v26, v42
    v_add_f32 v27, v27, v35
    v_add_f32 v43, v43, v51
    v_add_f32 v27, v27, v43
    v_add_f32 v28, v28, v36
    v_add_f32 v44, v44, v52
    v_add_f32 v28, v28, v44
    v_add_f32 v29, v29, v37
    v_add_f32 v45, v45, v53
    v_add_f32 v29, v29, v45
    v_add_f32 v30, v30, v38
    v_add_f32 v46, v46, v54
    v_add_f32 v30, v30, v46
    v_add_f32 v31, v31, v39
    v_add_f32 v47, v47, v55
    v_add_f32 v31, v31, v47
    v_cvt_pk_bf16_f32 v56, v24, v25
    v_cvt_pk_bf16_f32 v57, v26, v27
    v_cvt_pk_bf16_f32 v58, v28, v29
    v_cvt_pk_bf16_f32 v59, v30, v31
    buffer_store_dwordx4 v[56:59], v17, s[12:15], s21 offen sc1
L_m_r2:
L_o:
    s_setprio 0
    v_and_b32 v4, 15, v1
    v_lshlrev_b32 v19, 2, v4
    v_lshrrev_b32 v5, 4, v1
    v_lshlrev_b32 v20, 9, v5
    v_lshl_add_u32 v20, v4, 4, v20
    v_mov_b32 v30, 0x358637bd
    v_mov_b32 v22, 0x3fb8aa3b
    v_mov_b32 v23, v22
    s_waitcnt vmcnt(0)
    s_barrier
    s_cmp_lt_u32 s16, 4
    s_cbranch_scc1 L_o_nw
    s_cmp_lg_u32 s30, 0
    s_cbranch_scc1 L_o_nw
    s_sleep 2
    s_mul_i32 s34, s17, 98304
    s_lshl_b32 s23, s31, 7
    s_add_u32 s34, s34, s23
    s_lshl_b32 s23, s17, 12
    buffer_load_dwordx4 v[144:147], v7, s[96:99], s34 offen
    s_add_u32 s34, s34, 8192
    buffer_load_dwordx4 v[148:151], v7, s[96:99], s34 offen
    s_add_u32 s34, s34, 8192
    buffer_load_dwordx4 v[152:155], v7, s[96:99], s34 offen
    s_add_u32 s34, s34, 8192
    buffer_load_dwordx4 v[156:159], v7, s[96:99], s34 offen
    s_mul_i32 s34, s17, 98304
    s_lshl_b32 s23, s31, 7
    s_add_u32 s34, s34, s23
    s_add_u32 s34, s34, 32768
    s_lshl_b32 s23, s17, 12
    buffer_load_dwordx4 v[160:163], v7, s[96:99], s34 offen
    s_add_u32 s34, s34, 8192
    buffer_load_dwordx4 v[164:167], v7, s[96:99], s34 offen
    s_add_u32 s34, s34, 8192
    buffer_load_dwordx4 v[168:171], v7, s[96:99], s34 offen
    s_add_u32 s34, s34, 8192
    buffer_load_dwordx4 v[172:175], v7, s[96:99], s34 offen
    s_mul_i32 s34, s17, 98304
    s_lshl_b32 s23, s31, 7
    s_add_u32 s34, s34, s23
    s_add_u32 s34, s34, 65536
    s_lshl_b32 s23, s17, 12
    buffer_load_dwordx4 v[176:179], v7, s[96:99], s34 offen
    s_add_u32 s34, s34, 8192
    buffer_load_dwordx4 v[180:183], v7, s[96:99], s34 offen
    s_add_u32 s34, s34, 8192
    buffer_load_dwordx4 v[184:187], v7, s[96:99], s34 offen
    s_add_u32 s34, s34, 8192
    buffer_load_dwordx4 v[188:191], v7, s[96:99], s34 offen
    s_mul_i32 s34, s17, 98304
    s_lshl_b32 s23, s31, 7
    s_add_u32 s34, s34, s23
    s_add_u32 s34, s34, 98304
    s_lshl_b32 s23, s17, 12
    buffer_load_dwordx4 v[192:195], v7, s[96:99], s34 offen
    s_add_u32 s34, s34, 8192
    buffer_load_dwordx4 v[196:199], v7, s[96:99], s34 offen
    s_add_u32 s34, s34, 8192
    buffer_load_dwordx4 v[200:203], v7, s[96:99], s34 offen
    s_add_u32 s34, s34, 8192
    buffer_load_dwordx4 v[204:207], v7, s[96:99], s34 offen
    s_add_u32 s23, s31, 1
    s_cmp_ge_u32 s23, 7
    s_cselect_b32 s34, 7, 0
    s_sub_u32 s23, s23, s34
    s_lshl_b32 s34, s23, 17
    s_lshl_b32 s23, s31, 7
    s_add_u32 s34, s34, s23
    s_lshl_b32 s23, s17, 12
    s_add_u32 m0, s23, 147456
    s_nop 0
    buffer_load_dwordx4 v3, s[8:11], s34 offen lds
    s_add_u32 s34, s34, 8192
    s_add_u32 m0, s23, 148480
    s_nop 0
    buffer_load_dwordx4 v3, s[8:11], s34 offen lds
    s_add_u32 s34, s34, 8192
    s_add_u32 m0, s23, 149504
    s_nop 0
    buffer_load_dwordx4 v3, s[8:11], s34 offen lds
    s_add_u32 s34, s34, 8192
    s_add_u32 m0, s23, 150528
    s_nop 0
    buffer_load_dwordx4 v3, s[8:11], s34 offen lds
    s_add_u32 s23, s31, 2
    s_cmp_ge_u32 s23, 7
    s_cselect_b32 s34, 7, 0
    s_sub_u32 s23, s23, s34
    s_lshl_b32 s34, s23, 17
    s_lshl_b32 s23, s31, 7
    s_add_u32 s34, s34, s23
    s_lshl_b32 s23, s17, 12
    s_add_u32 m0, s23, 0
    s_nop 0
    buffer_load_dwordx4 v3, s[8:11], s34 offen lds
    s_add_u32 s34, s34, 8192
    s_add_u32 m0, s23, 1024
    s_nop 0
    buffer_load_dwordx4 v3, s[8:11], s34 offen lds
    s_add_u32 s34, s34, 8192
    s_add_u32 m0, s23, 2048
    s_nop 0
    buffer_load_dwordx4 v3, s[8:11], s34 offen lds
    s_add_u32 s34, s34, 8192
    s_add_u32 m0, s23, 3072
    s_nop 0
    buffer_load_dwordx4 v3, s[8:11], s34 offen lds
    s_add_u32 s23, s31, 3
    s_cmp_ge_u32 s23, 7
    s_cselect_b32 s34, 7, 0
    s_sub_u32 s23, s23, s34
    s_lshl_b32 s34, s23, 17
    s_lshl_b32 s23, s31, 7
    s_add_u32 s34, s34, s23
    s_lshl_b32 s23, s17, 12
    s_add_u32 m0, s23, 16384
    s_nop 0
    buffer_load_dwordx4 v3, s[8:11], s34 offen lds
    s_add_u32 s34, s34, 8192
    s_add_u32 m0, s23, 17408
    s_nop 0
    buffer_load_dwordx4 v3, s[8:11], s34 offen lds
    s_add_u32 s34, s34, 8192
    s_add_u32 m0, s23, 18432
    s_nop 0
    buffer_load_dwordx4 v3, s[8:11], s34 offen lds
    s_add_u32 s34, s34, 8192
    s_add_u32 m0, s23, 19456
    s_nop 0
    buffer_load_dwordx4 v3, s[8:11], s34 offen lds
    s_add_u32 s23, s31, 4
    s_cmp_ge_u32 s23, 7
    s_cselect_b32 s34, 7, 0
    s_sub_u32 s23, s23, s34
    s_lshl_b32 s34, s23, 17
    s_lshl_b32 s23, s31, 7
    s_add_u32 s34, s34, s23
    s_lshl_b32 s23, s17, 12
    s_add_u32 m0, s23, 32768
    s_nop 0
    buffer_load_dwordx4 v3, s[8:11], s34 offen lds
    s_add_u32 s34, s34, 8192
    s_add_u32 m0, s23, 33792
    s_nop 0
    buffer_load_dwordx4 v3, s[8:11], s34 offen lds
    s_add_u32 s34, s34, 8192
    s_add_u32 m0, s23, 34816
    s_nop 0
    buffer_load_dwordx4 v3, s[8:11], s34 offen lds
    s_add_u32 s34, s34, 8192
    s_add_u32 m0, s23, 35840
    s_nop 0
    buffer_load_dwordx4 v3, s[8:11], s34 offen lds
    s_add_u32 s23, s31, 5
    s_cmp_ge_u32 s23, 7
    s_cselect_b32 s34, 7, 0
    s_sub_u32 s23, s23, s34
    s_lshl_b32 s34, s23, 17
    s_lshl_b32 s23, s31, 7
    s_add_u32 s34, s34, s23
    s_lshl_b32 s23, s17, 12
    s_add_u32 m0, s23, 49152
    s_nop 0
    buffer_load_dwordx4 v3, s[8:11], s34 offen lds
    s_add_u32 s34, s34, 8192
    s_add_u32 m0, s23, 50176
    s_nop 0
    buffer_load_dwordx4 v3, s[8:11], s34 offen lds
    s_add_u32 s34, s34, 8192
    s_add_u32 m0, s23, 51200
    s_nop 0
    buffer_load_dwordx4 v3, s[8:11], s34 offen lds
    s_add_u32 s34, s34, 8192
    s_add_u32 m0, s23, 52224
    s_nop 0
    buffer_load_dwordx4 v3, s[8:11], s34 offen lds
    s_waitcnt vmcnt(20)
    v_lshrrev_b32 v28, 5, v1
    v_bfe_u32 v29, v1, 2, 2
    v_lshl_add_u32 v24, v28, 2, v29
    v_lshlrev_b32 v24, 7, v24
    v_bfe_u32 v28, v1, 3, 1
    v_lshl_add_u32 v24, v28, 6, v24
    v_bfe_u32 v28, v1, 4, 1
    v_lshl_add_u32 v24, v28, 5, v24
    v_and_b32 v28, 1, v1
    v_lshl_add_u32 v24, v28, 4, v24
    v_bfe_u32 v28, v1, 1, 1
    v_lshl_add_u32 v24, v28, 3, v24
    s_lshl_b32 s23, s17, 12
    s_add_u32 s23, s23, 98304
    v_add_u32 v24, s23, v24
    v_xor_b32 v25, 64, v24
    v_add_u32 v26, s23, v17
    ds_write_b128 v26, v[144:147] offset:0
    ds_write_b128 v26, v[148:151] offset:1024
    ds_write_b128 v26, v[152:155] offset:2048
    ds_write_b128 v26, v[156:159] offset:3072
    ds_read_b64_tr_b16 v[144:145], v24 offset:0
    ds_read_b64_tr_b16 v[146:147], v24 offset:2048
    ds_read_b64_tr_b16 v[148:149], v25 offset:0
    ds_read_b64_tr_b16 v[150:151], v25 offset:2048
    ds_read_b64_tr_b16 v[152:153], v24 offset:1024
    ds_read_b64_tr_b16 v[154:155], v24 offset:3072
    ds_read_b64_tr_b16 v[156:157], v25 offset:1024
    ds_read_b64_tr_b16 v[158:159], v25 offset:3072
    ds_write_b128 v26, v[160:163] offset:0
    ds_write_b128 v26, v[164:167] offset:1024
    ds_write_b128 v26, v[168:171] offset:2048
    ds_write_b128 v26, v[172:175] offset:3072
    ds_read_b64_tr_b16 v[160:161], v24 offset:0
    ds_read_b64_tr_b16 v[162:163], v24 offset:2048
    ds_read_b64_tr_b16 v[164:165], v25 offset:0
    ds_read_b64_tr_b16 v[166:167], v25 offset:2048
    ds_read_b64_tr_b16 v[168:169], v24 offset:1024
    ds_read_b64_tr_b16 v[170:171], v24 offset:3072
    ds_read_b64_tr_b16 v[172:173], v25 offset:1024
    ds_read_b64_tr_b16 v[174:175], v25 offset:3072
    ds_write_b128 v26, v[176:179] offset:0
    ds_write_b128 v26, v[180:183] offset:1024
    ds_write_b128 v26, v[184:187] offset:2048
    ds_write_b128 v26, v[188:191] offset:3072
    ds_read_b64_tr_b16 v[176:177], v24 offset:0
    ds_read_b64_tr_b16 v[178:179], v24 offset:2048
    ds_read_b64_tr_b16 v[180:181], v25 offset:0
    ds_read_b64_tr_b16 v[182:183], v25 offset:2048
    ds_read_b64_tr_b16 v[184:185], v24 offset:1024
    ds_read_b64_tr_b16 v[186:187], v24 offset:3072
    ds_read_b64_tr_b16 v[188:189], v25 offset:1024
    ds_read_b64_tr_b16 v[190:191], v25 offset:3072
    ds_write_b128 v26, v[192:195] offset:0
    ds_write_b128 v26, v[196:199] offset:1024
    ds_write_b128 v26, v[200:203] offset:2048
    ds_write_b128 v26, v[204:207] offset:3072
    ds_read_b64_tr_b16 v[192:193], v24 offset:0
    ds_read_b64_tr_b16 v[194:195], v24 offset:2048
    ds_read_b64_tr_b16 v[196:197], v25 offset:0
    ds_read_b64_tr_b16 v[198:199], v25 offset:2048
    ds_read_b64_tr_b16 v[200:201], v24 offset:1024
    ds_read_b64_tr_b16 v[202:203], v24 offset:3072
    ds_read_b64_tr_b16 v[204:205], v25 offset:1024
    ds_read_b64_tr_b16 v[206:207], v25 offset:3072
    s_waitcnt lgkmcnt(0)
    s_add_u32 s23, s31, 0
    s_cmp_ge_u32 s23, 7
    s_cselect_b32 s34, 7, 0
    s_sub_u32 s23, s23, s34
    s_lshl_b32 s34, s23, 17
    s_lshl_b32 s23, s31, 7
    s_add_u32 s34, s34, s23
    s_lshl_b32 s23, s17, 12
    s_add_u32 m0, s23, 131072
    s_nop 0
    buffer_load_dwordx4 v3, s[8:11], s34 offen lds
    s_add_u32 s34, s34, 8192
    s_add_u32 m0, s23, 132096
    s_nop 0
    buffer_load_dwordx4 v3, s[8:11], s34 offen lds
    s_add_u32 s34, s34, 8192
    s_add_u32 m0, s23, 133120
    s_nop 0
    buffer_load_dwordx4 v3, s[8:11], s34 offen lds
    s_add_u32 s34, s34, 8192
    s_add_u32 m0, s23, 134144
    s_nop 0
    buffer_load_dwordx4 v3, s[8:11], s34 offen lds
L_o_nw:
    s_cmp_lg_u32 s16, 0
    s_cbranch_scc1 L_o_w
    s_mul_i32 s34, s63, 16
    s_add_u32 s34, s34, s19
    s_lshl_b32 s34, s34, 7
    s_add_u32 s34, s34, 0x1684000
    s_lshl_b32 s23, s19, 7
    s_add_u32 s23, s23, 0x1698000
    s_cmp_eq_u32 s30, 0
    s_cselect_b32 s34, s34, s23
    v_mov_b32 v4, s28
    v_mov_b32 v5, 0
    s_mov_b64 exec, 1
    buffer_store_dword v4, v5, s[12:15], s34 offen sc1
    s_mov_b64 exec, -1
    v_and_b32 v8, 7, v1
    v_lshlrev_b32 v8, 11, v8
    s_lshl_b32 s34, s19, 7
    s_add_u32 s34, s34, 0x1684000
L_poll14:
    buffer_load_dword v9, v8, s[12:15], s34 offen sc1
    s_add_u32 s33, s33, 1
    s_waitcnt vmcnt(0)
    v_cmp_ne_u32 vcc, s28, v9
    s_cmp_gt_u32 s33, 262144
    s_cbranch_scc1 L_poll14_d
    s_cbranch_vccz L_poll14_d
    s_sleep 4
    s_branch L_poll14
L_poll14_d:
L_o_w:
    s_barrier
    s_lshl_b32 s23, s32, 7
    s_add_u32 s23, s23, 0x1610000
    buffer_load_dword v18, v19, s[12:15], s23 offen sc1
    buffer_load_dword v21, v19, s[12:15], s23 offen offset:64 sc1
    s_lshl_b32 s23, s32, 15
    s_lshl_b32 s24, s17, 12
    s_add_u32 s23, s23, s24
    s_add_u32 s23, s23, 0x800000
    buffer_load_dwordx4 v[96:99], v17, s[12:15], s23 offen offset:0 sc1
    buffer_load_dwordx4 v[100:103], v17, s[12:15], s23 offen offset:1024 sc1
    buffer_load_dwordx4 v[104:107], v17, s[12:15], s23 offen offset:2048 sc1
    buffer_load_dwordx4 v[108:111], v17, s[12:15], s23 offen offset:3072 sc1
    s_add_u32 s23, s23, 16384
    buffer_load_dwordx4 v[112:115], v17, s[12:15], s23 offen offset:0 sc1
    buffer_load_dwordx4 v[116:119], v17, s[12:15], s23 offen offset:1024 sc1
    buffer_load_dwordx4 v[120:123], v17, s[12:15], s23 offen offset:2048 sc1
    buffer_load_dwordx4 v[124:127], v17, s[12:15], s23 offen offset:3072 sc1
    s_waitcnt vmcnt(4)
    v_lshlrev_b32 v32, 16, v96
    v_and_b32 v33, 0xffff0000, v96
    v_lshlrev_b32 v34, 16, v97
    v_and_b32 v35, 0xffff0000, v97
    v_lshlrev_b32 v36, 16, v98
    v_and_b32 v37, 0xffff0000, v98
    v_lshlrev_b32 v38, 16, v99
    v_and_b32 v39, 0xffff0000, v99
    v_lshlrev_b32 v40, 16, v100
    v_and_b32 v41, 0xffff0000, v100
    v_lshlrev_b32 v42, 16, v101
    v_and_b32 v43, 0xffff0000, v101
    v_lshlrev_b32 v44, 16, v102
    v_and_b32 v45, 0xffff0000, v102
    v_lshlrev_b32 v46, 16, v103
    v_and_b32 v47, 0xffff0000, v103
    v_lshlrev_b32 v48, 16, v104
    v_and_b32 v49, 0xffff0000, v104
    v_lshlrev_b32 v50, 16, v105
    v_and_b32 v51, 0xffff0000, v105
    v_lshlrev_b32 v52, 16, v106
    v_and_b32 v53, 0xffff0000, v106
    v_lshlrev_b32 v54, 16, v107
    v_and_b32 v55, 0xffff0000, v107
    v_lshlrev_b32 v56, 16, v108
    v_and_b32 v57, 0xffff0000, v108
    v_lshlrev_b32 v58, 16, v109
    v_and_b32 v59, 0xffff0000, v109
    v_lshlrev_b32 v60, 16, v110
    v_and_b32 v61, 0xffff0000, v110
    v_lshlrev_b32 v62, 16, v111
    v_and_b32 v63, 0xffff0000, v111
    v_pk_mul_f32 v[64:65], v[32:33], v[22:23]
    v_pk_mul_f32 v[66:67], v[34:35], v[22:23]
    v_pk_mul_f32 v[68:69], v[36:37], v[22:23]
    v_pk_mul_f32 v[70:71], v[38:39], v[22:23]
    v_exp_f32 v64, v64 clamp
    v_exp_f32 v65, v65 clamp
    v_exp_f32 v66, v66 clamp
    v_exp_f32 v67, v67 clamp
    v_exp_f32 v68, v68 clamp
    v_exp_f32 v69, v69 clamp
    v_exp_f32 v70, v70 clamp
    v_exp_f32 v71, v71 clamp
    v_max_f32 v32, v30, v32
    v_max_f32 v33, v30, v33
    v_max_f32 v34, v30, v34
    v_max_f32 v35, v30, v35
    v_max_f32 v36, v30, v36
    v_max_f32 v37, v30, v37
    v_max_f32 v38, v30, v38
    v_max_f32 v39, v30, v39
    v_pk_add_f32 v[32:33], v[32:33], v[64:65]
    v_pk_add_f32 v[34:35], v[34:35], v[66:67]
    v_pk_add_f32 v[36:37], v[36:37], v[68:69]
    v_pk_add_f32 v[38:39], v[38:39], v[70:71]
    v_pk_mul_f32 v[64:65], v[40:41], v[22:23]
    v_pk_mul_f32 v[66:67], v[42:43], v[22:23]
    v_pk_mul_f32 v[68:69], v[44:45], v[22:23]
    v_pk_mul_f32 v[70:71], v[46:47], v[22:23]
    v_exp_f32 v64, v64 clamp
    v_exp_f32 v65, v65 clamp
    v_exp_f32 v66, v66 clamp
    v_exp_f32 v67, v67 clamp
    v_exp_f32 v68, v68 clamp
    v_exp_f32 v69, v69 clamp
    v_exp_f32 v70, v70 clamp
    v_exp_f32 v71, v71 clamp
    v_max_f32 v40, v30, v40
    v_max_f32 v41, v30, v41
    v_max_f32 v42, v30, v42
    v_max_f32 v43, v30, v43
    v_max_f32 v44, v30, v44
    v_max_f32 v45, v30, v45
    v_max_f32 v46, v30, v46
    v_max_f32 v47, v30, v47
    v_pk_add_f32 v[40:41], v[40:41], v[64:65]
    v_pk_add_f32 v[42:43], v[42:43], v[66:67]
    v_pk_add_f32 v[44:45], v[44:45], v[68:69]
    v_pk_add_f32 v[46:47], v[46:47], v[70:71]
    v_pk_mul_f32 v[64:65], v[48:49], v[22:23]
    v_pk_mul_f32 v[66:67], v[50:51], v[22:23]
    v_pk_mul_f32 v[68:69], v[52:53], v[22:23]
    v_pk_mul_f32 v[70:71], v[54:55], v[22:23]
    v_exp_f32 v64, v64 clamp
    v_exp_f32 v65, v65 clamp
    v_exp_f32 v66, v66 clamp
    v_exp_f32 v67, v67 clamp
    v_exp_f32 v68, v68 clamp
    v_exp_f32 v69, v69 clamp
    v_exp_f32 v70, v70 clamp
    v_exp_f32 v71, v71 clamp
    v_max_f32 v48, v30, v48
    v_max_f32 v49, v30, v49
    v_max_f32 v50, v30, v50
    v_max_f32 v51, v30, v51
    v_max_f32 v52, v30, v52
    v_max_f32 v53, v30, v53
    v_max_f32 v54, v30, v54
    v_max_f32 v55, v30, v55
    v_pk_add_f32 v[48:49], v[48:49], v[64:65]
    v_pk_add_f32 v[50:51], v[50:51], v[66:67]
    v_pk_add_f32 v[52:53], v[52:53], v[68:69]
    v_pk_add_f32 v[54:55], v[54:55], v[70:71]
    v_pk_mul_f32 v[64:65], v[56:57], v[22:23]
    v_pk_mul_f32 v[66:67], v[58:59], v[22:23]
    v_pk_mul_f32 v[68:69], v[60:61], v[22:23]
    v_pk_mul_f32 v[70:71], v[62:63], v[22:23]
    v_exp_f32 v64, v64 clamp
    v_exp_f32 v65, v65 clamp
    v_exp_f32 v66, v66 clamp
    v_exp_f32 v67, v67 clamp
    v_exp_f32 v68, v68 clamp
    v_exp_f32 v69, v69 clamp
    v_exp_f32 v70, v70 clamp
    v_exp_f32 v71, v71 clamp
    v_max_f32 v56, v30, v56
    v_max_f32 v57, v30, v57
    v_max_f32 v58, v30, v58
    v_max_f32 v59, v30, v59
    v_max_f32 v60, v30, v60
    v_max_f32 v61, v30, v61
    v_max_f32 v62, v30, v62
    v_max_f32 v63, v30, v63
    v_pk_add_f32 v[56:57], v[56:57], v[64:65]
    v_pk_add_f32 v[58:59], v[58:59], v[66:67]
    v_pk_add_f32 v[60:61], v[60:61], v[68:69]
    v_pk_add_f32 v[62:63], v[62:63], v[70:71]
    v_cvt_pk_bf16_f32 v96, v32, v33
    v_cvt_pk_bf16_f32 v97, v34, v35
    v_cvt_pk_bf16_f32 v98, v36, v37
    v_cvt_pk_bf16_f32 v99, v38, v39
    v_cvt_pk_bf16_f32 v100, v40, v41
    v_cvt_pk_bf16_f32 v101, v42, v43
    v_cvt_pk_bf16_f32 v102, v44, v45
    v_cvt_pk_bf16_f32 v103, v46, v47
    v_cvt_pk_bf16_f32 v104, v48, v49
    v_cvt_pk_bf16_f32 v105, v50, v51
    v_cvt_pk_bf16_f32 v106, v52, v53
    v_cvt_pk_bf16_f32 v107, v54, v55
    v_cvt_pk_bf16_f32 v108, v56, v57
    v_cvt_pk_bf16_f32 v109, v58, v59
    v_cvt_pk_bf16_f32 v110, v60, v61
    v_cvt_pk_bf16_f32 v111, v62, v63
    s_waitcnt vmcnt(0)
    v_lshlrev_b32 v32, 16, v112
    v_and_b32 v33, 0xffff0000, v112
    v_lshlrev_b32 v34, 16, v113
    v_and_b32 v35, 0xffff0000, v113
    v_lshlrev_b32 v36, 16, v114
    v_and_b32 v37, 0xffff0000, v114
    v_lshlrev_b32 v38, 16, v115
    v_and_b32 v39, 0xffff0000, v115
    v_lshlrev_b32 v40, 16, v116
    v_and_b32 v41, 0xffff0000, v116
    v_lshlrev_b32 v42, 16, v117
    v_and_b32 v43, 0xffff0000, v117
    v_lshlrev_b32 v44, 16, v118
    v_and_b32 v45, 0xffff0000, v118
    v_lshlrev_b32 v46, 16, v119
    v_and_b32 v47, 0xffff0000, v119
    v_lshlrev_b32 v48, 16, v120
    v_and_b32 v49, 0xffff0000, v120
    v_lshlrev_b32 v50, 16, v121
    v_and_b32 v51, 0xffff0000, v121
    v_lshlrev_b32 v52, 16, v122
    v_and_b32 v53, 0xffff0000, v122
    v_lshlrev_b32 v54, 16, v123
    v_and_b32 v55, 0xffff0000, v123
    v_lshlrev_b32 v56, 16, v124
    v_and_b32 v57, 0xffff0000, v124
    v_lshlrev_b32 v58, 16, v125
    v_and_b32 v59, 0xffff0000, v125
    v_lshlrev_b32 v60, 16, v126
    v_and_b32 v61, 0xffff0000, v126
    v_lshlrev_b32 v62, 16, v127
    v_and_b32 v63, 0xffff0000, v127
    v_pk_mul_f32 v[64:65], v[32:33], v[22:23]
    v_pk_mul_f32 v[66:67], v[34:35], v[22:23]
    v_pk_mul_f32 v[68:69], v[36:37], v[22:23]
    v_pk_mul_f32 v[70:71], v[38:39], v[22:23]
    v_exp_f32 v64, v64 clamp
    v_exp_f32 v65, v65 clamp
    v_exp_f32 v66, v66 clamp
    v_exp_f32 v67, v67 clamp
    v_exp_f32 v68, v68 clamp
    v_exp_f32 v69, v69 clamp
    v_exp_f32 v70, v70 clamp
    v_exp_f32 v71, v71 clamp
    v_max_f32 v32, v30, v32
    v_max_f32 v33, v30, v33
    v_max_f32 v34, v30, v34
    v_max_f32 v35, v30, v35
    v_max_f32 v36, v30, v36
    v_max_f32 v37, v30, v37
    v_max_f32 v38, v30, v38
    v_max_f32 v39, v30, v39
    v_pk_add_f32 v[32:33], v[32:33], v[64:65]
    v_pk_add_f32 v[34:35], v[34:35], v[66:67]
    v_pk_add_f32 v[36:37], v[36:37], v[68:69]
    v_pk_add_f32 v[38:39], v[38:39], v[70:71]
    v_pk_mul_f32 v[64:65], v[40:41], v[22:23]
    v_pk_mul_f32 v[66:67], v[42:43], v[22:23]
    v_pk_mul_f32 v[68:69], v[44:45], v[22:23]
    v_pk_mul_f32 v[70:71], v[46:47], v[22:23]
    v_exp_f32 v64, v64 clamp
    v_exp_f32 v65, v65 clamp
    v_exp_f32 v66, v66 clamp
    v_exp_f32 v67, v67 clamp
    v_exp_f32 v68, v68 clamp
    v_exp_f32 v69, v69 clamp
    v_exp_f32 v70, v70 clamp
    v_exp_f32 v71, v71 clamp
    v_max_f32 v40, v30, v40
    v_max_f32 v41, v30, v41
    v_max_f32 v42, v30, v42
    v_max_f32 v43, v30, v43
    v_max_f32 v44, v30, v44
    v_max_f32 v45, v30, v45
    v_max_f32 v46, v30, v46
    v_max_f32 v47, v30, v47
    v_pk_add_f32 v[40:41], v[40:41], v[64:65]
    v_pk_add_f32 v[42:43], v[42:43], v[66:67]
    v_pk_add_f32 v[44:45], v[44:45], v[68:69]
    v_pk_add_f32 v[46:47], v[46:47], v[70:71]
    v_pk_mul_f32 v[64:65], v[48:49], v[22:23]
    v_pk_mul_f32 v[66:67], v[50:51], v[22:23]
    v_pk_mul_f32 v[68:69], v[52:53], v[22:23]
    v_pk_mul_f32 v[70:71], v[54:55], v[22:23]
    v_exp_f32 v64, v64 clamp
    v_exp_f32 v65, v65 clamp
    v_exp_f32 v66, v66 clamp
    v_exp_f32 v67, v67 clamp
    v_exp_f32 v68, v68 clamp
    v_exp_f32 v69, v69 clamp
    v_exp_f32 v70, v70 clamp
    v_exp_f32 v71, v71 clamp
    v_max_f32 v48, v30, v48
    v_max_f32 v49, v30, v49
    v_max_f32 v50, v30, v50
    v_max_f32 v51, v30, v51
    v_max_f32 v52, v30, v52
    v_max_f32 v53, v30, v53
    v_max_f32 v54, v30, v54
    v_max_f32 v55, v30, v55
    v_pk_add_f32 v[48:49], v[48:49], v[64:65]
    v_pk_add_f32 v[50:51], v[50:51], v[66:67]
    v_pk_add_f32 v[52:53], v[52:53], v[68:69]
    v_pk_add_f32 v[54:55], v[54:55], v[70:71]
    v_pk_mul_f32 v[64:65], v[56:57], v[22:23]
    v_pk_mul_f32 v[66:67], v[58:59], v[22:23]
    v_pk_mul_f32 v[68:69], v[60:61], v[22:23]
    v_pk_mul_f32 v[70:71], v[62:63], v[22:23]
    v_exp_f32 v64, v64 clamp
    v_exp_f32 v65, v65 clamp
    v_exp_f32 v66, v66 clamp
    v_exp_f32 v67, v67 clamp
    v_exp_f32 v68, v68 clamp
    v_exp_f32 v69, v69 clamp
    v_exp_f32 v70, v70 clamp
    v_exp_f32 v71, v71 clamp
    v_max_f32 v56, v30, v56
    v_max_f32 v57, v30, v57
    v_max_f32 v58, v30, v58
    v_max_f32 v59, v30, v59
    v_max_f32 v60, v30, v60
    v_max_f32 v61, v30, v61
    v_max_f32 v62, v30, v62
    v_max_f32 v63, v30, v63
    v_pk_add_f32 v[56:57], v[56:57], v[64:65]
    v_pk_add_f32 v[58:59], v[58:59], v[66:67]
    v_pk_add_f32 v[60:61], v[60:61], v[68:69]
    v_pk_add_f32 v[62:63], v[62:63], v[70:71]
    v_cvt_pk_bf16_f32 v112, v32, v33
    v_cvt_pk_bf16_f32 v113, v34, v35
    v_cvt_pk_bf16_f32 v114, v36, v37
    v_cvt_pk_bf16_f32 v115, v38, v39
    v_cvt_pk_bf16_f32 v116, v40, v41
    v_cvt_pk_bf16_f32 v117, v42, v43
    v_cvt_pk_bf16_f32 v118, v44, v45
    v_cvt_pk_bf16_f32 v119, v46, v47
    v_cvt_pk_bf16_f32 v120, v48, v49
    v_cvt_pk_bf16_f32 v121, v50, v51
    v_cvt_pk_bf16_f32 v122, v52, v53
    v_cvt_pk_bf16_f32 v123, v54, v55
    v_cvt_pk_bf16_f32 v124, v56, v57
    v_cvt_pk_bf16_f32 v125, v58, v59
    v_cvt_pk_bf16_f32 v126, v60, v61
    v_cvt_pk_bf16_f32 v127, v62, v63
    s_cmp_lg_u32 s16, 0
    s_cbranch_scc1 L_o_w2
    v_and_b32 v8, 15, v1
    v_lshlrev_b32 v8, 7, v8
    s_mov_b32 s34, 0x1698000
L_poll15:
    buffer_load_dword v9, v8, s[12:15], s34 offen sc1
    s_add_u32 s33, s33, 1
    s_waitcnt vmcnt(0)
    v_cmp_ne_u32 vcc, s28, v9
    s_cmp_gt_u32 s33, 262144
    s_cbranch_scc1 L_poll15_d
    s_cbranch_vccz L_poll15_d
    s_sleep 4
    s_branch L_poll15
L_poll15_d:
L_o_w2:
    s_barrier
    s_lshl_b32 s23, s17, 13
    s_add_u32 s23, s23, 0x15f0000
    buffer_load_dwordx4 v[32:35], v17, s[12:15], s23 offen offset:0 sc1
    buffer_load_dwordx4 v[36:39], v17, s[12:15], s23 offen offset:1024 sc1
    buffer_load_dwordx4 v[40:43], v17, s[12:15], s23 offen offset:2048 sc1
    buffer_load_dwordx4 v[44:47], v17, s[12:15], s23 offen offset:3072 sc1
    s_add_u32 s23, s23, 4096
    buffer_load_dwordx4 v[48:51], v17, s[12:15], s23 offen offset:0 sc1
    buffer_load_dwordx4 v[52:55], v17, s[12:15], s23 offen offset:1024 sc1
    buffer_load_dwordx4 v[56:59], v17, s[12:15], s23 offen offset:2048 sc1
    buffer_load_dwordx4 v[60:63], v17, s[12:15], s23 offen offset:3072 sc1
    s_lshl_b32 s23, s32, 15
    s_lshl_b32 s24, s17, 13
    s_add_u32 s23, s23, s24
    s_add_u32 s23, s23, 0x1200000
    s_add_u32 s24, s23, 4096
    s_waitcnt vmcnt(0)
    v_mfma_f32_16x16x16_bf16 v[64:67], v[32:33], v[96:97], 0
    v_mfma_f32_16x16x16_bf16 v[72:75], v[34:35], v[96:97], 0
    v_mfma_f32_16x16x16_bf16 v[68:71], v[36:37], v[98:99], 0
    v_mfma_f32_16x16x16_bf16 v[76:79], v[38:39], v[98:99], 0
    v_mfma_f32_16x16x16_bf16 v[80:83], v[40:41], v[100:101], 0
    v_mfma_f32_16x16x16_bf16 v[88:91], v[42:43], v[100:101], 0
    v_mfma_f32_16x16x16_bf16 v[84:87], v[44:45], v[102:103], 0
    v_mfma_f32_16x16x16_bf16 v[92:95], v[46:47], v[102:103], 0
    v_mfma_f32_16x16x16_bf16 v[128:131], v[48:49], v[104:105], 0
    v_mfma_f32_16x16x16_bf16 v[136:139], v[50:51], v[104:105], 0
    v_mfma_f32_16x16x16_bf16 v[132:135], v[52:53], v[106:107], 0
    v_mfma_f32_16x16x16_bf16 v[140:143], v[54:55], v[106:107], 0
    v_mfma_f32_16x16x16_bf16 v[208:211], v[56:57], v[108:109], 0
    v_mfma_f32_16x16x16_bf16 v[216:219], v[58:59], v[108:109], 0
    v_mfma_f32_16x16x16_bf16 v[212:215], v[60:61], v[110:111], 0
    v_mfma_f32_16x16x16_bf16 v[220:223], v[62:63], v[110:111], 0
    v_mfma_f32_16x16x16_bf16 v[224:227], v[32:33], v[112:113], 0
    v_mfma_f32_16x16x16_bf16 v[232:235], v[34:35], v[112:113], 0
    v_mfma_f32_16x16x16_bf16 v[228:231], v[36:37], v[114:115], 0
    v_mfma_f32_16x16x16_bf16 v[236:239], v[38:39], v[114:115], 0
    v_mfma_f32_16x16x16_bf16 v[240:243], v[40:41], v[116:117], 0
    v_mfma_f32_16x16x16_bf16 v[248:251], v[42:43], v[116:117], 0
    v_mfma_f32_16x16x16_bf16 v[244:247], v[44:45], v[118:119], 0
    v_mfma_f32_16x16x16_bf16 v[252:255], v[46:47], v[118:119], 0
    v_add_f32 v72, v72, v30
    v_add_f32 v76, v76, v30
    v_rcp_f32 v72, v72
    v_rcp_f32 v76, v76
    v_mul_f32 v72, v72, v18
    v_mul_f32 v76, v76, v18
    v_pk_mul_f32 v[64:65], v[64:65], v[72:73] op_sel_hi:[1,0]
    v_pk_mul_f32 v[66:67], v[66:67], v[72:73] op_sel_hi:[1,0]
    v_pk_mul_f32 v[68:69], v[68:69], v[76:77] op_sel_hi:[1,0]
    v_pk_mul_f32 v[70:71], v[70:71], v[76:77] op_sel_hi:[1,0]
    v_cvt_pk_bf16_f32 v96, v64, v65
    v_cvt_pk_bf16_f32 v97, v66, v67
    v_cvt_pk_bf16_f32 v98, v68, v69
    v_cvt_pk_bf16_f32 v99, v70, v71
    v_mfma_f32_16x16x16_bf16 v[64:67], v[48:49], v[120:121], 0
    v_mfma_f32_16x16x16_bf16 v[72:75], v[50:51], v[120:121], 0
    v_mfma_f32_16x16x16_bf16 v[68:71], v[52:53], v[122:123], 0
    v_mfma_f32_16x16x16_bf16 v[76:79], v[54:55], v[122:123], 0
    buffer_store_dwordx4 v[96:99], v20, s[12:15], s23 offen offset:0 sc1
    v_add_f32 v88, v88, v30
    v_add_f32 v92, v92, v30
    v_rcp_f32 v88, v88
    v_rcp_f32 v92, v92
    v_mul_f32 v88, v88, v18
    v_mul_f32 v92, v92, v18
    v_pk_mul_f32 v[80:81], v[80:81], v[88:89] op_sel_hi:[1,0]
    v_pk_mul_f32 v[82:83], v[82:83], v[88:89] op_sel_hi:[1,0]
    v_pk_mul_f32 v[84:85], v[84:85], v[92:93] op_sel_hi:[1,0]
    v_pk_mul_f32 v[86:87], v[86:87], v[92:93] op_sel_hi:[1,0]
    v_cvt_pk_bf16_f32 v100, v80, v81
    v_cvt_pk_bf16_f32 v101, v82, v83
    v_cvt_pk_bf16_f32 v102, v84, v85
    v_cvt_pk_bf16_f32 v103, v86, v87
    v_mfma_f32_16x16x16_bf16 v[80:83], v[56:57], v[124:125], 0
    v_mfma_f32_16x16x16_bf16 v[88:91], v[58:59], v[124:125], 0
    v_mfma_f32_16x16x16_bf16 v[84:87], v[60:61], v[126:127], 0
    v_mfma_f32_16x16x16_bf16 v[92:95], v[62:63], v[126:127], 0
    buffer_store_dwordx4 v[100:103], v20, s[12:15], s23 offen offset:2048 sc1
    v_add_f32 v136, v136, v30
    v_add_f32 v140, v140, v30
    v_rcp_f32 v136, v136
    v_rcp_f32 v140, v140
    v_mul_f32 v136, v136, v18
    v_mul_f32 v140, v140, v18
    v_pk_mul_f32 v[128:129], v[128:129], v[136:137] op_sel_hi:[1,0]
    v_pk_mul_f32 v[130:131], v[130:131], v[136:137] op_sel_hi:[1,0]
    v_pk_mul_f32 v[132:133], v[132:133], v[140:141] op_sel_hi:[1,0]
    v_pk_mul_f32 v[134:135], v[134:135], v[140:141] op_sel_hi:[1,0]
    v_cvt_pk_bf16_f32 v104, v128, v129
    v_cvt_pk_bf16_f32 v105, v130, v131
    v_cvt_pk_bf16_f32 v106, v132, v133
    v_cvt_pk_bf16_f32 v107, v134, v135
    buffer_store_dwordx4 v[104:107], v20, s[12:15], s24 offen offset:0 sc1
    v_add_f32 v216, v216, v30
    v_add_f32 v220, v220, v30
    v_rcp_f32 v216, v216
    v_rcp_f32 v220, v220
    v_mul_f32 v216, v216, v18
    v_mul_f32 v220, v220, v18
    v_pk_mul_f32 v[208:209], v[208:209], v[216:217] op_sel_hi:[1,0]
    v_pk_mul_f32 v[210:211], v[210:211], v[216:217] op_sel_hi:[1,0]
    v_pk_mul_f32 v[212:213], v[212:213], v[220:221] op_sel_hi:[1,0]
    v_pk_mul_f32 v[214:215], v[214:215], v[220:221] op_sel_hi:[1,0]
    v_cvt_pk_bf16_f32 v108, v208, v209
    v_cvt_pk_bf16_f32 v109, v210, v211
    v_cvt_pk_bf16_f32 v110, v212, v213
    v_cvt_pk_bf16_f32 v111, v214, v215
    buffer_store_dwordx4 v[108:111], v20, s[12:15], s24 offen offset:2048 sc1
    v_add_f32 v232, v232, v30
    v_add_f32 v236, v236, v30
    v_rcp_f32 v232, v232
    v_rcp_f32 v236, v236
    v_mul_f32 v232, v232, v21
    v_mul_f32 v236, v236, v21
    v_pk_mul_f32 v[224:225], v[224:225], v[232:233] op_sel_hi:[1,0]
    v_pk_mul_f32 v[226:227], v[226:227], v[232:233] op_sel_hi:[1,0]
    v_pk_mul_f32 v[228:229], v[228:229], v[236:237] op_sel_hi:[1,0]
    v_pk_mul_f32 v[230:231], v[230:231], v[236:237] op_sel_hi:[1,0]
    v_cvt_pk_bf16_f32 v112, v224, v225
    v_cvt_pk_bf16_f32 v113, v226, v227
    v_cvt_pk_bf16_f32 v114, v228, v229
    v_cvt_pk_bf16_f32 v115, v230, v231
    buffer_store_dwordx4 v[112:115], v20, s[12:15], s23 offen offset:256 sc1
    v_add_f32 v248, v248, v30
    v_add_f32 v252, v252, v30
    v_rcp_f32 v248, v248
    v_rcp_f32 v252, v252
    v_mul_f32 v248, v248, v21
    v_mul_f32 v252, v252, v21
    v_pk_mul_f32 v[240:241], v[240:241], v[248:249] op_sel_hi:[1,0]
    v_pk_mul_f32 v[242:243], v[242:243], v[248:249] op_sel_hi:[1,0]
    v_pk_mul_f32 v[244:245], v[244:245], v[252:253] op_sel_hi:[1,0]
    v_pk_mul_f32 v[246:247], v[246:247], v[252:253] op_sel_hi:[1,0]
    v_cvt_pk_bf16_f32 v116, v240, v241
    v_cvt_pk_bf16_f32 v117, v242, v243
    v_cvt_pk_bf16_f32 v118, v244, v245
    v_cvt_pk_bf16_f32 v119, v246, v247
    buffer_store_dwordx4 v[116:119], v20, s[12:15], s23 offen offset:2304 sc1
    v_add_f32 v72, v72, v30
    v_add_f32 v76, v76, v30
    v_rcp_f32 v72, v72
    v_rcp_f32 v76, v76
    v_mul_f32 v72, v72, v21
    v_mul_f32 v76, v76, v21
    v_pk_mul_f32 v[64:65], v[64:65], v[72:73] op_sel_hi:[1,0]
    v_pk_mul_f32 v[66:67], v[66:67], v[72:73] op_sel_hi:[1,0]
    v_pk_mul_f32 v[68:69], v[68:69], v[76:77] op_sel_hi:[1,0]
    v_pk_mul_f32 v[70:71], v[70:71], v[76:77] op_sel_hi:[1,0]
    v_cvt_pk_bf16_f32 v120, v64, v65
    v_cvt_pk_bf16_f32 v121, v66, v67
    v_cvt_pk_bf16_f32 v122, v68, v69
    v_cvt_pk_bf16_f32 v123, v70, v71
    buffer_store_dwordx4 v[120:123], v20, s[12:15], s24 offen offset:256 sc1
    v_add_f32 v88, v88, v30
    v_add_f32 v92, v92, v30
    v_rcp_f32 v88, v88
    v_rcp_f32 v92, v92
    v_mul_f32 v88, v88, v21
    v_mul_f32 v92, v92, v21
    v_pk_mul_f32 v[80:81], v[80:81], v[88:89] op_sel_hi:[1,0]
    v_pk_mul_f32 v[82:83], v[82:83], v[88:89] op_sel_hi:[1,0]
    v_pk_mul_f32 v[84:85], v[84:85], v[92:93] op_sel_hi:[1,0]
    v_pk_mul_f32 v[86:87], v[86:87], v[92:93] op_sel_hi:[1,0]
    v_cvt_pk_bf16_f32 v124, v80, v81
    v_cvt_pk_bf16_f32 v125, v82, v83
    v_cvt_pk_bf16_f32 v126, v84, v85
    v_cvt_pk_bf16_f32 v127, v86, v87
    buffer_store_dwordx4 v[124:127], v20, s[12:15], s24 offen offset:2304 sc1
    s_mul_i32 s23, s19, 16
    s_add_u32 s23, s23, s62
    s_lshl_b32 s23, s23, 7
    s_add_u32 s23, s23, 0x16a0000
    s_waitcnt vmcnt(0)
    s_barrier
    s_cmp_lg_u32 s16, 0
    s_cbranch_scc1 L_of16
    v_mov_b32 v4, s28
    v_mov_b32 v5, 0
    s_mov_b64 exec, 1
    buffer_store_dword v4, v5, s[12:15], s23 offen sc1
    s_mov_b64 exec, -1
L_of16:
    s_cmp_ge_u32 s16, 4
    s_cbranch_scc1 L_o_h
    s_cmp_lg_u32 s2, 97
    s_cbranch_scc1 L_id_nb
    s_cmp_lg_u32 s16, 0
    s_cbranch_scc1 L_id_nb
    v_lshlrev_b32 v10, 7, v1
    s_mov_b32 s25, 0x1680000
L_poll17:
    buffer_load_dword v20, v10, s[12:15], s25 offen sc1
    s_add_u32 s35, s25, 8192
    buffer_load_dword v21, v10, s[12:15], s35 offen sc1
    s_add_u32 s35, s25, 16384
    buffer_load_dword v22, v10, s[12:15], s35 offen sc1
    s_add_u32 s35, s25, 24576
    buffer_load_dword v23, v10, s[12:15], s35 offen sc1
    s_add_u32 s33, s33, 1
    s_waitcnt vmcnt(0)
    v_cmp_ne_u32 vcc, s28, v20
    v_cmp_ne_u32 s[60:61], s28, v21
    s_nop 1
    s_or_b64 vcc, vcc, s[60:61]
    v_cmp_ne_u32 s[60:61], s28, v22
    s_nop 1
    s_or_b64 vcc, vcc, s[60:61]
    v_cmp_ne_u32 s[60:61], s28, v23
    s_nop 1
    s_or_b64 vcc, vcc, s[60:61]
    s_cmp_gt_u32 s33, 262144
    s_cbranch_scc1 L_poll17_d
    s_cbranch_vccz L_poll17_d
    s_sleep 8
    s_branch L_poll17
L_poll17_d:
    s_mov_b32 s25, 0x16f0000
    v_mov_b32 v4, s28
    v_mov_b32 v5, 0
    s_mov_b64 exec, 1
    buffer_store_dword v4, v5, s[12:15], s25 offen sc1
    s_mov_b64 exec, -1
L_id_nb:
    s_barrier
    s_branch L_upoll
L_o_h:
    s_branch L_p3pre
L_sp_help:
    s_lshl_b32 s23, s17, 13
    s_add_u32 s23, s23, 131072
    v_add_u32 v18, s23, v17
    s_waitcnt lgkmcnt(0)
    s_barrier
    s_setprio 0
    s_waitcnt lgkmcnt(0)
    s_barrier
    s_waitcnt vmcnt(0)
    s_add_u32 s34, s24, 1024
    s_add_u32 m0, s27, 131072
    s_nop 0
    buffer_load_dwordx4 v2, s[4:7], s34 offen lds
    s_add_u32 s34, s34, 131072
    s_add_u32 m0, s27, 135168
    s_nop 0
    buffer_load_dwordx4 v2, s[4:7], s34 offen lds
    s_add_u32 s34, s34, 131072
    s_add_u32 m0, s27, 139264
    s_nop 0
    buffer_load_dwordx4 v2, s[4:7], s34 offen lds
    s_add_u32 s34, s34, 131072
    s_add_u32 m0, s27, 143360
    s_nop 0
    buffer_load_dwordx4 v2, s[4:7], s34 offen lds
    s_add_u32 s34, s24, 1152
    s_add_u32 m0, s27, 147456
    s_nop 0
    buffer_load_dwordx4 v2, s[4:7], s34 offen lds
    s_add_u32 s34, s34, 131072
    s_add_u32 m0, s27, 151552
    s_nop 0
    buffer_load_dwordx4 v2, s[4:7], s34 offen lds
    s_add_u32 s34, s34, 131072
    s_add_u32 m0, s27, 155648
    s_nop 0
    buffer_load_dwordx4 v2, s[4:7], s34 offen lds
    s_add_u32 s34, s34, 131072
    s_add_u32 m0, s27, 159744
    s_nop 0
    buffer_load_dwordx4 v2, s[4:7], s34 offen lds
    s_add_u32 s34, s24, 1280
    s_add_u32 m0, s27, 0
    s_nop 0
    buffer_load_dwordx4 v2, s[4:7], s34 offen lds
    s_add_u32 s34, s34, 131072
    s_add_u32 m0, s27, 4096
    s_nop 0
    buffer_load_dwordx4 v2, s[4:7], s34 offen lds
    s_add_u32 s34, s34, 131072
    s_add_u32 m0, s27, 8192
    s_nop 0
    buffer_load_dwordx4 v2, s[4:7], s34 offen lds
    s_add_u32 s34, s34, 131072
    s_add_u32 m0, s27, 12288
    s_nop 0
    buffer_load_dwordx4 v2, s[4:7], s34 offen lds
    s_barrier
    s_add_u32 s34, s24, 1408
    s_add_u32 m0, s27, 16384
    s_nop 0
    buffer_load_dwordx4 v2, s[4:7], s34 offen lds
    s_add_u32 s34, s34, 131072
    s_add_u32 m0, s27, 20480
    s_nop 0
    buffer_load_dwordx4 v2, s[4:7], s34 offen lds
    s_add_u32 s34, s34, 131072
    s_add_u32 m0, s27, 24576
    s_nop 0
    buffer_load_dwordx4 v2, s[4:7], s34 offen lds
    s_add_u32 s34, s34, 131072
    s_add_u32 m0, s27, 28672
    s_nop 0
    buffer_load_dwordx4 v2, s[4:7], s34 offen lds
    s_add_u32 s34, s24, 1536
    s_add_u32 m0, s27, 32768
    s_nop 0
    buffer_load_dwordx4 v2, s[4:7], s34 offen lds
    s_add_u32 s34, s34, 131072
    s_add_u32 m0, s27, 36864
    s_nop 0
    buffer_load_dwordx4 v2, s[4:7], s34 offen lds
    s_add_u32 s34, s34, 131072
    s_add_u32 m0, s27, 40960
    s_nop 0
    buffer_load_dwordx4 v2, s[4:7], s34 offen lds
    s_add_u32 s34, s34, 131072
    s_add_u32 m0, s27, 45056
    s_nop 0
    buffer_load_dwordx4 v2, s[4:7], s34 offen lds
    s_waitcnt lgkmcnt(0)
    s_barrier
    s_add_u32 s34, s24, 1664
    s_add_u32 m0, s27, 49152
    s_nop 0
    buffer_load_dwordx4 v2, s[4:7], s34 offen lds
    s_add_u32 s34, s34, 131072
    s_add_u32 m0, s27, 53248
    s_nop 0
    buffer_load_dwordx4 v2, s[4:7], s34 offen lds
    s_add_u32 s34, s34, 131072
    s_add_u32 m0, s27, 57344
    s_nop 0
    buffer_load_dwordx4 v2, s[4:7], s34 offen lds
    s_add_u32 s34, s34, 131072
    s_add_u32 m0, s27, 61440
    s_nop 0
    buffer_load_dwordx4 v2, s[4:7], s34 offen lds
    s_add_u32 s34, s24, 1792
    s_add_u32 m0, s27, 65536
    s_nop 0
    buffer_load_dwordx4 v2, s[4:7], s34 offen lds
    s_add_u32 s34, s34, 131072
    s_add_u32 m0, s27, 69632
    s_nop 0
    buffer_load_dwordx4 v2, s[4:7], s34 offen lds
    s_add_u32 s34, s34, 131072
    s_add_u32 m0, s27, 73728
    s_nop 0
    buffer_load_dwordx4 v2, s[4:7], s34 offen lds
    s_add_u32 s34, s34, 131072
    s_add_u32 m0, s27, 77824
    s_nop 0
    buffer_load_dwordx4 v2, s[4:7], s34 offen lds
    s_waitcnt vmcnt(20)
    s_barrier
    s_add_u32 s34, s24, 1920
    s_add_u32 m0, s27, 81920
    s_nop 0
    buffer_load_dwordx4 v2, s[4:7], s34 offen lds
    s_add_u32 s34, s34, 131072
    s_add_u32 m0, s27, 86016
    s_nop 0
    buffer_load_dwordx4 v2, s[4:7], s34 offen lds
    s_add_u32 s34, s34, 131072
    s_add_u32 m0, s27, 90112
    s_nop 0
    buffer_load_dwordx4 v2, s[4:7], s34 offen lds
    s_add_u32 s34, s34, 131072
    s_add_u32 m0, s27, 94208
    s_nop 0
    buffer_load_dwordx4 v2, s[4:7], s34 offen lds
    s_xor_b32 s34, s24, 2048
    s_add_u32 s34, s34, 1792
    s_add_u32 m0, s27, 98304
    s_nop 0
    buffer_load_dwordx4 v2, s[4:7], s34 offen lds
    s_add_u32 s34, s34, 131072
    s_add_u32 m0, s27, 102400
    s_nop 0
    buffer_load_dwordx4 v2, s[4:7], s34 offen lds
    s_add_u32 s34, s34, 131072
    s_add_u32 m0, s27, 106496
    s_nop 0
    buffer_load_dwordx4 v2, s[4:7], s34 offen lds
    s_add_u32 s34, s34, 131072
    s_add_u32 m0, s27, 110592
    s_nop 0
    buffer_load_dwordx4 v2, s[4:7], s34 offen lds
    s_waitcnt vmcnt(20)
    s_waitcnt lgkmcnt(0)
    s_barrier
    s_xor_b32 s34, s24, 2048
    s_add_u32 s34, s34, 1920
    s_add_u32 m0, s27, 114688
    s_nop 0
    buffer_load_dwordx4 v2, s[4:7], s34 offen lds
    s_add_u32 s34, s34, 131072
    s_add_u32 m0, s27, 118784
    s_nop 0
    buffer_load_dwordx4 v2, s[4:7], s34 offen lds
    s_add_u32 s34, s34, 131072
    s_add_u32 m0, s27, 122880
    s_nop 0
    buffer_load_dwordx4 v2, s[4:7], s34 offen lds
    s_add_u32 s34, s34, 131072
    s_add_u32 m0, s27, 126976
    s_nop 0
    buffer_load_dwordx4 v2, s[4:7], s34 offen lds
    s_add_u32 s23, s31, 0
    s_cmp_ge_u32 s23, 7
    s_cselect_b32 s34, 7, 0
    s_sub_u32 s23, s23, s34
    s_lshl_b32 s34, s23, 17
    s_lshl_b32 s23, s31, 7
    s_add_u32 s34, s34, s23
    s_lshl_b32 s23, s17, 12
    s_add_u32 m0, s23, 131072
    s_nop 0
    buffer_load_dwordx4 v3, s[8:11], s34 offen lds
    s_add_u32 s34, s34, 8192
    s_add_u32 m0, s23, 132096
    s_nop 0
    buffer_load_dwordx4 v3, s[8:11], s34 offen lds
    s_add_u32 s34, s34, 8192
    s_add_u32 m0, s23, 133120
    s_nop 0
    buffer_load_dwordx4 v3, s[8:11], s34 offen lds
    s_add_u32 s34, s34, 8192
    s_add_u32 m0, s23, 134144
    s_nop 0
    buffer_load_dwordx4 v3, s[8:11], s34 offen lds
    s_waitcnt vmcnt(20)
    s_barrier
    s_add_u32 s23, s31, 1
    s_cmp_ge_u32 s23, 7
    s_cselect_b32 s34, 7, 0
    s_sub_u32 s23, s23, s34
    s_lshl_b32 s34, s23, 17
    s_lshl_b32 s23, s31, 7
    s_add_u32 s34, s34, s23
    s_lshl_b32 s23, s17, 12
    s_add_u32 m0, s23, 147456
    s_nop 0
    buffer_load_dwordx4 v3, s[8:11], s34 offen lds
    s_add_u32 s34, s34, 8192
    s_add_u32 m0, s23, 148480
    s_nop 0
    buffer_load_dwordx4 v3, s[8:11], s34 offen lds
    s_add_u32 s34, s34, 8192
    s_add_u32 m0, s23, 149504
    s_nop 0
    buffer_load_dwordx4 v3, s[8:11], s34 offen lds
    s_add_u32 s34, s34, 8192
    s_add_u32 m0, s23, 150528
    s_nop 0
    buffer_load_dwordx4 v3, s[8:11], s34 offen lds
    s_add_u32 s23, s31, 2
    s_cmp_ge_u32 s23, 7
    s_cselect_b32 s34, 7, 0
    s_sub_u32 s23, s23, s34
    s_lshl_b32 s34, s23, 17
    s_lshl_b32 s23, s31, 7
    s_add_u32 s34, s34, s23
    s_lshl_b32 s23, s17, 12
    s_add_u32 m0, s23, 0
    s_nop 0
    buffer_load_dwordx4 v3, s[8:11], s34 offen lds
    s_add_u32 s34, s34, 8192
    s_add_u32 m0, s23, 1024
    s_nop 0
    buffer_load_dwordx4 v3, s[8:11], s34 offen lds
    s_add_u32 s34, s34, 8192
    s_add_u32 m0, s23, 2048
    s_nop 0
    buffer_load_dwordx4 v3, s[8:11], s34 offen lds
    s_add_u32 s34, s34, 8192
    s_add_u32 m0, s23, 3072
    s_nop 0
    buffer_load_dwordx4 v3, s[8:11], s34 offen lds
    s_waitcnt vmcnt(20)
    s_barrier
    s_add_u32 s23, s31, 3
    s_cmp_ge_u32 s23, 7
    s_cselect_b32 s34, 7, 0
    s_sub_u32 s23, s23, s34
    s_lshl_b32 s34, s23, 17
    s_lshl_b32 s23, s31, 7
    s_add_u32 s34, s34, s23
    s_lshl_b32 s23, s17, 12
    s_add_u32 m0, s23, 16384
    s_nop 0
    buffer_load_dwordx4 v3, s[8:11], s34 offen lds
    s_add_u32 s34, s34, 8192
    s_add_u32 m0, s23, 17408
    s_nop 0
    buffer_load_dwordx4 v3, s[8:11], s34 offen lds
    s_add_u32 s34, s34, 8192
    s_add_u32 m0, s23, 18432
    s_nop 0
    buffer_load_dwordx4 v3, s[8:11], s34 offen lds
    s_add_u32 s34, s34, 8192
    s_add_u32 m0, s23, 19456
    s_nop 0
    buffer_load_dwordx4 v3, s[8:11], s34 offen lds
    s_add_u32 s23, s31, 4
    s_cmp_ge_u32 s23, 7
    s_cselect_b32 s34, 7, 0
    s_sub_u32 s23, s23, s34
    s_lshl_b32 s34, s23, 17
    s_lshl_b32 s23, s31, 7
    s_add_u32 s34, s34, s23
    s_lshl_b32 s23, s17, 12
    s_add_u32 m0, s23, 32768
    s_nop 0
    buffer_load_dwordx4 v3, s[8:11], s34 offen lds
    s_add_u32 s34, s34, 8192
    s_add_u32 m0, s23, 33792
    s_nop 0
    buffer_load_dwordx4 v3, s[8:11], s34 offen lds
    s_add_u32 s34, s34, 8192
    s_add_u32 m0, s23, 34816
    s_nop 0
    buffer_load_dwordx4 v3, s[8:11], s34 offen lds
    s_add_u32 s34, s34, 8192
    s_add_u32 m0, s23, 35840
    s_nop 0
    buffer_load_dwordx4 v3, s[8:11], s34 offen lds
    s_waitcnt vmcnt(20)
    s_barrier
    v_lshrrev_b32 v28, 5, v1
    v_bfe_u32 v29, v1, 2, 2
    v_lshl_add_u32 v24, v28, 2, v29
    v_lshlrev_b32 v24, 7, v24
    v_bfe_u32 v28, v1, 3, 1
    v_lshl_add_u32 v24, v28, 6, v24
    v_bfe_u32 v28, v1, 4, 1
    v_lshl_add_u32 v24, v28, 5, v24
    v_and_b32 v28, 1, v1
    v_lshl_add_u32 v24, v28, 4, v24
    v_bfe_u32 v28, v1, 1, 1
    v_lshl_add_u32 v24, v28, 3, v24
    s_lshl_b32 s23, s17, 12
    s_add_u32 s23, s23, 65536
    v_add_u32 v24, s23, v24
    v_xor_b32 v25, 64, v24
    v_add_u32 v26, s23, v17
    ds_write_b128 v26, v[144:147] offset:0
    ds_write_b128 v26, v[148:151] offset:1024
    ds_write_b128 v26, v[152:155] offset:2048
    ds_write_b128 v26, v[156:159] offset:3072
    ds_read_b64_tr_b16 v[144:145], v24 offset:0
    ds_read_b64_tr_b16 v[146:147], v24 offset:2048
    ds_read_b64_tr_b16 v[148:149], v25 offset:0
    ds_read_b64_tr_b16 v[150:151], v25 offset:2048
    ds_read_b64_tr_b16 v[152:153], v24 offset:1024
    ds_read_b64_tr_b16 v[154:155], v24 offset:3072
    ds_read_b64_tr_b16 v[156:157], v25 offset:1024
    ds_read_b64_tr_b16 v[158:159], v25 offset:3072
    ds_write_b128 v26, v[160:163] offset:0
    ds_write_b128 v26, v[164:167] offset:1024
    ds_write_b128 v26, v[168:171] offset:2048
    ds_write_b128 v26, v[172:175] offset:3072
    ds_read_b64_tr_b16 v[160:161], v24 offset:0
    ds_read_b64_tr_b16 v[162:163], v24 offset:2048
    ds_read_b64_tr_b16 v[164:165], v25 offset:0
    ds_read_b64_tr_b16 v[166:167], v25 offset:2048
    ds_read_b64_tr_b16 v[168:169], v24 offset:1024
    ds_read_b64_tr_b16 v[170:171], v24 offset:3072
    ds_read_b64_tr_b16 v[172:173], v25 offset:1024
    ds_read_b64_tr_b16 v[174:175], v25 offset:3072
    ds_write_b128 v26, v[176:179] offset:0
    ds_write_b128 v26, v[180:183] offset:1024
    ds_write_b128 v26, v[184:187] offset:2048
    ds_write_b128 v26, v[188:191] offset:3072
    ds_read_b64_tr_b16 v[176:177], v24 offset:0
    ds_read_b64_tr_b16 v[178:179], v24 offset:2048
    ds_read_b64_tr_b16 v[180:181], v25 offset:0
    ds_read_b64_tr_b16 v[182:183], v25 offset:2048
    ds_read_b64_tr_b16 v[184:185], v24 offset:1024
    ds_read_b64_tr_b16 v[186:187], v24 offset:3072
    ds_read_b64_tr_b16 v[188:189], v25 offset:1024
    ds_read_b64_tr_b16 v[190:191], v25 offset:3072
    ds_write_b128 v26, v[192:195] offset:0
    ds_write_b128 v26, v[196:199] offset:1024
    ds_write_b128 v26, v[200:203] offset:2048
    ds_write_b128 v26, v[204:207] offset:3072
    ds_read_b64_tr_b16 v[192:193], v24 offset:0
    ds_read_b64_tr_b16 v[194:195], v24 offset:2048
    ds_read_b64_tr_b16 v[196:197], v25 offset:0
    ds_read_b64_tr_b16 v[198:199], v25 offset:2048
    ds_read_b64_tr_b16 v[200:201], v24 offset:1024
    ds_read_b64_tr_b16 v[202:203], v24 offset:3072
    ds_read_b64_tr_b16 v[204:205], v25 offset:1024
    ds_read_b64_tr_b16 v[206:207], v25 offset:3072
    s_waitcnt lgkmcnt(0)
    s_add_u32 s23, s31, 5
    s_cmp_ge_u32 s23, 7
    s_cselect_b32 s34, 7, 0
    s_sub_u32 s23, s23, s34
    s_lshl_b32 s34, s23, 17
    s_lshl_b32 s23, s31, 7
    s_add_u32 s34, s34, s23
    s_lshl_b32 s23, s17, 12
    s_add_u32 m0, s23, 49152
    s_nop 0
    buffer_load_dwordx4 v3, s[8:11], s34 offen lds
    s_add_u32 s34, s34, 8192
    s_add_u32 m0, s23, 50176
    s_nop 0
    buffer_load_dwordx4 v3, s[8:11], s34 offen lds
    s_add_u32 s34, s34, 8192
    s_add_u32 m0, s23, 51200
    s_nop 0
    buffer_load_dwordx4 v3, s[8:11], s34 offen lds
    s_add_u32 s34, s34, 8192
    s_add_u32 m0, s23, 52224
    s_nop 0
    buffer_load_dwordx4 v3, s[8:11], s34 offen lds
L_p3pre:
L_p3:
    s_setprio 0
    v_lshrrev_b32 v28, 5, v1
    v_bfe_u32 v29, v1, 2, 2
    v_lshl_add_u32 v24, v28, 2, v29
    v_lshlrev_b32 v24, 7, v24
    v_bfe_u32 v28, v1, 3, 1
    v_lshl_add_u32 v24, v28, 6, v24
    v_bfe_u32 v28, v1, 4, 1
    v_lshl_add_u32 v24, v28, 5, v24
    v_and_b32 v28, 1, v1
    v_lshl_add_u32 v24, v28, 4, v24
    v_bfe_u32 v28, v1, 1, 1
    v_lshl_add_u32 v24, v28, 3, v24
    s_lshl_b32 s23, s17, 12
    s_add_u32 s23, s23, 131072
    v_add_u32 v24, s23, v24
    v_xor_b32 v25, 64, v24
    s_lshl_b32 s29, s19, 1
    s_add_u32 s29, s29, s30
    s_lshl_b32 s29, s29, 10
    s_add_u32 s29, s29, 0x16a0380
    v_mov_b32 v19, 0
    buffer_load_dword v20, v19, s[12:15], s29 offen sc1
    s_waitcnt vmcnt(21)
    ds_read_b64_tr_b16 v[32:33], v24 offset:0
    ds_read_b64_tr_b16 v[34:35], v24 offset:2048
    ds_read_b64_tr_b16 v[36:37], v25 offset:0
    ds_read_b64_tr_b16 v[38:39], v25 offset:2048
    ds_read_b64_tr_b16 v[40:41], v24 offset:1024
    ds_read_b64_tr_b16 v[42:43], v24 offset:3072
    ds_read_b64_tr_b16 v[44:45], v25 offset:1024
    ds_read_b64_tr_b16 v[46:47], v25 offset:3072
    s_sub_u32 s32, s32, 1
    v_and_b32 v7, 7, v1
    s_mul_i32 s25, s32, 56
    s_lshl_b32 s23, s17, 1
    s_add_u32 s25, s25, s23
    s_lshl_b32 s25, s25, 10
    s_add_u32 s25, s25, 0xa00000
    v_add_u32 v18, 57344, v17
    s_waitcnt lgkmcnt(0)
    s_add_u32 s23, s31, 6
    s_cmp_ge_u32 s23, 7
    s_cselect_b32 s34, 7, 0
    s_sub_u32 s23, s23, s34
    s_lshl_b32 s34, s23, 17
    s_lshl_b32 s23, s31, 7
    s_add_u32 s34, s34, s23
    s_lshl_b32 s23, s17, 12
    s_add_u32 m0, s23, 131072
    s_nop 0
    buffer_load_dwordx4 v3, s[8:11], s34 offen lds
    s_add_u32 s34, s34, 8192
    s_add_u32 m0, s23, 132096
    s_nop 0
    buffer_load_dwordx4 v3, s[8:11], s34 offen lds
    s_add_u32 s34, s34, 8192
    s_add_u32 m0, s23, 133120
    s_nop 0
    buffer_load_dwordx4 v3, s[8:11], s34 offen lds
    s_add_u32 s34, s34, 8192
    s_add_u32 m0, s23, 134144
    s_nop 0
    buffer_load_dwordx4 v3, s[8:11], s34 offen lds
    s_mov_b32 s4, s54
    s_mov_b32 s5, s55
    s_mov_b32 s6, 0x200000
    v_bfe_u32 v48, v1, 4, 1
    v_lshlrev_b32 v48, 14, v48
    v_and_b32 v4, 15, v1
    v_lshl_add_u32 v48, v4, 8, v48
    v_lshrrev_b32 v4, 5, v1
    v_lshlrev_b32 v4, 1, v4
    v_xor_b32 v4, v4, v7
    v_lshl_add_u32 v48, v4, 4, v48
    s_lshl_b32 s23, s17, 12
    s_add_u32 s23, s23, 65536
    v_add_u32 v48, s23, v48
    v_xor_b32 v49, 16, v48
    v_xor_b32 v50, 64, v48
    v_xor_b32 v51, 0x50, v48
    v_lshrrev_b32 v4, 3, v1
    v_lshlrev_b32 v5, 1, v7
    v_xor_b32 v5, v5, v4
    v_lshlrev_b32 v5, 4, v5
    v_lshl_add_u32 v52, v4, 8, v5
    s_lshl_b32 s23, s17, 14
    s_add_u32 s23, s23, 65536
    v_add_u32 v52, s23, v52
    v_xor_b32 v53, 16, v52
    v_lshlrev_b32 v54, 10, v4
    v_lshl_add_u32 v54, v7, 4, v54
    s_lshl_b32 s22, s32, 15
    s_lshl_b32 s23, s31, 7
    s_add_u32 s22, s22, s23
    s_lshl_b32 s23, s17, 14
    s_add_u32 s22, s22, s23
    s_barrier
    s_waitcnt vmcnt(4)
    v_cmp_ne_u32 vcc, s28, v20
    s_nop 0
    s_cbranch_vccz L_p3_o
L_poll18:
    buffer_load_dword v20, v19, s[12:15], s29 offen sc1
    s_add_u32 s33, s33, 1
    s_waitcnt vmcnt(0)
    v_cmp_ne_u32 vcc, s28, v20
    s_cmp_gt_u32 s33, 262144
    s_cbranch_scc1 L_poll18_d
    s_cbranch_vccz L_poll18_d
    s_sleep 4
    s_branch L_poll18
L_poll18_d:
L_p3_o:
    s_lshl_b32 s21, s32, 5
    s_lshl_b32 s23, s17, 3
    s_add_u32 s21, s21, s23
    s_lshl_b32 s21, s21, 10
    s_add_u32 s21, s21, 0x1200000
    v_add_u32 v21, 32768, v17
    buffer_load_dwordx4 v[128:131], v17, s[12:15], s21 offen offset:0 sc1
    buffer_load_dwordx4 v[132:135], v21, s[12:15], s21 offen offset:0 sc1
    buffer_load_dwordx4 v[136:139], v17, s[12:15], s21 offen offset:1024 sc1
    buffer_load_dwordx4 v[140:143], v21, s[12:15], s21 offen offset:1024 sc1
    buffer_load_dwordx4 v[208:211], v17, s[12:15], s21 offen offset:2048 sc1
    buffer_load_dwordx4 v[212:215], v21, s[12:15], s21 offen offset:2048 sc1
    buffer_load_dwordx4 v[216:219], v17, s[12:15], s21 offen offset:3072 sc1
    buffer_load_dwordx4 v[220:223], v21, s[12:15], s21 offen offset:3072 sc1
    s_add_u32 s21, s21, 4096
    buffer_load_dwordx4 v[224:227], v17, s[12:15], s21 offen offset:0 sc1
    buffer_load_dwordx4 v[228:231], v21, s[12:15], s21 offen offset:0 sc1
    buffer_load_dwordx4 v[232:235], v17, s[12:15], s21 offen offset:1024 sc1
    buffer_load_dwordx4 v[236:239], v21, s[12:15], s21 offen offset:1024 sc1
    buffer_load_dwordx4 v[240:243], v17, s[12:15], s21 offen offset:2048 sc1
    buffer_load_dwordx4 v[244:247], v21, s[12:15], s21 offen offset:2048 sc1
    buffer_load_dwordx4 v[248:251], v17, s[12:15], s21 offen offset:3072 sc1
    buffer_load_dwordx4 v[252:255], v21, s[12:15], s21 offen offset:3072 sc1
    s_waitcnt vmcnt(14)
    v_mfma_f32_32x32x16_bf16 v[64:79], v[144:147], v[128:131], 0
    v_mfma_f32_32x32x16_bf16 v[80:95], v[148:151], v[128:131], 0
    v_mfma_f32_32x32x16_bf16 v[96:111], v[144:147], v[132:135], 0
    v_mfma_f32_32x32x16_bf16 v[112:127], v[148:151], v[132:135], 0
    s_waitcnt vmcnt(12)
    v_mfma_f32_32x32x16_bf16 v[64:79], v[152:155], v[136:139], v[64:79]
    v_mfma_f32_32x32x16_bf16 v[80:95], v[156:159], v[136:139], v[80:95]
    v_mfma_f32_32x32x16_bf16 v[96:111], v[152:155], v[140:143], v[96:111]
    v_mfma_f32_32x32x16_bf16 v[112:127], v[156:159], v[140:143], v[112:127]
    s_waitcnt vmcnt(10)
    v_mfma_f32_32x32x16_bf16 v[64:79], v[160:163], v[208:211], v[64:79]
    v_mfma_f32_32x32x16_bf16 v[80:95], v[164:167], v[208:211], v[80:95]
    v_mfma_f32_32x32x16_bf16 v[96:111], v[160:163], v[212:215], v[96:111]
    v_mfma_f32_32x32x16_bf16 v[112:127], v[164:167], v[212:215], v[112:127]
    s_waitcnt vmcnt(8)
    v_mfma_f32_32x32x16_bf16 v[64:79], v[168:171], v[216:219], v[64:79]
    v_mfma_f32_32x32x16_bf16 v[80:95], v[172:175], v[216:219], v[80:95]
    v_mfma_f32_32x32x16_bf16 v[96:111], v[168:171], v[220:223], v[96:111]
    v_mfma_f32_32x32x16_bf16 v[112:127], v[172:175], v[220:223], v[112:127]
    s_waitcnt vmcnt(6)
    v_mfma_f32_32x32x16_bf16 v[64:79], v[176:179], v[224:227], v[64:79]
    v_mfma_f32_32x32x16_bf16 v[80:95], v[180:183], v[224:227], v[80:95]
    v_mfma_f32_32x32x16_bf16 v[96:111], v[176:179], v[228:231], v[96:111]
    v_mfma_f32_32x32x16_bf16 v[112:127], v[180:183], v[228:231], v[112:127]
    s_waitcnt vmcnt(4)
    v_mfma_f32_32x32x16_bf16 v[64:79], v[184:187], v[232:235], v[64:79]
    v_mfma_f32_32x32x16_bf16 v[80:95], v[188:191], v[232:235], v[80:95]
    v_mfma_f32_32x32x16_bf16 v[96:111], v[184:187], v[236:239], v[96:111]
    v_mfma_f32_32x32x16_bf16 v[112:127], v[188:191], v[236:239], v[112:127]
    s_waitcnt vmcnt(2)
    v_mfma_f32_32x32x16_bf16 v[64:79], v[192:195], v[240:243], v[64:79]
    v_mfma_f32_32x32x16_bf16 v[80:95], v[196:199], v[240:243], v[80:95]
    v_mfma_f32_32x32x16_bf16 v[96:111], v[192:195], v[244:247], v[96:111]
    v_mfma_f32_32x32x16_bf16 v[112:127], v[196:199], v[244:247], v[112:127]
    s_waitcnt vmcnt(0)
    v_mfma_f32_32x32x16_bf16 v[64:79], v[200:203], v[248:251], v[64:79]
    v_mfma_f32_32x32x16_bf16 v[80:95], v[204:207], v[248:251], v[80:95]
    v_mfma_f32_32x32x16_bf16 v[96:111], v[200:203], v[252:255], v[96:111]
    v_mfma_f32_32x32x16_bf16 v[112:127], v[204:207], v[252:255], v[112:127]
    s_barrier
    s_add_u32 s23, s31, 0
    s_cmp_ge_u32 s23, 7
    s_cselect_b32 s24, 7, 0
    s_sub_u32 s23, s23, s24
    s_lshl_b32 s23, s23, 13
    s_add_u32 s23, s23, s25
    buffer_load_dwordx4 v[128:131], v17, s[12:15], s23 offen offset:0 sc1
    buffer_load_dwordx4 v[132:135], v18, s[12:15], s23 offen offset:0 sc1
    buffer_load_dwordx4 v[136:139], v17, s[12:15], s23 offen offset:1024 sc1
    buffer_load_dwordx4 v[140:143], v18, s[12:15], s23 offen offset:1024 sc1
    s_add_u32 s23, s31, 1
    s_cmp_ge_u32 s23, 7
    s_cselect_b32 s24, 7, 0
    s_sub_u32 s23, s23, s24
    s_lshl_b32 s23, s23, 13
    s_add_u32 s23, s23, s25
    buffer_load_dwordx4 v[144:147], v17, s[12:15], s23 offen offset:0 sc1
    buffer_load_dwordx4 v[148:151], v18, s[12:15], s23 offen offset:0 sc1
    buffer_load_dwordx4 v[152:155], v17, s[12:15], s23 offen offset:1024 sc1
    buffer_load_dwordx4 v[156:159], v18, s[12:15], s23 offen offset:1024 sc1
    s_add_u32 s23, s31, 2
    s_cmp_ge_u32 s23, 7
    s_cselect_b32 s24, 7, 0
    s_sub_u32 s23, s23, s24
    s_lshl_b32 s23, s23, 13
    s_add_u32 s23, s23, s25
    buffer_load_dwordx4 v[160:163], v17, s[12:15], s23 offen offset:0 sc1
    buffer_load_dwordx4 v[164:167], v18, s[12:15], s23 offen offset:0 sc1
    buffer_load_dwordx4 v[168:171], v17, s[12:15], s23 offen offset:1024 sc1
    buffer_load_dwordx4 v[172:175], v18, s[12:15], s23 offen offset:1024 sc1
    v_add_u32 v24, 16384, v24
    v_add_u32 v25, 16384, v25
    ds_read_b64_tr_b16 v[56:57], v24 offset:0
    ds_read_b64_tr_b16 v[58:59], v24 offset:2048
    ds_read_b64_tr_b16 v[60:61], v25 offset:0
    ds_read_b64_tr_b16 v[62:63], v25 offset:2048
    ds_read_b64_tr_b16 v[8:9], v24 offset:1024
    ds_read_b64_tr_b16 v[10:11], v24 offset:3072
    ds_read_b64_tr_b16 v[12:13], v25 offset:1024
    ds_read_b64_tr_b16 v[14:15], v25 offset:3072
    s_waitcnt vmcnt(11)
    v_mfma_f32_32x32x16_bf16 v[64:79], v[32:35], v[128:131], v[64:79]
    s_add_u32 s23, s31, 3
    s_cmp_ge_u32 s23, 7
    s_cselect_b32 s24, 7, 0
    s_sub_u32 s23, s23, s24
    s_lshl_b32 s23, s23, 13
    s_add_u32 s23, s23, s25
    buffer_load_dwordx4 v[176:179], v17, s[12:15], s23 offen offset:0 sc1
    v_mfma_f32_32x32x16_bf16 v[80:95], v[36:39], v[128:131], v[80:95]
    s_waitcnt vmcnt(11)
    v_mfma_f32_32x32x16_bf16 v[96:111], v[32:35], v[132:135], v[96:111]
    buffer_load_dwordx4 v[180:183], v18, s[12:15], s23 offen offset:0 sc1
    v_mfma_f32_32x32x16_bf16 v[112:127], v[36:39], v[132:135], v[112:127]
    v_add_u32 v24, -147456, v24
    v_add_u32 v25, -147456, v25
    ds_read_b64_tr_b16 v[240:241], v24 offset:0
    ds_read_b64_tr_b16 v[242:243], v24 offset:2048
    ds_read_b64_tr_b16 v[244:245], v25 offset:0
    ds_read_b64_tr_b16 v[246:247], v25 offset:2048
    s_waitcnt vmcnt(11)
    v_mfma_f32_32x32x16_bf16 v[64:79], v[40:43], v[136:139], v[64:79]
    buffer_load_dwordx4 v[184:187], v17, s[12:15], s23 offen offset:1024 sc1
    v_mfma_f32_32x32x16_bf16 v[80:95], v[44:47], v[136:139], v[80:95]
    s_waitcnt vmcnt(11)
    v_mfma_f32_32x32x16_bf16 v[96:111], v[40:43], v[140:143], v[96:111]
    buffer_load_dwordx4 v[188:191], v18, s[12:15], s23 offen offset:1024 sc1
    v_mfma_f32_32x32x16_bf16 v[112:127], v[44:47], v[140:143], v[112:127]
    ds_read_b64_tr_b16 v[248:249], v24 offset:1024
    ds_read_b64_tr_b16 v[250:251], v24 offset:3072
    ds_read_b64_tr_b16 v[252:253], v25 offset:1024
    ds_read_b64_tr_b16 v[254:255], v25 offset:3072
    s_waitcnt vmcnt(11) lgkmcnt(12)
    v_mfma_f32_32x32x16_bf16 v[64:79], v[56:59], v[144:147], v[64:79]
    s_add_u32 s23, s31, 4
    s_cmp_ge_u32 s23, 7
    s_cselect_b32 s24, 7, 0
    s_sub_u32 s23, s23, s24
    s_lshl_b32 s23, s23, 13
    s_add_u32 s23, s23, s25
    buffer_load_dwordx4 v[192:195], v17, s[12:15], s23 offen offset:0 sc1
    v_mfma_f32_32x32x16_bf16 v[80:95], v[60:63], v[144:147], v[80:95]
    s_waitcnt vmcnt(11)
    v_mfma_f32_32x32x16_bf16 v[96:111], v[56:59], v[148:151], v[96:111]
    buffer_load_dwordx4 v[196:199], v18, s[12:15], s23 offen offset:0 sc1
    v_mfma_f32_32x32x16_bf16 v[112:127], v[60:63], v[148:151], v[112:127]
    v_add_u32 v24, 16384, v24
    v_add_u32 v25, 16384, v25
    ds_read_b64_tr_b16 v[32:33], v24 offset:0
    ds_read_b64_tr_b16 v[34:35], v24 offset:2048
    ds_read_b64_tr_b16 v[36:37], v25 offset:0
    ds_read_b64_tr_b16 v[38:39], v25 offset:2048
    s_waitcnt vmcnt(11) lgkmcnt(12)
    v_mfma_f32_32x32x16_bf16 v[64:79], v[8:11], v[152:155], v[64:79]
    buffer_load_dwordx4 v[200:203], v17, s[12:15], s23 offen offset:1024 sc1
    v_mfma_f32_32x32x16_bf16 v[80:95], v[12:15], v[152:155], v[80:95]
    s_waitcnt vmcnt(11)
    v_mfma_f32_32x32x16_bf16 v[96:111], v[8:11], v[156:159], v[96:111]
    buffer_load_dwordx4 v[204:207], v18, s[12:15], s23 offen offset:1024 sc1
    v_mfma_f32_32x32x16_bf16 v[112:127], v[12:15], v[156:159], v[112:127]
    ds_read_b64_tr_b16 v[40:41], v24 offset:1024
    ds_read_b64_tr_b16 v[42:43], v24 offset:3072
    ds_read_b64_tr_b16 v[44:45], v25 offset:1024
    ds_read_b64_tr_b16 v[46:47], v25 offset:3072
    s_waitcnt vmcnt(11) lgkmcnt(12)
    v_mfma_f32_32x32x16_bf16 v[64:79], v[240:243], v[160:163], v[64:79]
    s_add_u32 s23, s31, 5
    s_cmp_ge_u32 s23, 7
    s_cselect_b32 s24, 7, 0
    s_sub_u32 s23, s23, s24
    s_lshl_b32 s23, s23, 13
    s_add_u32 s23, s23, s25
    buffer_load_dwordx4 v[208:211], v17, s[12:15], s23 offen offset:0 sc1
    v_mfma_f32_32x32x16_bf16 v[80:95], v[244:247], v[160:163], v[80:95]
    s_waitcnt vmcnt(11)
    v_mfma_f32_32x32x16_bf16 v[96:111], v[240:243], v[164:167], v[96:111]
    buffer_load_dwordx4 v[212:215], v17, s[12:15], s23 offen offset:1024 sc1
    v_mfma_f32_32x32x16_bf16 v[112:127], v[244:247], v[164:167], v[112:127]
    v_add_u32 v24, 16384, v24
    v_add_u32 v25, 16384, v25
    ds_read_b64_tr_b16 v[56:57], v24 offset:0
    ds_read_b64_tr_b16 v[58:59], v24 offset:2048
    ds_read_b64_tr_b16 v[60:61], v25 offset:0
    ds_read_b64_tr_b16 v[62:63], v25 offset:2048
    s_waitcnt vmcnt(11) lgkmcnt(12)
    v_mfma_f32_32x32x16_bf16 v[64:79], v[248:251], v[168:171], v[64:79]
    s_add_u32 s23, s31, 6
    s_cmp_ge_u32 s23, 7
    s_cselect_b32 s24, 7, 0
    s_sub_u32 s23, s23, s24
    s_lshl_b32 s23, s23, 13
    s_add_u32 s23, s23, s25
    buffer_load_dwordx4 v[216:219], v17, s[12:15], s23 offen offset:0 sc1
    v_mfma_f32_32x32x16_bf16 v[80:95], v[252:255], v[168:171], v[80:95]
    s_waitcnt vmcnt(11)
    v_mfma_f32_32x32x16_bf16 v[96:111], v[248:251], v[172:175], v[96:111]
    buffer_load_dwordx4 v[220:223], v17, s[12:15], s23 offen offset:1024 sc1
    v_mfma_f32_32x32x16_bf16 v[112:127], v[252:255], v[172:175], v[112:127]
    ds_read_b64_tr_b16 v[8:9], v24 offset:1024
    ds_read_b64_tr_b16 v[10:11], v24 offset:3072
    ds_read_b64_tr_b16 v[12:13], v25 offset:1024
    ds_read_b64_tr_b16 v[14:15], v25 offset:3072
    s_waitcnt vmcnt(11) lgkmcnt(12)
    v_mfma_f32_32x32x16_bf16 v[64:79], v[32:35], v[176:179], v[64:79]
    s_add_u32 s23, s31, 5
    s_cmp_ge_u32 s23, 7
    s_cselect_b32 s24, 7, 0
    s_sub_u32 s23, s23, s24
    s_lshl_b32 s23, s23, 13
    s_add_u32 s23, s23, s25
    buffer_load_dwordx4 v[224:227], v18, s[12:15], s23 offen offset:0 sc1
    v_mfma_f32_32x32x16_bf16 v[80:95], v[36:39], v[176:179], v[80:95]
    s_waitcnt vmcnt(11)
    v_mfma_f32_32x32x16_bf16 v[96:111], v[32:35], v[180:183], v[96:111]
    buffer_load_dwordx4 v[228:231], v18, s[12:15], s23 offen offset:1024 sc1
    v_mfma_f32_32x32x16_bf16 v[112:127], v[36:39], v[180:183], v[112:127]
    v_add_u32 v24, 16384, v24
    v_add_u32 v25, 16384, v25
    ds_read_b64_tr_b16 v[240:241], v24 offset:0
    ds_read_b64_tr_b16 v[242:243], v24 offset:2048
    ds_read_b64_tr_b16 v[244:245], v25 offset:0
    ds_read_b64_tr_b16 v[246:247], v25 offset:2048
    s_waitcnt vmcnt(11) lgkmcnt(12)
    v_mfma_f32_32x32x16_bf16 v[64:79], v[40:43], v[184:187], v[64:79]
    s_add_u32 s23, s31, 6
    s_cmp_ge_u32 s23, 7
    s_cselect_b32 s24, 7, 0
    s_sub_u32 s23, s23, s24
    s_lshl_b32 s23, s23, 13
    s_add_u32 s23, s23, s25
    buffer_load_dwordx4 v[232:235], v18, s[12:15], s23 offen offset:0 sc1
    v_mfma_f32_32x32x16_bf16 v[80:95], v[44:47], v[184:187], v[80:95]
    s_waitcnt vmcnt(11)
    v_mfma_f32_32x32x16_bf16 v[96:111], v[40:43], v[188:191], v[96:111]
    buffer_load_dwordx4 v[236:239], v18, s[12:15], s23 offen offset:1024 sc1
    v_mfma_f32_32x32x16_bf16 v[112:127], v[44:47], v[188:191], v[112:127]
    ds_read_b64_tr_b16 v[248:249], v24 offset:1024
    ds_read_b64_tr_b16 v[250:251], v24 offset:3072
    ds_read_b64_tr_b16 v[252:253], v25 offset:1024
    ds_read_b64_tr_b16 v[254:255], v25 offset:3072
    s_waitcnt vmcnt(11) lgkmcnt(12)
    v_mfma_f32_32x32x16_bf16 v[64:79], v[56:59], v[192:195], v[64:79]
    v_mfma_f32_32x32x16_bf16 v[80:95], v[60:63], v[192:195], v[80:95]
    s_waitcnt vmcnt(10)
    v_mfma_f32_32x32x16_bf16 v[96:111], v[56:59], v[196:199], v[96:111]
    v_mfma_f32_32x32x16_bf16 v[112:127], v[60:63], v[196:199], v[112:127]
    v_add_u32 v24, 81920, v24
    v_add_u32 v25, 81920, v25
    ds_read_b64_tr_b16 v[32:33], v24 offset:0
    ds_read_b64_tr_b16 v[34:35], v24 offset:2048
    ds_read_b64_tr_b16 v[36:37], v25 offset:0
    ds_read_b64_tr_b16 v[38:39], v25 offset:2048
    s_waitcnt vmcnt(9) lgkmcnt(12)
    v_mfma_f32_32x32x16_bf16 v[64:79], v[8:11], v[200:203], v[64:79]
    v_mfma_f32_32x32x16_bf16 v[80:95], v[12:15], v[200:203], v[80:95]
    s_waitcnt vmcnt(8)
    v_mfma_f32_32x32x16_bf16 v[96:111], v[8:11], v[204:207], v[96:111]
    v_mfma_f32_32x32x16_bf16 v[112:127], v[12:15], v[204:207], v[112:127]
    ds_read_b64_tr_b16 v[40:41], v24 offset:1024
    ds_read_b64_tr_b16 v[42:43], v24 offset:3072
    ds_read_b64_tr_b16 v[44:45], v25 offset:1024
    ds_read_b64_tr_b16 v[46:47], v25 offset:3072
    s_waitcnt vmcnt(7) lgkmcnt(12)
    v_mfma_f32_32x32x16_bf16 v[64:79], v[240:243], v[208:211], v[64:79]
    v_mfma_f32_32x32x16_bf16 v[80:95], v[244:247], v[208:211], v[80:95]
    s_waitcnt vmcnt(6) lgkmcnt(8)
    v_mfma_f32_32x32x16_bf16 v[64:79], v[248:251], v[212:215], v[64:79]
    v_mfma_f32_32x32x16_bf16 v[80:95], v[252:255], v[212:215], v[80:95]
    s_waitcnt vmcnt(5) lgkmcnt(4)
    v_mfma_f32_32x32x16_bf16 v[64:79], v[32:35], v[216:219], v[64:79]
    v_mfma_f32_32x32x16_bf16 v[80:95], v[36:39], v[216:219], v[80:95]
    s_waitcnt vmcnt(4) lgkmcnt(0)
    v_mfma_f32_32x32x16_bf16 v[64:79], v[40:43], v[220:223], v[64:79]
    v_mfma_f32_32x32x16_bf16 v[80:95], v[44:47], v[220:223], v[80:95]
    s_waitcnt vmcnt(3)
    v_mfma_f32_32x32x16_bf16 v[96:111], v[240:243], v[224:227], v[96:111]
    v_mfma_f32_32x32x16_bf16 v[112:127], v[244:247], v[224:227], v[112:127]
    s_waitcnt vmcnt(2)
    v_mfma_f32_32x32x16_bf16 v[96:111], v[248:251], v[228:231], v[96:111]
    s_nop 5
    ds_write_b128 v48, v[64:67] offset:0
    ds_write_b128 v49, v[68:71] offset:0
    v_mfma_f32_32x32x16_bf16 v[112:127], v[252:255], v[228:231], v[112:127]
    ds_write_b128 v50, v[72:75] offset:0
    ds_write_b128 v51, v[76:79] offset:0
    s_waitcnt vmcnt(1)
    v_mfma_f32_32x32x16_bf16 v[96:111], v[32:35], v[232:235], v[96:111]
    ds_write_b128 v48, v[80:83] offset:128
    ds_write_b128 v49, v[84:87] offset:128
    v_mfma_f32_32x32x16_bf16 v[112:127], v[36:39], v[232:235], v[112:127]
    ds_write_b128 v50, v[88:91] offset:128
    ds_write_b128 v51, v[92:95] offset:128
    s_waitcnt vmcnt(0)
    v_mfma_f32_32x32x16_bf16 v[96:111], v[40:43], v[236:239], v[96:111]
    v_mfma_f32_32x32x16_bf16 v[112:127], v[44:47], v[236:239], v[112:127]
    s_nop 10
    ds_write_b128 v48, v[96:99] offset:32768
    ds_write_b128 v49, v[100:103] offset:32768
    ds_write_b128 v50, v[104:107] offset:32768
    ds_write_b128 v51, v[108:111] offset:32768
    ds_write_b128 v48, v[112:115] offset:32896
    ds_write_b128 v49, v[116:119] offset:32896
    ds_write_b128 v50, v[120:123] offset:32896
    ds_write_b128 v51, v[124:127] offset:32896
    s_waitcnt lgkmcnt(0)
    s_barrier
    ds_read_b128 v[128:131], v52 offset:0
    ds_read_b128 v[132:135], v53 offset:0
    ds_read_b128 v[136:139], v52 offset:4096
    ds_read_b128 v[140:143], v53 offset:4096
    ds_read_b128 v[144:147], v52 offset:8192
    ds_read_b128 v[148:151], v53 offset:8192
    ds_read_b128 v[152:155], v52 offset:12288
    ds_read_b128 v[156:159], v53 offset:12288
    ds_read_b128 v[160:163], v52 offset:2048
    ds_read_b128 v[164:167], v53 offset:2048
    ds_read_b128 v[168:171], v52 offset:6144
    ds_read_b128 v[172:175], v53 offset:6144
    ds_read_b128 v[176:179], v52 offset:10240
    ds_read_b128 v[180:183], v53 offset:10240
    ds_read_b128 v[184:187], v52 offset:14336
    ds_read_b128 v[188:191], v53 offset:14336
    s_add_u32 s23, s22, 8192
    s_waitcnt lgkmcnt(8)
    v_pk_add_f32 v[128:129], v[128:129], v[136:137]
    v_pk_add_f32 v[144:145], v[144:145], v[152:153]
    v_pk_add_f32 v[130:131], v[130:131], v[138:139]
    v_pk_add_f32 v[146:147], v[146:147], v[154:155]
    v_pk_add_f32 v[132:133], v[132:133], v[140:141]
    v_pk_add_f32 v[148:149], v[148:149], v[156:157]
    v_pk_add_f32 v[134:135], v[134:135], v[142:143]
    v_pk_add_f32 v[150:151], v[150:151], v[158:159]
    v_pk_add_f32 v[128:129], v[128:129], v[144:145]
    v_pk_add_f32 v[130:131], v[130:131], v[146:147]
    v_pk_add_f32 v[132:133], v[132:133], v[148:149]
    v_pk_add_f32 v[134:135], v[134:135], v[150:151]
    v_cvt_pk_bf16_f32 v128, v128, v129
    v_cvt_pk_bf16_f32 v129, v130, v131
    v_cvt_pk_bf16_f32 v130, v132, v133
    v_cvt_pk_bf16_f32 v131, v134, v135
    buffer_store_dwordx4 v[128:131], v54, s[4:7], s22 offen sc1
    s_waitcnt lgkmcnt(0)
    v_pk_add_f32 v[160:161], v[160:161], v[168:169]
    v_pk_add_f32 v[176:177], v[176:177], v[184:185]
    v_pk_add_f32 v[162:163], v[162:163], v[170:171]
    v_pk_add_f32 v[178:179], v[178:179], v[186:187]
    v_pk_add_f32 v[164:165], v[164:165], v[172:173]
    v_pk_add_f32 v[180:181], v[180:181], v[188:189]
    v_pk_add_f32 v[166:167], v[166:167], v[174:175]
    v_pk_add_f32 v[182:183], v[182:183], v[190:191]
    v_pk_add_f32 v[160:161], v[160:161], v[176:177]
    v_pk_add_f32 v[162:163], v[162:163], v[178:179]
    v_pk_add_f32 v[164:165], v[164:165], v[180:181]
    v_pk_add_f32 v[166:167], v[166:167], v[182:183]
    v_cvt_pk_bf16_f32 v160, v160, v161
    v_cvt_pk_bf16_f32 v161, v162, v163
    v_cvt_pk_bf16_f32 v162, v164, v165
    v_cvt_pk_bf16_f32 v163, v166, v167
    buffer_store_dwordx4 v[160:163], v54, s[4:7], s23 offen sc1
L_end:
    s_endpgm
L_codeend:
.section .rodata,"a"
.p2align 6
.amdhsa_kernel gated_mix__linear_attn_block__mixer_gmlp__prompt_kernel
  .amdhsa_next_free_vgpr 256
  .amdhsa_next_free_sgpr 102
  .amdhsa_accum_offset 256
  .amdhsa_group_segment_fixed_size 0
  .amdhsa_kernarg_size 96
  .amdhsa_user_sgpr_count 2
  .amdhsa_user_sgpr_kernarg_segment_ptr 1
  .amdhsa_system_sgpr_workgroup_id_x 1
.end_amdhsa_kernel
```
